```python
import torch

def _softmax(x, axis=-1):
    return torch.softmax(x, dim=axis)
def _gelu(x):
    return torch.nn.functional.gelu(x, approximate="tanh")
def _silu(x):
    return torch.nn.functional.silu(x)
def _sigmoid(x):
    return torch.sigmoid(x)
def _layernorm(x, axis=-1, eps=1e-5):
    m = x.mean(dim=axis, keepdim=True)
    v = x.var(dim=axis, keepdim=True, unbiased=False)
    return (x - m) / torch.sqrt(v + eps)
def _scatter_add(tgt, idx, src, axis=0):
    return tgt.clone().index_add_(axis, idx, src)
def _segment_sum(src, seg, n):
    out = torch.zeros((n,) + src.shape[1:], dtype=src.dtype)
    return out.index_add_(0, seg, src)
def _pad(x, pw):
    flat = tuple(v for pair in reversed(pw) for v in pair)
    return torch.nn.functional.pad(x, flat)

kernel_name = 'interleave_layers__spectral_gfnet__glu_gated_reglu__prompt'

def setup_inputs():

    _w = (lambda a: (lambda t: t.to(torch.bfloat16) if t.is_floating_point() else t)(torch.as_tensor(a)))
    def _A_setup():
        B, S, D = 1, 2048, 512
        Df = D // 2 + 1
        return {
            "x": _w((lambda *s: torch.randn(*s, dtype=torch.bfloat16) * 0.05)(B, S, D)),
            "w_r": _w((lambda *s: torch.randn(*s, dtype=torch.bfloat16) * 0.4)(S, Df) * 0.02),
            "w_i": _w((lambda *s: torch.randn(*s, dtype=torch.bfloat16) * 0.4)(S, Df) * 0.02),
        }
    _A_in = _A_setup()

    def _B_setup():
        B, S, D, F = 1, 2048, 512, 1792
        return {
            "x": _w((lambda *s: torch.randn(*s, dtype=torch.bfloat16) * 0.05)(B, S, D)),
            "W_gate": _w((lambda *s: torch.randn(*s, dtype=torch.bfloat16) * 0.2)(D, F) * (2.0 / D) ** 0.5),
            "W_up": _w((lambda *s: torch.randn(*s, dtype=torch.bfloat16) * 0.2)(D, F) * (2.0 / D) ** 0.5),
            "W_down": _w((lambda *s: torch.randn(*s, dtype=torch.bfloat16) * 0.2)(F, D) * (1.0 / F) ** 0.5),
        }
    _B_in = _B_setup()

    return {
        "A_x": _A_in["x"],
        "A_w_r": _A_in["w_r"],
        "A_w_i": _A_in["w_i"],
        "B_x": _B_in["x"],
        "B_W_gate": _B_in["W_gate"],
        "B_W_up": _B_in["W_up"],
        "B_W_down": _B_in["W_down"],
    }

def reference(A_x, A_w_r, A_w_i, B_x, B_W_gate, B_W_up, B_W_down):
    def _A_ref(x, w_r, w_i):
        B, S, D = x.shape
        X = (lambda x, axes=(-2,-1): torch.fft.rfft2(x.float(), dim=axes))(x, axes=(-2, -1))
        W = w_r + 1j * w_i
        X = X * W
        y = (lambda x, s, axes=(-2,-1): torch.fft.irfft2(x, s=s, dim=axes).to(torch.bfloat16))(X, (S, D), axes=(-2, -1))
        return y

    def _B_ref(x, W_gate, W_up, W_down):
        gate = torch.einsum("bsd,df->bsf", x, W_gate)
        up = torch.einsum("bsd,df->bsf", x, W_up)
        gate = gate * (lambda x, dt: x.to(dt))(gate > 0, gate.dtype)
        h = gate * up
        return torch.einsum("bsf,fd->bsd", h, W_down)

    x = A_x
    x = x + _A_ref(_layernorm(x, axis=-1), A_w_r, A_w_i)
    x = x + _B_ref(_layernorm(x, axis=-1), B_W_gate, B_W_up, B_W_down)
    x = x + _A_ref(_layernorm(x, axis=-1), A_w_r, A_w_i)
    x = x + _B_ref(_layernorm(x, axis=-1), B_W_gate, B_W_up, B_W_down)
    return x
```

```asm
; @launch grid=(256,1,1) block=(256,1,1) lds=163840
.amdgcn_target "amdgcn-amd-amdhsa--gfx950"
.text
.globl interleave_layers__spectral_gfnet__glu_gated_reglu__prompt_kernel
.p2align 8
.type interleave_layers__spectral_gfnet__glu_gated_reglu__prompt_kernel,@function
interleave_layers__spectral_gfnet__glu_gated_reglu__prompt_kernel:
    s_cmp_ge_u32 s2, 256
    s_cbranch_scc1 L_exit
    s_load_dwordx4 s[4:7], s[0:1], 64
    s_load_dwordx2 s[12:13], s[0:1], 0
    s_load_dwordx4 s[52:55], s[0:1], 8
    s_load_dwordx8 s[44:51], s[0:1], 32
    s_memrealtime s[56:57]
    s_getpc_b64 s[28:29]
L_pc0:
    s_bfe_u32 s30, s2, 196611
    s_lshl_b32 s30, s30, 13
    v_lshrrev_b32 v9, 2, v0
    v_lshlrev_b32 v9, 7, v9
    v_add_u32 v9, s30, v9
    v_min_u32 v9, L_exit - L_pc0, v9
    v_mov_b32 v11, s29
    v_add_co_u32 v10, vcc, s28, v9
    s_nop 1
    v_addc_co_u32 v11, vcc, 0, v11, vcc
    global_load_dword v228, v[10:11], off
    s_bfe_u32 s20, s2, 0x20001
    s_lshl_b32 s20, s20, 6
    s_lshr_b32 s3, s2, 6
    s_lshl_b32 s3, s3, 4
    s_add_u32 s20, s20, s3
    s_and_b32 s3, s2, 1
    s_lshl_b32 s3, s3, 3
    s_add_u32 s20, s20, s3
    s_bfe_u32 s3, s2, 0x30003
    s_add_u32 s20, s20, s3
    s_and_b32 s25, s20, 15
    s_lshl_b32 s25, s25, 4
    s_lshr_b32 s3, s20, 4
    s_add_u32 s25, s25, s3
    v_and_b32 v1, 15, v0
    v_bfe_u32 v2, v0, 4, 2
    v_lshrrev_b32 v3, 6, v0
    v_and_b32 v9, 63, v0
    v_readfirstlane_b32 s21, v3
    v_lshlrev_b32 v6, 4, v9
    v_lshlrev_b32 v7, 4, v0
    v_lshrrev_b32 v9, 5, v0
    v_lshlrev_b32 v8, 18, v9
    v_and_b32 v9, 31, v0
    v_lshl_add_u32 v8, v9, 4, v8
    v_cvt_f32_u32 v4, v1
    v_cvt_f32_u32 v5, v2
    s_mov_b32 s24, 0
    s_mov_b32 s22, 0
    s_lshl_b32 s30, s25, 10
    v_add_u32 v200, s2, v0
    v_lshlrev_b32 v200, 12, v200
    v_accvgpr_write_b32 a252, -1
    v_accvgpr_write_b32 a253, -1
    v_accvgpr_write_b32 a254, -1
    v_accvgpr_write_b32 a255, -1
    s_lshl_b32 s39, s21, 11
    s_lshl_b32 s31, s20, 13
    s_add_u32 s32, s31, 4096
    s_add_u32 s36, s31, 2097152
    s_add_u32 s37, s36, 4096
    s_add_u32 s38, s31, s39
    s_add_u32 s43, s38, 0
    s_add_u32 s38, s38, 4194304
    v_cmp_eq_u32 vcc, 0, v6
    v_lshlrev_b32 v10, 6, v3
    v_sub_u32 v10, 256, v10
    v_cmp_ne_u32 s[28:29], 0, v3
    v_cndmask_b32 v196, v0, v10, vcc
    v_lshlrev_b32 v196, 1, v196
    s_and_b64 vcc, vcc, s[28:29]
    s_lshr_b32 s40, s20, 6
    s_lshl_b32 s40, s40, 1
    s_and_b32 s41, s20, 15
    s_lshl_b32 s41, s41, 3
    s_add_u32 s40, s40, s41
    s_bfe_u32 s41, s20, 0x20004
    s_lshl_b32 s41, s41, 9
    s_add_u32 s40, s40, s41
    v_cndmask_b32 v198, 1, -1, vcc
    v_and_b32 v225, 0x80000000, v198
    v_mul_i32_i24 v197, s40, v198
    s_waitcnt lgkmcnt(0)
    s_mov_b32 s14, 2097152
    s_mov_b32 s15, 0x20000
    buffer_load_dwordx4 v[16:19], v8, s[12:15], s30 offen offset:0
    buffer_load_dwordx4 v[20:23], v8, s[12:15], s30 offen offset:512
    s_mov_b32 s16, s4
    s_mov_b32 s17, s5
    s_mov_b32 s18, 0x100
    s_mov_b32 s19, 0x20000
    s_or_b32 s56, s56, 1
    v_mov_b32 v216, s56
    v_mov_b32 v217, s57
    buffer_store_dwordx2 v[216:217], v200, s[16:19], 0 offen sc1
    s_mov_b32 s8, s6
    s_mov_b32 s9, s7
    s_mov_b32 s10, 0x1200000
    s_mov_b32 s11, 0x20000
    s_mov_b32 s26, s50
    s_mov_b32 s27, s51
    s_and_b32 s41, s21, 1
    s_cselect_b32 s60, s46, s44
    s_cselect_b32 s61, s47, s45
    s_mov_b32 s62, 1835008
    s_mov_b32 s63, 0x20000
    s_mov_b32 s44, s52
    s_mov_b32 s45, s53
    s_mov_b32 s46, 0x101000
    s_mov_b32 s47, 0x20000
    s_mov_b32 s56, s54
    s_mov_b32 s57, s55
    s_mov_b32 s58, 0x101000
    s_mov_b32 s59, 0x20000
    s_movk_i32 s42, 514
    v_lshlrev_b32 v202, 7, v198
    buffer_store_dwordx4 a[252:255], v6, s[8:11], s38 offen offset:0 sc1
    v_bfe_u32 v222, v0, 5, 1
    v_lshrrev_b32 v9, 5, v0
    v_lshlrev_b32 v199, 10, v222
    v_and_b32 v10, 1, v9
    v_and_b32 v222, 31, v0
    v_lshlrev_b32 v10, 3, v10
    v_lshl_add_u32 v199, v222, 4, v199
    v_and_b32 v11, 31, v0
    s_lshr_b32 s33, s20, 1
    v_xor_b32 v10, v10, v11
    s_mul_i32 s52, s33, 9363
    v_lshlrev_b32 v10, 4, v10
    s_lshr_b32 s52, s52, 16
    v_lshl_add_u32 v208, v9, 10, v10
    s_mul_i32 s53, s52, 7
    v_add_u32 v208, 151744, v208
    s_sub_u32 s53, s33, s53
    v_lshrrev_b32 v9, 2, v1
    s_lshl_b32 s54, s52, 6
    s_lshl_b32 s55, s53, 4
    buffer_store_dwordx4 a[252:255], v6, s[8:11], s38 offen offset:1024 sc1
    v_lshl_add_u32 v9, v2, 2, v9
    s_add_u32 s54, s54, s55
    v_bfe_u32 v10, v1, 1, 1
    s_lshl_b32 s41, s52, 5
    v_lshlrev_b32 v11, 3, v10
    s_add_u32 s41, s41, s55
    v_xor_b32 v9, v9, v11
    s_add_u32 s41, s41, 960
    v_lshlrev_b32 v9, 4, v9
    s_cmp_ge_u32 s53, 4
    s_cselect_b32 s54, s41, s54
    v_lshl_add_u32 v9, v10, 10, v9
    s_lshl_b32 s41, s52, 4
    v_and_b32 v10, 1, v1
    s_add_u32 s41, s41, 1536
    v_lshl_add_u32 v209, v10, 3, v9
    s_cmp_eq_u32 s53, 6
    s_cselect_b32 s54, s41, s54
    s_lshl_b32 s55, s21, 2
    v_add_u32 v209, 151744, v209
    s_add_u32 s54, s54, s55
    v_and_b32 v200, 2047, v197
    v_mad_u32_u24 v200, v200, s42, v196
    buffer_load_ushort v240, v200, s[44:47], 0 offen
    buffer_load_ushort v248, v200, s[56:59], 0 offen
    v_lshrrev_b32 v9, 1, v2
    s_lshl_b32 s54, s54, 10
    v_lshlrev_b32 v10, 4, v2
    s_and_b32 s55, s20, 1
    v_lshl_add_u32 v211, v3, 2, v10
    s_lshl_b32 s55, s55, 9
    v_add_u32 v211, 159936, v211
    s_add_u32 s54, s54, s55
    v_lshlrev_b32 v15, 5, v9
    s_add_u32 s55, s54, 2048
    v_add_u32 v15, 159936, v15
    s_mov_b32 s50, 1835008
    v_mov_b32 v213, 0x3f803f80
    s_mov_b32 s51, 0x20000
    s_lshr_b32 s3, s20, 4
    v_lshl_add_u32 v12, v3, 4, v1
    s_lshl_b32 s3, s3, 2
    v_cvt_f32_u32 v9, v12
    s_add_u32 s3, s3, s21
    v_add_u32 v201, v197, v198
    v_and_b32 v201, 2047, v201
    v_add_u32 v197, v197, v202
    v_mad_u32_u24 v201, v201, s42, v196
    buffer_load_ushort v244, v201, s[44:47], 0 offen
    buffer_load_ushort v252, v201, s[56:59], 0 offen
    v_mul_f32 v10, 0x3c800000, v9
    s_mul_i32 s3, s3, 114688
    v_mul_f32 v11, v9, v5
    s_and_b32 s101, s20, 15
    v_mul_f32 v11, 0x3d800000, v11
    s_mul_i32 s101, s101, 7168
    v_mov_b32 v72, v11
    s_add_u32 s3, s3, s101
    v_add_f32 v73, v10, v11
    s_add_u32 s3, s3, 6291456
    v_fmamk_f32 v74, v10, 0x40000000, v11
    s_add_u32 s101, s3, 4096
    v_fmamk_f32 v75, v10, 0x40400000, v11
    s_lshl_b32 s40, s20, 1
    s_lshr_b32 s41, s21, 1
    v_fmamk_f32 v76, v10, 0x41800000, v11
    s_add_u32 s40, s40, s41
    v_fmamk_f32 v77, v10, 0x41880000, v11
    s_mul_i32 s40, s40, 3584
    v_fmamk_f32 v78, v10, 0x41900000, v11
    v_and_b32 v200, 2047, v197
    v_mad_u32_u24 v200, v200, s42, v196
    buffer_load_ushort v241, v200, s[44:47], 0 offen
    buffer_load_ushort v249, v200, s[56:59], 0 offen
    s_lshl_b32 s34, s20, 7
    v_fmamk_f32 v79, v10, 0x41980000, v11
    s_add_u32 s34, s34, 13631488
    v_sin_f32 v80, v72
    s_mov_b32 s35, 13631488
    v_cos_f32 v72, v72
    v_lshrrev_b32 v220, 3, v0
    v_sin_f32 v81, v73
    v_min_u32 v220, 1, v220
    v_cos_f32 v73, v73
    v_lshl_add_u32 v220, v220, 30, v7
    v_lshrrev_b32 v224, 1, v0
    v_sin_f32 v82, v74
    v_lshlrev_b32 v224, 7, v224
    v_cos_f32 v74, v74
    v_and_b32 v222, 1, v0
    v_sin_f32 v83, v75
    v_lshl_add_u32 v224, v222, 14, v224
    v_cos_f32 v75, v75
    v_add_u32 v201, v197, v198
    v_and_b32 v201, 2047, v201
    v_add_u32 v197, v197, v202
    v_mad_u32_u24 v201, v201, s42, v196
    buffer_load_ushort v245, v201, s[44:47], 0 offen
    buffer_load_ushort v253, v201, s[56:59], 0 offen
    v_lshlrev_b32 v135, 6, v2
    v_sin_f32 v84, v76
    v_lshl_add_u32 v135, v3, 4, v135
    v_cos_f32 v76, v76
    v_add_lshl_u32 v135, v135, v1, 4
    v_sin_f32 v85, v77
    v_lshlrev_b32 v226, 2, v2
    v_cos_f32 v77, v77
    v_and_b32 v227, 2, v3
    v_add_u32 v226, v226, v227
    v_sin_f32 v86, v78
    v_bfe_u32 v227, v0, 3, 1
    v_cos_f32 v78, v78
    v_add_u32 v226, v226, v227
    v_sin_f32 v87, v79
    v_mul_u32_u24 v226, 3584, v226
    v_cos_f32 v79, v79
    s_and_b32 s92, s20, 15
    v_and_b32 v13, 1, v1
    v_and_b32 v200, 2047, v197
    v_mad_u32_u24 v200, v200, s42, v196
    buffer_load_ushort v242, v200, s[44:47], 0 offen
    buffer_load_ushort v250, v200, s[56:59], 0 offen
    s_lshl_b32 s92, s92, 7
    s_mov_b32 s28, 0x80008000
    s_add_u32 s92, s92, 0
    v_mul_lo_u32 v13, v13, s28
    v_and_b32 v132, 7, v0
    v_cvt_pk_bf16_f32 v56, v72, v73
    v_lshl_add_u32 v132, v132, 4, v226
    v_add_u32 v132, s92, v132
    v_cvt_pk_bf16_f32 v64, -v80, -v81
    s_and_b32 s92, s20, 15
    v_cvt_pk_bf16_f32 v57, v74, v75
    s_lshl_b32 s92, s92, 6
    v_cvt_pk_bf16_f32 v65, -v82, -v83
    s_add_u32 s92, s92, 2048
    v_cvt_pk_bf16_f32 v58, v76, v77
    v_and_b32 v133, 3, v0
    v_cvt_pk_bf16_f32 v66, -v84, -v85
    v_lshl_add_u32 v133, v133, 4, v226
    v_cvt_pk_bf16_f32 v59, v78, v79
    v_bfe_u32 v227, v0, 2, 1
    v_add_u32 v201, v197, v198
    v_and_b32 v201, 2047, v201
    v_add_u32 v197, v197, v202
    v_mad_u32_u24 v201, v201, s42, v196
    buffer_load_ushort v246, v201, s[44:47], 0 offen
    buffer_load_ushort v254, v201, s[56:59], 0 offen
    v_cvt_pk_bf16_f32 v67, -v86, -v87
    v_mul_u32_u24 v227, 57344, v227
    v_xor_b32 v60, v56, v13
    v_add_u32 v133, v133, v227
    v_xor_b32 v68, v64, v13
    v_add_u32 v133, s92, v133
    s_and_b32 s92, s20, 15
    v_xor_b32 v61, v57, v13
    s_lshl_b32 s92, s92, 5
    v_xor_b32 v69, v65, v13
    s_add_u32 s92, s92, 3072
    v_xor_b32 v62, v58, v13
    v_and_b32 v134, 1, v0
    v_xor_b32 v70, v66, v13
    v_lshl_add_u32 v134, v134, 4, v226
    v_xor_b32 v63, v59, v13
    v_bfe_u32 v227, v0, 1, 2
    v_xor_b32 v71, v67, v13
    v_mul_u32_u24 v227, 57344, v227
    v_and_b32 v200, 2047, v197
    v_mad_u32_u24 v200, v200, s42, v196
    buffer_load_ushort v243, v200, s[44:47], 0 offen
    buffer_load_ushort v251, v200, s[56:59], 0 offen
    v_cmp_eq_u32 vcc, 0, v12
    v_add_u32 v134, v134, v227
    v_mov_b32 v10, 0x43800000
    v_add_u32 v134, s92, v134
    v_accvgpr_write_b32 a240, v132
    v_cndmask_b32 v128, 0, 1.0, vcc
    s_lshr_b32 s93, s20, 4
    v_cndmask_b32 v9, v9, v10, vcc
    s_mul_i32 s94, s93, 114688
    v_cndmask_b32 v129, 0, -1.0, vcc
    s_lshr_b32 s95, s93, 1
    v_cndmask_b32 v130, 0, 1.0, vcc
    s_mul_i32 s96, s95, 229376
    v_cndmask_b32 v131, 0, -1.0, vcc
    s_and_b32 s97, s20, 15
    v_mul_f32 v9, 0x3b000000, v9
    s_mul_i32 s97, s97, 98304
    v_and_b32 v10, 1, v2
    s_lshl_b32 s98, s21, 10
    v_add_u32 v201, v197, v198
    v_and_b32 v201, 2047, v201
    v_add_u32 v197, v197, v202
    v_mad_u32_u24 v201, v201, s42, v196
    buffer_load_ushort v247, v201, s[44:47], 0 offen
    buffer_load_ushort v255, v201, s[56:59], 0 offen
    v_cvt_f32_u32 v14, v10
    s_add_u32 s97, s97, s98
    s_add_u32 s97, s97, 14155776
    v_mul_f32 v10, v14, v9
    s_lshl_b32 s98, s93, 12
    v_mul_f32 v10, 4.0, v10
    s_add_u32 s98, s98, s97
    v_mov_b32 v104, v10
    s_lshl_b32 s99, s95, 12
    v_add_f32 v105, v9, v10
    s_add_u32 s99, s99, s97
    v_fmamk_f32 v106, v9, 0x40000000, v10
    s_add_u32 s99, s99, 65536
    v_fmamk_f32 v107, v9, 0x40400000, v10
    s_lshr_b32 s95, s21, 1
    v_sin_f32 v108, v104
    s_xor_b32 s95, s95, s93
    v_cos_f32 v104, v104
    s_and_b32 s95, s95, 1
    s_cselect_b32 s96, 0x7ff00000, s96
    s_cselect_b32 s99, 0x7ff00000, s99
    s_add_u32 m0, s39, 8192
    s_nop 0
    buffer_load_dwordx4 v199, s[48:51], s54 offen lds
    v_sin_f32 v109, v105
    v_cos_f32 v105, v105
    v_sin_f32 v110, v106
    v_cos_f32 v106, v106
    v_sin_f32 v111, v107
    v_cos_f32 v107, v107
    v_and_b32 v9, 3, v1
    v_cvt_f32_u32 v9, v9
    v_mul_f32 v9, 0x3e000000, v9
    v_lshrrev_b32 v10, 2, v1
    v_cvt_f32_u32 v10, v10
    v_mul_f32 v10, 0x3e000000, v10
    v_lshrrev_b32 v12, 1, v2
    v_cvt_f32_u32 v11, v12
    v_mul_f32 v11, v11, v9
    v_mul_f32 v14, v14, v10
    v_fmamk_f32 v11, v14, 0x40800000, v11
    v_mul_lo_u32 v14, v12, s28
    v_fmamk_f32 v12, v9, 0x40000000, v11
    v_mov_b32 v72, v11
    v_add_f32 v73, v10, v11
    v_fmamk_f32 v74, v10, 0x40000000, v11
    v_fmamk_f32 v75, v10, 0x40400000, v11
    v_mov_b32 v76, v12
    v_add_f32 v77, v10, v12
    v_fmamk_f32 v78, v10, 0x40000000, v12
    v_fmamk_f32 v79, v10, 0x40400000, v12
    v_sin_f32 v80, v72
    v_cos_f32 v72, v72
    v_sin_f32 v81, v73
    v_cos_f32 v73, v73
    v_sin_f32 v82, v74
    v_cos_f32 v74, v74
    v_sin_f32 v83, v75
    v_cos_f32 v75, v75
    v_sin_f32 v84, v76
    v_cos_f32 v76, v76
    v_sin_f32 v85, v77
    v_cos_f32 v77, v77
    v_sin_f32 v86, v78
    v_cos_f32 v78, v78
    v_sin_f32 v87, v79
    v_cos_f32 v79, v79
    v_xor_b32 v12, v13, v14
    v_cvt_pk_bf16_f32 v144, v72, v73
    v_cvt_pk_bf16_f32 v160, v80, v81
    s_add_u32 m0, s39, 9216
    s_nop 0
    buffer_load_dwordx4 v199, s[48:51], s55 offen lds
    v_cvt_pk_bf16_f32 v176, -v80, -v81
    v_cvt_pk_bf16_f32 v145, v74, v75
    v_cvt_pk_bf16_f32 v161, v82, v83
    v_cvt_pk_bf16_f32 v177, -v82, -v83
    v_cvt_pk_bf16_f32 v146, v76, v77
    v_cvt_pk_bf16_f32 v162, v84, v85
    v_cvt_pk_bf16_f32 v178, -v84, -v85
    v_cvt_pk_bf16_f32 v147, v78, v79
    v_cvt_pk_bf16_f32 v163, v86, v87
    v_cvt_pk_bf16_f32 v179, -v86, -v87
    v_xor_b32 v148, v144, v13
    v_xor_b32 v164, v160, v13
    v_xor_b32 v180, v176, v13
    v_xor_b32 v149, v145, v13
    v_xor_b32 v165, v161, v13
    v_xor_b32 v181, v177, v13
    v_xor_b32 v150, v146, v13
    v_xor_b32 v166, v162, v13
    v_xor_b32 v182, v178, v13
    v_xor_b32 v151, v147, v13
    v_xor_b32 v167, v163, v13
    v_xor_b32 v183, v179, v13
    v_xor_b32 v152, v144, v14
    v_xor_b32 v168, v160, v14
    v_xor_b32 v184, v176, v14
    v_xor_b32 v153, v145, v14
    v_xor_b32 v169, v161, v14
    v_xor_b32 v185, v177, v14
    v_xor_b32 v154, v146, v14
    v_xor_b32 v170, v162, v14
    v_xor_b32 v186, v178, v14
    v_xor_b32 v155, v147, v14
    v_xor_b32 v171, v163, v14
    v_xor_b32 v187, v179, v14
    v_xor_b32 v156, v144, v12
    v_xor_b32 v172, v160, v12
    v_xor_b32 v188, v176, v12
    v_xor_b32 v157, v145, v12
    v_xor_b32 v173, v161, v12
    v_xor_b32 v189, v177, v12
    v_xor_b32 v158, v146, v12
    v_xor_b32 v174, v162, v12
    v_xor_b32 v190, v178, v12
    v_xor_b32 v159, v147, v12
    v_xor_b32 v175, v163, v12
    v_xor_b32 v191, v179, v12
    s_waitcnt vmcnt(21)
L_p1_data:
    ds_write_b128 v208, v[16:19] offset:0
    ds_write_b128 v208, v[20:23] offset:512
    v_mov_b32 v192, 0
    v_mov_b32 v193, 0
    v_dot2c_f32_bf16 v192, v16, v213
    v_dot2c_f32_bf16 v193, v16, v16
    v_dot2c_f32_bf16 v192, v17, v213
    v_dot2c_f32_bf16 v193, v17, v17
    v_dot2c_f32_bf16 v192, v18, v213
    v_dot2c_f32_bf16 v193, v18, v18
    v_dot2c_f32_bf16 v192, v19, v213
    v_dot2c_f32_bf16 v193, v19, v19
    v_dot2c_f32_bf16 v192, v20, v213
    v_dot2c_f32_bf16 v193, v20, v20
    v_dot2c_f32_bf16 v192, v21, v213
    v_dot2c_f32_bf16 v193, v21, v21
    v_dot2c_f32_bf16 v192, v22, v213
    v_dot2c_f32_bf16 v193, v22, v22
    v_dot2c_f32_bf16 v192, v23, v213
    v_dot2c_f32_bf16 v193, v23, v23
    s_waitcnt lgkmcnt(0)
    s_barrier
    s_nop 0
    v_permlane16_swap_b32 v192, v193
    v_add_f32 v192, v192, v193
    ds_read_b64_tr_b16 v[24:25], v209 offset:0
    ds_read_b64_tr_b16 v[26:27], v209 offset:256
    ds_read_b64_tr_b16 v[28:29], v209 offset:512
    ds_read_b64_tr_b16 v[30:31], v209 offset:768
    v_add_f32_dpp v192, v192, v192 row_ror:8 row_mask:0xf bank_mask:0xf
    ds_read_b64_tr_b16 v[32:33], v209 offset:2048
    ds_read_b64_tr_b16 v[34:35], v209 offset:2304
    ds_read_b64_tr_b16 v[36:37], v209 offset:2560
    v_add_f32_dpp v192, v192, v192 row_ror:4 row_mask:0xf bank_mask:0xf
    ds_read_b64_tr_b16 v[38:39], v209 offset:2816
    ds_read_b64_tr_b16 v[40:41], v209 offset:4096
    ds_read_b64_tr_b16 v[42:43], v209 offset:4352
    v_add_f32_dpp v192, v192, v192 row_ror:2 row_mask:0xf bank_mask:0xf
    ds_read_b64_tr_b16 v[44:45], v209 offset:4608
    ds_read_b64_tr_b16 v[46:47], v209 offset:4864
    ds_read_b64_tr_b16 v[48:49], v209 offset:6144
    v_add_f32_dpp v192, v192, v192 row_ror:1 row_mask:0xf bank_mask:0xf
    ds_read_b64_tr_b16 v[50:51], v209 offset:6400
    ds_read_b64_tr_b16 v[52:53], v209 offset:6656
    ds_read_b64_tr_b16 v[54:55], v209 offset:6912
    s_cmp_eq_u32 s22, 0
    s_cbranch_scc0 L_l0_1
    buffer_load_dwordx2 v[216:217], off, s[16:19], 0 sc1
    buffer_load_dwordx4 v[136:139], v133, s[60:63], s94 offen
    buffer_load_dwordx4 v[140:143], v134, s[60:63], s96 offen
L_l0_1:
    v_mul_f32 v192, 0x3b000000, v192
    s_mov_b32 vcc_lo, 0xffff0000
    v_mov_b32 v193, v192
    s_mov_b32 vcc_hi, 0xffff0000
    s_nop 0
    v_permlane16_swap_b32 v192, v193
    s_waitcnt lgkmcnt(14)
    v_mfma_f32_16x16x32_bf16 v[72:75], v[24:27], v[56:59], 0
    v_mfma_f32_16x16x32_bf16 v[88:91], v[24:27], v[64:67], 0
    v_fma_f32 v193, -v192, v192, v193
    v_mul_f32 v192, 0xc2800000, v192
    s_waitcnt lgkmcnt(12)
    v_mfma_f32_16x16x32_bf16 v[72:75], v[28:31], v[60:63], v[72:75]
    v_max_f32 v193, 0, v193
    v_mfma_f32_16x16x32_bf16 v[88:91], v[28:31], v[68:71], v[88:91]
    s_waitcnt lgkmcnt(10)
    v_mfma_f32_16x16x32_bf16 v[76:79], v[32:35], v[56:59], 0
    v_add_f32 v193, 0x3727c5ac, v193
    v_mfma_f32_16x16x32_bf16 v[92:95], v[32:35], v[64:67], 0
    v_rsq_f32 v193, v193
    s_waitcnt lgkmcnt(8)
    v_mfma_f32_16x16x32_bf16 v[76:79], v[36:39], v[60:63], v[76:79]
    v_mfma_f32_16x16x32_bf16 v[92:95], v[36:39], v[68:71], v[92:95]
    v_mul_f32 v192, v192, v193
    s_waitcnt lgkmcnt(6)
    v_mfma_f32_16x16x32_bf16 v[80:83], v[40:43], v[56:59], 0
    v_cndmask_b32 v192, v193, v192, vcc
    v_mfma_f32_16x16x32_bf16 v[96:99], v[40:43], v[64:67], 0
    s_waitcnt lgkmcnt(4)
    v_mfma_f32_16x16x32_bf16 v[80:83], v[44:47], v[60:63], v[80:83]
    v_mfma_f32_16x16x32_bf16 v[96:99], v[44:47], v[68:71], v[96:99]
    s_waitcnt lgkmcnt(2)
    v_mfma_f32_16x16x32_bf16 v[84:87], v[48:51], v[56:59], 0
    v_mfma_f32_16x16x32_bf16 v[100:103], v[48:51], v[64:67], 0
    s_waitcnt lgkmcnt(0)
    v_mfma_f32_16x16x32_bf16 v[84:87], v[52:55], v[60:63], v[84:87]
    v_mfma_f32_16x16x32_bf16 v[100:103], v[52:55], v[68:71], v[100:103]
    ds_write_b32 v211, v192
    s_cmp_eq_u32 s22, 0
    s_cbranch_scc0 L_l0_2
    s_waitcnt vmcnt(3)
L_l0_2:
    v_pk_mul_f32 v[24:25], v[72:73], v[104:105]
    v_pk_mul_f32 v[40:41], v[88:89], v[104:105]
    v_pk_mul_f32 v[26:27], v[74:75], v[106:107]
    v_pk_mul_f32 v[42:43], v[90:91], v[106:107]
    v_pk_fma_f32 v[24:25], v[88:89], v[108:109], v[24:25]
    v_pk_fma_f32 v[40:41], v[72:73], v[108:109], v[40:41] neg_lo:[1,0,0] neg_hi:[1,0,0]
    v_pk_fma_f32 v[26:27], v[90:91], v[110:111], v[26:27]
    v_pk_fma_f32 v[42:43], v[74:75], v[110:111], v[42:43] neg_lo:[1,0,0] neg_hi:[1,0,0]
    v_pk_mul_f32 v[28:29], v[76:77], v[104:105]
    v_pk_mul_f32 v[44:45], v[92:93], v[104:105]
    v_pk_mul_f32 v[30:31], v[78:79], v[106:107]
    v_pk_mul_f32 v[46:47], v[94:95], v[106:107]
    v_pk_fma_f32 v[28:29], v[92:93], v[108:109], v[28:29]
    v_pk_fma_f32 v[44:45], v[76:77], v[108:109], v[44:45] neg_lo:[1,0,0] neg_hi:[1,0,0]
    v_pk_fma_f32 v[30:31], v[94:95], v[110:111], v[30:31]
    v_pk_fma_f32 v[46:47], v[78:79], v[110:111], v[46:47] neg_lo:[1,0,0] neg_hi:[1,0,0]
    s_waitcnt lgkmcnt(0)
    s_barrier
    ds_read_b128 v[192:195], v15
    ds_read_b128 v[196:199], v15 offset:16
    v_pk_mul_f32 v[32:33], v[80:81], v[104:105]
    v_pk_mul_f32 v[48:49], v[96:97], v[104:105]
    v_pk_mul_f32 v[34:35], v[82:83], v[106:107]
    v_pk_mul_f32 v[50:51], v[98:99], v[106:107]
    v_pk_fma_f32 v[32:33], v[96:97], v[108:109], v[32:33]
    v_pk_fma_f32 v[48:49], v[80:81], v[108:109], v[48:49] neg_lo:[1,0,0] neg_hi:[1,0,0]
    v_pk_fma_f32 v[34:35], v[98:99], v[110:111], v[34:35]
    v_pk_fma_f32 v[50:51], v[82:83], v[110:111], v[50:51] neg_lo:[1,0,0] neg_hi:[1,0,0]
    v_pk_mul_f32 v[36:37], v[84:85], v[104:105]
    v_pk_mul_f32 v[52:53], v[100:101], v[104:105]
    v_pk_mul_f32 v[38:39], v[86:87], v[106:107]
    v_pk_mul_f32 v[54:55], v[102:103], v[106:107]
    v_pk_fma_f32 v[36:37], v[100:101], v[108:109], v[36:37]
    v_pk_fma_f32 v[52:53], v[84:85], v[108:109], v[52:53] neg_lo:[1,0,0] neg_hi:[1,0,0]
    v_pk_fma_f32 v[38:39], v[102:103], v[110:111], v[38:39]
    v_pk_fma_f32 v[54:55], v[86:87], v[110:111], v[54:55] neg_lo:[1,0,0] neg_hi:[1,0,0]
    s_waitcnt lgkmcnt(0)
    v_pk_mul_f32 v[200:201], v[128:129], v[196:197] op_sel:[0,0] op_sel_hi:[1,0]
    v_pk_mul_f32 v[40:41], v[40:41], v[192:193] op_sel:[0,0] op_sel_hi:[1,0]
    v_pk_mul_f32 v[202:203], v[130:131], v[196:197] op_sel:[0,0] op_sel_hi:[1,0]
    v_pk_mul_f32 v[42:43], v[42:43], v[192:193] op_sel:[0,0] op_sel_hi:[1,0]
    v_pk_fma_f32 v[24:25], v[24:25], v[192:193], v[200:201] op_sel:[0,0,0] op_sel_hi:[1,0,1]
    v_pk_fma_f32 v[26:27], v[26:27], v[192:193], v[202:203] op_sel:[0,0,0] op_sel_hi:[1,0,1]
    v_pk_mul_f32 v[200:201], v[128:129], v[196:197] op_sel:[0,1] op_sel_hi:[1,1]
    v_pk_mul_f32 v[44:45], v[44:45], v[192:193] op_sel:[0,1] op_sel_hi:[1,1]
    v_pk_mul_f32 v[202:203], v[130:131], v[196:197] op_sel:[0,1] op_sel_hi:[1,1]
    v_pk_mul_f32 v[46:47], v[46:47], v[192:193] op_sel:[0,1] op_sel_hi:[1,1]
    v_pk_fma_f32 v[28:29], v[28:29], v[192:193], v[200:201] op_sel:[0,1,0] op_sel_hi:[1,1,1]
    v_pk_fma_f32 v[30:31], v[30:31], v[192:193], v[202:203] op_sel:[0,1,0] op_sel_hi:[1,1,1]
    v_cvt_pk_bf16_f32 v64, v40, v41
    v_cvt_pk_bf16_f32 v65, v42, v43
    v_cvt_pk_bf16_f32 v66, v44, v45
    v_cvt_pk_bf16_f32 v67, v46, v47
    v_cvt_pk_bf16_f32 v56, v24, v25
    v_cvt_pk_bf16_f32 v57, v26, v27
    v_cvt_pk_bf16_f32 v58, v28, v29
    v_cvt_pk_bf16_f32 v59, v30, v31
    v_mfma_f32_16x16x32_bf16 v[112:115], v[160:163], v[64:67], 0
    v_pk_mul_f32 v[200:201], v[128:129], v[198:199] op_sel:[0,0] op_sel_hi:[1,0]
    v_pk_mul_f32 v[48:49], v[48:49], v[194:195] op_sel:[0,0] op_sel_hi:[1,0]
    v_pk_mul_f32 v[202:203], v[130:131], v[198:199] op_sel:[0,0] op_sel_hi:[1,0]
    v_mfma_f32_16x16x32_bf16 v[120:123], v[144:147], v[64:67], 0
    v_pk_mul_f32 v[50:51], v[50:51], v[194:195] op_sel:[0,0] op_sel_hi:[1,0]
    v_pk_fma_f32 v[32:33], v[32:33], v[194:195], v[200:201] op_sel:[0,0,0] op_sel_hi:[1,0,1]
    v_mfma_f32_16x16x32_bf16 v[116:119], v[168:171], v[64:67], 0
    v_pk_fma_f32 v[34:35], v[34:35], v[194:195], v[202:203] op_sel:[0,0,0] op_sel_hi:[1,0,1]
    v_pk_mul_f32 v[200:201], v[128:129], v[198:199] op_sel:[0,1] op_sel_hi:[1,1]
    v_pk_mul_f32 v[52:53], v[52:53], v[194:195] op_sel:[0,1] op_sel_hi:[1,1]
    v_mfma_f32_16x16x32_bf16 v[124:127], v[152:155], v[64:67], 0
    v_pk_mul_f32 v[202:203], v[130:131], v[198:199] op_sel:[0,1] op_sel_hi:[1,1]
    v_pk_mul_f32 v[54:55], v[54:55], v[194:195] op_sel:[0,1] op_sel_hi:[1,1]
    v_mfma_f32_16x16x32_bf16 v[112:115], v[144:147], v[56:59], v[112:115]
    v_pk_fma_f32 v[36:37], v[36:37], v[194:195], v[200:201] op_sel:[0,1,0] op_sel_hi:[1,1,1]
    v_pk_fma_f32 v[38:39], v[38:39], v[194:195], v[202:203] op_sel:[0,1,0] op_sel_hi:[1,1,1]
    v_cvt_pk_bf16_f32 v68, v48, v49
    v_mfma_f32_16x16x32_bf16 v[120:123], v[176:179], v[56:59], v[120:123]
    v_cvt_pk_bf16_f32 v69, v50, v51
    v_cvt_pk_bf16_f32 v70, v52, v53
    v_mfma_f32_16x16x32_bf16 v[116:119], v[152:155], v[56:59], v[116:119]
    v_cvt_pk_bf16_f32 v71, v54, v55
    v_cvt_pk_bf16_f32 v60, v32, v33
    v_cvt_pk_bf16_f32 v61, v34, v35
    v_mfma_f32_16x16x32_bf16 v[124:127], v[184:187], v[56:59], v[124:127]
    v_cvt_pk_bf16_f32 v62, v36, v37
    v_cvt_pk_bf16_f32 v63, v38, v39
    v_mfma_f32_16x16x32_bf16 v[112:115], v[164:167], v[68:71], v[112:115]
    v_permlane16_swap_b32 v16, v18
    v_mfma_f32_16x16x32_bf16 v[120:123], v[148:151], v[68:71], v[120:123]
    v_permlane16_swap_b32 v17, v19
    v_mfma_f32_16x16x32_bf16 v[116:119], v[172:175], v[68:71], v[116:119]
    v_permlane16_swap_b32 v20, v22
    v_mfma_f32_16x16x32_bf16 v[124:127], v[156:159], v[68:71], v[124:127]
    v_permlane16_swap_b32 v21, v23
    v_mfma_f32_16x16x32_bf16 v[112:115], v[148:151], v[60:63], v[112:115]
    v_accvgpr_write_b32 a232, v16
    v_accvgpr_write_b32 a233, v17
    v_mfma_f32_16x16x32_bf16 v[120:123], v[180:183], v[60:63], v[120:123]
    v_accvgpr_write_b32 a234, v18
    v_accvgpr_write_b32 a235, v19
    v_mfma_f32_16x16x32_bf16 v[116:119], v[156:159], v[60:63], v[116:119]
    v_accvgpr_write_b32 a236, v20
    v_accvgpr_write_b32 a237, v21
    v_mfma_f32_16x16x32_bf16 v[124:127], v[188:191], v[60:63], v[124:127]
    v_accvgpr_write_b32 a238, v22
    v_accvgpr_write_b32 a239, v23
    v_cvt_pk_bf16_f32 v88, v112, v120
    v_cvt_pk_bf16_f32 v89, v113, v121
    v_cvt_pk_bf16_f32 v90, v114, v122
    v_cvt_pk_bf16_f32 v91, v115, v123
    s_nop 1
    v_cvt_pk_bf16_f32 v92, v116, v124
    v_cvt_pk_bf16_f32 v93, v117, v125
    v_cvt_pk_bf16_f32 v94, v118, v126
    v_cvt_pk_bf16_f32 v95, v119, v127
    v_or_b32 v88, 1, v88
    v_or_b32 v92, 1, v92
    s_mov_b32 vcc_lo, 0x55555555
    s_mov_b32 vcc_hi, 0x55555555
    v_cndmask_b32_dpp v96, v92, v88, vcc quad_perm:[1,0,3,2] row_mask:0xf bank_mask:0xf
    v_cndmask_b32_dpp v97, v93, v89, vcc quad_perm:[1,0,3,2] row_mask:0xf bank_mask:0xf
    v_cndmask_b32_dpp v98, v94, v90, vcc quad_perm:[1,0,3,2] row_mask:0xf bank_mask:0xf
    v_cndmask_b32_dpp v99, v95, v91, vcc quad_perm:[1,0,3,2] row_mask:0xf bank_mask:0xf
    s_not_b64 vcc, vcc
    v_cndmask_b32_dpp v100, v88, v92, vcc quad_perm:[1,0,3,2] row_mask:0xf bank_mask:0xf
    v_cndmask_b32_dpp v101, v89, v93, vcc quad_perm:[1,0,3,2] row_mask:0xf bank_mask:0xf
    v_cndmask_b32_dpp v102, v90, v94, vcc quad_perm:[1,0,3,2] row_mask:0xf bank_mask:0xf
    v_cndmask_b32_dpp v103, v91, v95, vcc quad_perm:[1,0,3,2] row_mask:0xf bank_mask:0xf
    buffer_store_dwordx4 v[96:99], v7, s[8:11], s31 offen sc1
    buffer_store_dwordx4 v[100:103], v7, s[8:11], s32 offen sc1
    s_cmp_eq_u32 s22, 0
    s_cbranch_scc0 L_p2l1_3
    v_lshl_or_b32 v240, v248, 16, v240
    v_xor_b32 v240, v240, v225
    v_lshl_or_b32 v241, v249, 16, v241
    v_xor_b32 v241, v241, v225
    v_lshl_or_b32 v242, v250, 16, v242
    v_xor_b32 v242, v242, v225
    v_lshl_or_b32 v243, v251, 16, v243
    v_xor_b32 v243, v243, v225
    v_lshl_or_b32 v244, v252, 16, v244
    v_xor_b32 v244, v244, v225
    v_lshl_or_b32 v245, v253, 16, v245
    v_xor_b32 v245, v245, v225
    v_lshl_or_b32 v246, v254, 16, v246
    v_xor_b32 v246, v246, v225
    v_lshl_or_b32 v247, v255, 16, v247
    v_xor_b32 v247, v247, v225
    v_and_b32 v240, -2, v240
    v_and_b32 v244, -2, v244
    s_mov_b32 vcc_lo, 0x55555555
    s_mov_b32 vcc_hi, 0x55555555
    v_cndmask_b32_dpp v228, v244, v240, vcc quad_perm:[1,0,3,2] row_mask:0xf bank_mask:0xf
    v_cndmask_b32_dpp v229, v245, v241, vcc quad_perm:[1,0,3,2] row_mask:0xf bank_mask:0xf
    v_cndmask_b32_dpp v230, v246, v242, vcc quad_perm:[1,0,3,2] row_mask:0xf bank_mask:0xf
    v_cndmask_b32_dpp v231, v247, v243, vcc quad_perm:[1,0,3,2] row_mask:0xf bank_mask:0xf
    s_not_b64 vcc, vcc
    v_cndmask_b32_dpp v232, v240, v244, vcc quad_perm:[1,0,3,2] row_mask:0xf bank_mask:0xf
    v_cndmask_b32_dpp v233, v241, v245, vcc quad_perm:[1,0,3,2] row_mask:0xf bank_mask:0xf
    v_cndmask_b32_dpp v234, v242, v246, vcc quad_perm:[1,0,3,2] row_mask:0xf bank_mask:0xf
    v_cndmask_b32_dpp v235, v243, v247, vcc quad_perm:[1,0,3,2] row_mask:0xf bank_mask:0xf
    buffer_store_dwordx4 v[228:231], v135, s[8:11], s36 offen sc1
    buffer_store_dwordx4 v[232:235], v135, s[8:11], s37 offen sc1
    v_bfe_u32 v200, v0, 5, 1
    v_lshlrev_b32 v200, 3, v200
    v_bfe_u32 v201, v0, 2, 2
    v_add_u32 v200, v200, v201
    v_lshlrev_b32 v199, 9, v200
    v_bfe_u32 v200, v0, 4, 1
    v_lshl_add_u32 v199, v200, 5, v199
    v_and_b32 v200, 3, v0
    v_lshl_add_u32 v199, v200, 3, v199
    v_lshl_add_u32 v199, v3, 7, v199
    v_add_u32 v199, 8192, v199
    s_lshr_b32 s59, s52, 2
    s_mul_i32 s59, s59, 57344
    s_and_b32 s52, s52, 3
    s_lshl_b32 s53, s53, 2
    s_add_u32 s52, s52, s53
    s_lshl_b32 s52, s52, 11
    s_add_u32 s59, s59, s52
    s_and_b32 s51, s20, 1
    s_lshl_b32 s51, s51, 2
    s_add_u32 s51, s51, s21
    s_mul_i32 s51, s51, 229376
    s_add_u32 s59, s59, s51
    s_add_u32 s59, s59, 16777216
    s_cmp_ge_u32 s20, 224
    s_cselect_b32 s59, 0x7ff00000, s59
    ds_read_b64_tr_b16 v[184:185], v199 offset:0
    ds_read_b64_tr_b16 v[186:187], v199 offset:2048
    ds_read_b64_tr_b16 v[188:189], v199 offset:64
    ds_read_b64_tr_b16 v[190:191], v199 offset:2112
    s_waitcnt vmcnt(4)
    buffer_store_dwordx4 v[136:139], v6, s[8:11], s98 offen sc1
    buffer_store_dwordx4 v[140:143], v6, s[8:11], s99 offen sc1
    s_waitcnt lgkmcnt(2)
    buffer_store_dwordx4 v[184:187], v6, s[8:11], s59 offen offset:0 sc1
    s_waitcnt lgkmcnt(0)
    buffer_store_dwordx4 v[188:191], v6, s[8:11], s59 offen offset:1024 sc1
    s_mov_b32 s48, s40
    s_mul_i32 s40, s21, 35872
    v_accvgpr_read_b32 v250, a240
    v_lshrrev_b32 v176, 1, v0
    v_lshlrev_b32 v176, 13, v176
    v_and_b32 v9, 1, v0
    v_lshl_add_u32 v176, v9, 4, v176
    s_and_b32 s30, s20, 1
    s_lshl_b32 s30, s30, 12
    s_lshr_b32 s33, s20, 1
    s_lshl_b32 s33, s33, 5
    s_add_u32 s30, s30, s33
    s_lshl_b32 s33, s22, 21
    s_add_u32 s30, s30, s33
    s_add_u32 s33, s30, 1048576
    s_mov_b32 s28, 143488
    v_lshrrev_b32 v177, 1, v0
    v_lshlrev_b32 v177, 2, v177
    v_lshlrev_b32 v9, 4, v3
    v_xor_b32 v177, v177, v9
    v_and_b32 v9, 1, v0
    v_mul_u32_u24 v9, 4160, v9
    v_add3_u32 v177, v177, v9, s28
    v_lshlrev_b32 v178, 11, v3
    v_lshl_add_u32 v178, v1, 6, v178
    v_bfe_u32 v9, v1, 1, 2
    v_xor_b32 v9, v9, v2
    v_lshl_add_u32 v178, v9, 4, v178
    v_lshrrev_b32 v9, 1, v3
    v_lshlrev_b32 v9, 6, v9
    v_add3_u32 v178, v178, v9, s28
    v_mul_f32 v179, 4.0, v5
    s_mov_b32 s29, 0x36000000
    s_cmp_eq_u32 s20, 0
    s_cselect_b32 s29, 0x35800000, s29
    v_lshlrev_b32 v9, 1, v3
    v_lshl_add_u32 v9, v1, 3, v9
    v_cvt_f32_u32 v9, v9
    v_mul_f32 v9, 0x3c000000, v9
    v_mul_f32 v10, v9, v179
    v_mov_b32 v160, v10
    v_add_f32 v161, v9, v10
    v_fmamk_f32 v162, v9, 0x40000000, v10
    v_fmamk_f32 v163, v9, 0x40400000, v10
    v_mul_f32 v64, 0x3d800000, v160
    v_mul_f32 v65, 0x3d800000, v161
    v_mul_f32 v66, 0x3d800000, v162
    v_mul_f32 v67, 0x3d800000, v163
    v_sin_f32 v164, v160
    v_cos_f32 v160, v160
    v_sin_f32 v165, v161
    v_cos_f32 v161, v161
    v_sin_f32 v166, v162
    v_cos_f32 v162, v162
    v_sin_f32 v167, v163
    v_cos_f32 v163, v163
    v_sin_f32 v72, v64
    v_cos_f32 v64, v64
    v_sin_f32 v73, v65
    v_cos_f32 v65, v65
    v_sin_f32 v74, v66
    v_cos_f32 v66, v66
    v_sin_f32 v75, v67
    v_cos_f32 v67, v67
    v_cvt_pk_bf16_f32 v48, v160, v164
    v_cvt_pk_bf16_f32 v56, -v164, v160
    v_cvt_pk_bf16_f32 v49, v161, v165
    v_cvt_pk_bf16_f32 v57, -v165, v161
    v_cvt_pk_bf16_f32 v50, v162, v166
    v_cvt_pk_bf16_f32 v58, -v166, v162
    v_cvt_pk_bf16_f32 v51, v163, v167
    v_cvt_pk_bf16_f32 v59, -v167, v163
    v_lshlrev_b32 v9, 1, v3
    s_waitcnt vmcnt(0)
L_echk_6:
    v_cmp_eq_u32 vcc, 0, v216
    s_cbranch_vccz L_eok_7
    s_add_u32 s24, s24, 1
    s_cmp_gt_u32 s24, 1000000
    s_cbranch_scc1 L_eok_7
    buffer_load_dwordx2 v[216:217], off, s[16:19], 0 sc1
    s_waitcnt vmcnt(0)
    s_branch L_echk_6
L_eok_7:
    s_barrier
    buffer_store_dwordx4 v[216:219], v220, s[8:11], s34 offen sc1
    s_mov_b32 s16, s26
    s_mov_b32 s17, s27
    s_mov_b32 s18, 0x200000
    s_mov_b32 s19, 0x20000
    s_add_u32 m0, s40, 0
    s_mov_b32 s39, 0
    buffer_load_dwordx4 v250, s[60:63], s39 offen lds
    v_lshl_add_u32 v9, v1, 3, v9
    v_add_u32 v9, 1, v9
    v_cvt_f32_u32 v9, v9
    v_mul_f32 v9, 0x3c000000, v9
    v_mul_f32 v10, v9, v179
    v_mov_b32 v160, v10
    v_add_f32 v161, v9, v10
    v_fmamk_f32 v162, v9, 0x40000000, v10
    v_fmamk_f32 v163, v9, 0x40400000, v10
    s_add_u32 m0, s40, 1024
    s_mov_b32 s39, 57344
    buffer_load_dwordx4 v250, s[60:63], s39 offen lds
    v_mul_f32 v68, 0x3d800000, v160
    v_mul_f32 v69, 0x3d800000, v161
    v_mul_f32 v70, 0x3d800000, v162
    v_mul_f32 v71, 0x3d800000, v163
    v_sin_f32 v164, v160
    v_cos_f32 v160, v160
    v_sin_f32 v165, v161
    v_cos_f32 v161, v161
    v_sin_f32 v166, v162
    s_add_u32 m0, s40, 2048
    s_mov_b32 s39, 114688
    buffer_load_dwordx4 v250, s[60:63], s39 offen lds
    v_cos_f32 v162, v162
    v_sin_f32 v167, v163
    v_cos_f32 v163, v163
    v_sin_f32 v76, v68
    v_cos_f32 v68, v68
    v_sin_f32 v77, v69
    v_cos_f32 v69, v69
    v_sin_f32 v78, v70
    s_add_u32 m0, s40, 3072
    s_mov_b32 s39, 172032
    buffer_load_dwordx4 v250, s[60:63], s39 offen lds
    v_cos_f32 v70, v70
    v_sin_f32 v79, v71
    v_cos_f32 v71, v71
    v_cvt_pk_bf16_f32 v52, v160, v164
    v_cvt_pk_bf16_f32 v60, -v164, v160
    v_cvt_pk_bf16_f32 v53, v161, v165
    v_cvt_pk_bf16_f32 v61, -v165, v161
    v_cvt_pk_bf16_f32 v54, v162, v166
    v_cvt_pk_bf16_f32 v62, -v166, v162
    s_add_u32 m0, s40, 4096
    s_mov_b32 s39, 229376
    buffer_load_dwordx4 v250, s[60:63], s39 offen lds
    v_cvt_pk_bf16_f32 v55, v163, v167
    v_cvt_pk_bf16_f32 v63, -v167, v163
    v_mul_f32 v9, 0x3d800000, v4
    v_mul_f32 v10, v9, v179
    v_mov_b32 v160, v10
    v_add_f32 v161, v9, v10
    v_fmamk_f32 v162, v9, 0x40000000, v10
    v_fmamk_f32 v163, v9, 0x40400000, v10
    v_sin_f32 v164, v160
    s_add_u32 m0, s40, 5120
    s_mov_b32 s39, 286720
    buffer_load_dwordx4 v250, s[60:63], s39 offen lds
    v_cos_f32 v160, v160
    v_sin_f32 v165, v161
    v_cos_f32 v161, v161
    v_sin_f32 v166, v162
    v_cos_f32 v162, v162
    v_sin_f32 v167, v163
    v_cos_f32 v163, v163
    v_nop
    s_add_u32 m0, s40, 6144
    s_mov_b32 s39, 344064
    buffer_load_dwordx4 v250, s[60:63], s39 offen lds
    v_cvt_pk_bf16_f32 v80, v160, v164
    v_cvt_pk_bf16_f32 v84, -v164, v160
    v_cvt_pk_bf16_f32 v88, v160, -v164
    v_cvt_pk_bf16_f32 v92, v164, v160
    v_cvt_pk_bf16_f32 v81, v161, v165
    v_cvt_pk_bf16_f32 v85, -v165, v161
    v_cvt_pk_bf16_f32 v89, v161, -v165
    v_cvt_pk_bf16_f32 v93, v165, v161
    v_cvt_pk_bf16_f32 v82, v162, v166
    s_add_u32 m0, s40, 7168
    s_mov_b32 s39, 401408
    buffer_load_dwordx4 v250, s[60:63], s39 offen lds
    v_cvt_pk_bf16_f32 v86, -v166, v162
    v_cvt_pk_bf16_f32 v90, v162, -v166
    v_cvt_pk_bf16_f32 v94, v166, v162
    v_cvt_pk_bf16_f32 v83, v163, v167
    v_cvt_pk_bf16_f32 v87, -v167, v163
    v_cvt_pk_bf16_f32 v91, v163, -v167
    v_cvt_pk_bf16_f32 v95, v167, v163
    v_lshlrev_b32 v11, 1, v3
    v_lshl_add_u32 v11, v2, 5, v11
    s_add_u32 m0, s40, 8192
    s_mov_b32 s39, 458752
    buffer_load_dwordx4 v250, s[60:63], s39 offen lds
    v_cvt_f32_u32 v11, v11
    v_mul_f32 v11, v11, v4
    v_mul_f32 v11, 0x3c000000, v11
    v_mov_b32 v160, v11
    v_add_f32 v161, v9, v11
    v_fmamk_f32 v162, v9, 0x40000000, v11
    v_fmamk_f32 v163, v9, 0x40400000, v11
    v_mul_f32 v96, 0x3d800000, v160
    s_add_u32 m0, s40, 9216
    s_mov_b32 s39, 516096
    buffer_load_dwordx4 v250, s[60:63], s39 offen lds
    v_mul_f32 v97, 0x3d800000, v161
    v_mul_f32 v98, 0x3d800000, v162
    v_mul_f32 v99, 0x3d800000, v163
    v_sin_f32 v164, v160
    v_cos_f32 v160, v160
    v_sin_f32 v165, v161
    v_cos_f32 v161, v161
    v_sin_f32 v166, v162
    v_cos_f32 v162, v162
    s_add_u32 m0, s40, 10240
    s_mov_b32 s39, 573440
    buffer_load_dwordx4 v250, s[60:63], s39 offen lds
    v_sin_f32 v167, v163
    v_cos_f32 v163, v163
    v_sin_f32 v104, v96
    v_cos_f32 v96, v96
    v_sin_f32 v105, v97
    v_cos_f32 v97, v97
    v_sin_f32 v106, v98
    v_cos_f32 v98, v98
    v_sin_f32 v107, v99
    s_add_u32 m0, s40, 11264
    s_mov_b32 s39, 630784
    buffer_load_dwordx4 v250, s[60:63], s39 offen lds
    v_cos_f32 v99, v99
    v_cvt_pk_bf16_f32 v112, v160, -v164
    v_cvt_pk_bf16_f32 v120, v164, v160
    v_cvt_pk_bf16_f32 v113, v161, -v165
    v_cvt_pk_bf16_f32 v121, v165, v161
    v_cvt_pk_bf16_f32 v114, v162, -v166
    v_cvt_pk_bf16_f32 v122, v166, v162
    v_cvt_pk_bf16_f32 v115, v163, -v167
    buffer_load_dwordx2 v[222:223], v224, s[8:11], s35 offen sc1
    v_cvt_pk_bf16_f32 v123, v167, v163
    v_mul_f32 v96, s29, v96
    v_mul_f32 v104, s29, v104
    v_mul_f32 v97, s29, v97
    v_mul_f32 v105, s29, v105
    v_mul_f32 v98, s29, v98
    v_mul_f32 v106, s29, v106
    v_mul_f32 v99, s29, v99
    v_mul_f32 v107, s29, v107
    v_lshlrev_b32 v11, 1, v3
    v_lshl_add_u32 v11, v2, 5, v11
    v_add_u32 v11, 1, v11
    v_cvt_f32_u32 v11, v11
    v_mul_f32 v11, v11, v4
    v_mul_f32 v11, 0x3c000000, v11
    v_mov_b32 v160, v11
    v_add_f32 v161, v9, v11
    v_fmamk_f32 v162, v9, 0x40000000, v11
    v_fmamk_f32 v163, v9, 0x40400000, v11
    v_mul_f32 v100, 0x3d800000, v160
    v_mul_f32 v101, 0x3d800000, v161
    v_mul_f32 v102, 0x3d800000, v162
    v_mul_f32 v103, 0x3d800000, v163
    v_sin_f32 v164, v160
    v_cos_f32 v160, v160
    v_sin_f32 v165, v161
    v_cos_f32 v161, v161
    v_sin_f32 v166, v162
    v_cos_f32 v162, v162
    v_sin_f32 v167, v163
    v_cos_f32 v163, v163
    v_sin_f32 v108, v100
    v_cos_f32 v100, v100
    v_sin_f32 v109, v101
    v_cos_f32 v101, v101
    v_sin_f32 v110, v102
    v_cos_f32 v102, v102
    v_sin_f32 v111, v103
    v_cos_f32 v103, v103
    v_cvt_pk_bf16_f32 v116, v160, -v164
    v_cvt_pk_bf16_f32 v124, v164, v160
    v_cvt_pk_bf16_f32 v117, v161, -v165
    v_cvt_pk_bf16_f32 v125, v165, v161
    v_cvt_pk_bf16_f32 v118, v162, -v166
    v_cvt_pk_bf16_f32 v126, v166, v162
    v_cvt_pk_bf16_f32 v119, v163, -v167
    v_cvt_pk_bf16_f32 v127, v167, v163
    v_mul_f32 v100, s29, v100
    v_mul_f32 v108, s29, v108
    v_mul_f32 v101, s29, v101
    v_mul_f32 v109, s29, v109
    v_mul_f32 v102, s29, v102
    v_mul_f32 v110, s29, v110
    v_mul_f32 v103, s29, v103
    v_mul_f32 v111, s29, v111
    s_lshl_b32 s31, s20, 13
    s_add_u32 s31, s31, 4194304
    s_add_u32 s32, s31, 4096
    v_lshrrev_b32 v200, 1, v0
    v_lshlrev_b32 v200, 14, v200
    v_and_b32 v201, 1, v0
    v_lshl_add_u32 v200, v201, 4, v200
    s_add_u32 s52, s30, 2097152
    s_add_u32 s53, s52, 8192
    s_waitcnt vmcnt(0)
L_fchk_8:
    v_cmp_ne_u64 vcc, v[222:223], v[216:217]
    s_cbranch_vccz L_fok_9
    s_add_u32 s24, s24, 1
    s_cmp_gt_u32 s24, 1000000
    s_cbranch_scc1 L_fok_9
    s_mov_b64 exec, vcc
    buffer_load_dwordx2 v[222:223], v224, s[8:11], s35 offen sc1
    s_mov_b64 exec, -1
    s_waitcnt vmcnt(0)
    s_branch L_fchk_8
L_fok_9:
    buffer_load_dwordx4 v[16:19], v176, s[8:11], s30 offen sc1
    buffer_load_dwordx4 v[20:23], v176, s[8:11], s33 offen sc1
    v_and_b32 v9, 3, v0
    v_mul_u32_u24 v9, 7, v9
    v_lshrrev_b32 v9, v9, v216
    v_and_b32 v9, 0xfe, v9
    v_lshl_or_b32 v9, v9, 14, v9
    v_lshrrev_b32 v10, 0, v9
    v_and_b32 v10, 0x30003, v10
    v_accvgpr_write_b32 a244, v10
    v_lshrrev_b32 v10, 4, v9
    v_and_b32 v10, 0x30003, v10
    v_accvgpr_write_b32 a245, v10
    s_mov_b32 s92, 0x30003
    s_barrier
    buffer_load_dwordx4 v[228:231], v200, s[8:11], s52 offen sc1
    buffer_load_dwordx4 v[232:235], v200, s[8:11], s53 offen sc1
    s_mov_b32 s38, s97
    s_and_b32 s23, s20, 7
    s_mul_i32 s23, s23, 229376
    s_mul_i32 s28, s21, 57344
    s_add_u32 s23, s23, s28
    s_add_u32 s23, s23, 16777216
    s_add_u32 s42, s23, 0
    s_add_u32 s43, s23, 2048
    s_add_u32 s49, s23, 4096
    s_add_u32 s51, s23, 6144
    s_waitcnt vmcnt(2)
    s_branch L_p2j_4
L_p2l1_3:
    s_add_u32 m0, s40, 4096
    s_mov_b32 s39, 229376
    buffer_load_dwordx4 v250, s[60:63], s39 offen lds
    v_lshrrev_b32 v176, 1, v0
    v_lshlrev_b32 v176, 13, v176
    v_and_b32 v9, 1, v0
    v_lshl_add_u32 v176, v9, 4, v176
    s_and_b32 s30, s20, 1
    s_lshl_b32 s30, s30, 12
    s_lshr_b32 s33, s20, 1
    s_lshl_b32 s33, s33, 5
    s_add_u32 s30, s30, s33
    s_lshl_b32 s33, s22, 21
    s_add_u32 s30, s30, s33
    s_add_u32 s33, s30, 1048576
    s_mov_b32 s28, 143488
    v_lshrrev_b32 v177, 1, v0
    v_lshlrev_b32 v177, 2, v177
    v_lshlrev_b32 v9, 4, v3
    v_xor_b32 v177, v177, v9
    v_and_b32 v9, 1, v0
    s_add_u32 m0, s40, 5120
    s_mov_b32 s39, 286720
    buffer_load_dwordx4 v250, s[60:63], s39 offen lds
    v_mul_u32_u24 v9, 4160, v9
    v_add3_u32 v177, v177, v9, s28
    v_lshlrev_b32 v178, 11, v3
    v_lshl_add_u32 v178, v1, 6, v178
    v_bfe_u32 v9, v1, 1, 2
    v_xor_b32 v9, v9, v2
    v_lshl_add_u32 v178, v9, 4, v178
    v_lshrrev_b32 v9, 1, v3
    v_lshlrev_b32 v9, 6, v9
    v_add3_u32 v178, v178, v9, s28
    v_mul_f32 v179, 4.0, v5
    s_mov_b32 s29, 0x36000000
    s_cmp_eq_u32 s20, 0
    s_cselect_b32 s29, 0x35800000, s29
    v_lshlrev_b32 v9, 1, v3
    v_lshl_add_u32 v9, v1, 3, v9
    v_cvt_f32_u32 v9, v9
    v_mul_f32 v9, 0x3c000000, v9
    s_add_u32 m0, s40, 6144
    s_mov_b32 s39, 344064
    buffer_load_dwordx4 v250, s[60:63], s39 offen lds
    v_mul_f32 v10, v9, v179
    v_mov_b32 v160, v10
    v_add_f32 v161, v9, v10
    v_fmamk_f32 v162, v9, 0x40000000, v10
    v_fmamk_f32 v163, v9, 0x40400000, v10
    v_mul_f32 v64, 0x3d800000, v160
    v_mul_f32 v65, 0x3d800000, v161
    v_mul_f32 v66, 0x3d800000, v162
    v_mul_f32 v67, 0x3d800000, v163
    v_sin_f32 v164, v160
    v_cos_f32 v160, v160
    v_sin_f32 v165, v161
    v_cos_f32 v161, v161
    v_sin_f32 v166, v162
    v_cos_f32 v162, v162
    v_sin_f32 v167, v163
    v_cos_f32 v163, v163
    s_add_u32 m0, s40, 7168
    s_mov_b32 s39, 401408
    buffer_load_dwordx4 v250, s[60:63], s39 offen lds
    v_sin_f32 v72, v64
    v_cos_f32 v64, v64
    v_sin_f32 v73, v65
    v_cos_f32 v65, v65
    v_sin_f32 v74, v66
    v_cos_f32 v66, v66
    v_sin_f32 v75, v67
    v_cos_f32 v67, v67
    v_cvt_pk_bf16_f32 v48, v160, v164
    v_cvt_pk_bf16_f32 v56, -v164, v160
    v_cvt_pk_bf16_f32 v49, v161, v165
    v_cvt_pk_bf16_f32 v57, -v165, v161
    v_cvt_pk_bf16_f32 v50, v162, v166
    v_cvt_pk_bf16_f32 v58, -v166, v162
    v_cvt_pk_bf16_f32 v51, v163, v167
    v_cvt_pk_bf16_f32 v59, -v167, v163
    v_lshlrev_b32 v9, 1, v3
    v_lshl_add_u32 v9, v1, 3, v9
    v_add_u32 v9, 1, v9
    v_cvt_f32_u32 v9, v9
    v_mul_f32 v9, 0x3c000000, v9
    v_mul_f32 v10, v9, v179
    v_mov_b32 v160, v10
    v_add_f32 v161, v9, v10
    v_fmamk_f32 v162, v9, 0x40000000, v10
    v_fmamk_f32 v163, v9, 0x40400000, v10
    v_mul_f32 v68, 0x3d800000, v160
    v_mul_f32 v69, 0x3d800000, v161
    v_mul_f32 v70, 0x3d800000, v162
    v_mul_f32 v71, 0x3d800000, v163
    v_sin_f32 v164, v160
    v_cos_f32 v160, v160
    v_sin_f32 v165, v161
    v_cos_f32 v161, v161
    v_sin_f32 v166, v162
    v_cos_f32 v162, v162
    v_sin_f32 v167, v163
    v_cos_f32 v163, v163
    v_sin_f32 v76, v68
    v_cos_f32 v68, v68
    v_sin_f32 v77, v69
    v_cos_f32 v69, v69
    v_sin_f32 v78, v70
    v_cos_f32 v70, v70
    v_sin_f32 v79, v71
    v_cos_f32 v71, v71
    v_cvt_pk_bf16_f32 v52, v160, v164
    v_cvt_pk_bf16_f32 v60, -v164, v160
    v_cvt_pk_bf16_f32 v53, v161, v165
    v_cvt_pk_bf16_f32 v61, -v165, v161
    v_cvt_pk_bf16_f32 v54, v162, v166
    v_cvt_pk_bf16_f32 v62, -v166, v162
    v_cvt_pk_bf16_f32 v55, v163, v167
    v_cvt_pk_bf16_f32 v63, -v167, v163
    v_mul_f32 v9, 0x3d800000, v4
    v_mul_f32 v10, v9, v179
    v_mov_b32 v160, v10
    v_add_f32 v161, v9, v10
    v_fmamk_f32 v162, v9, 0x40000000, v10
    v_fmamk_f32 v163, v9, 0x40400000, v10
    v_sin_f32 v164, v160
    v_cos_f32 v160, v160
    v_sin_f32 v165, v161
    v_cos_f32 v161, v161
    v_sin_f32 v166, v162
    v_cos_f32 v162, v162
    v_sin_f32 v167, v163
    v_cos_f32 v163, v163
    v_nop
    v_cvt_pk_bf16_f32 v80, v160, v164
    v_cvt_pk_bf16_f32 v84, -v164, v160
    v_cvt_pk_bf16_f32 v88, v160, -v164
    v_cvt_pk_bf16_f32 v92, v164, v160
    v_cvt_pk_bf16_f32 v81, v161, v165
    v_cvt_pk_bf16_f32 v85, -v165, v161
    v_cvt_pk_bf16_f32 v89, v161, -v165
    v_cvt_pk_bf16_f32 v93, v165, v161
    v_cvt_pk_bf16_f32 v82, v162, v166
    v_cvt_pk_bf16_f32 v86, -v166, v162
    v_cvt_pk_bf16_f32 v90, v162, -v166
    v_cvt_pk_bf16_f32 v94, v166, v162
    v_cvt_pk_bf16_f32 v83, v163, v167
    v_cvt_pk_bf16_f32 v87, -v167, v163
    v_cvt_pk_bf16_f32 v91, v163, -v167
    v_cvt_pk_bf16_f32 v95, v167, v163
    v_lshlrev_b32 v11, 1, v3
    buffer_load_dwordx4 v[16:19], v176, s[8:11], s30 offen sc1
    buffer_load_dwordx4 v[20:23], v176, s[8:11], s33 offen sc1
    v_lshl_add_u32 v11, v2, 5, v11
    v_cvt_f32_u32 v11, v11
    v_mul_f32 v11, v11, v4
    v_mul_f32 v11, 0x3c000000, v11
    v_mov_b32 v160, v11
    v_add_f32 v161, v9, v11
    v_fmamk_f32 v162, v9, 0x40000000, v11
    v_fmamk_f32 v163, v9, 0x40400000, v11
    v_mul_f32 v96, 0x3d800000, v160
    v_mul_f32 v97, 0x3d800000, v161
    v_mul_f32 v98, 0x3d800000, v162
    v_mul_f32 v99, 0x3d800000, v163
    v_sin_f32 v164, v160
    v_cos_f32 v160, v160
    v_sin_f32 v165, v161
    v_cos_f32 v161, v161
    v_sin_f32 v166, v162
    v_cos_f32 v162, v162
    v_sin_f32 v167, v163
    v_cos_f32 v163, v163
    v_sin_f32 v104, v96
    v_cos_f32 v96, v96
    v_sin_f32 v105, v97
    v_cos_f32 v97, v97
    v_sin_f32 v106, v98
    v_cos_f32 v98, v98
    v_sin_f32 v107, v99
    v_cos_f32 v99, v99
    v_cvt_pk_bf16_f32 v112, v160, -v164
    v_cvt_pk_bf16_f32 v120, v164, v160
    v_cvt_pk_bf16_f32 v113, v161, -v165
    v_cvt_pk_bf16_f32 v121, v165, v161
    v_cvt_pk_bf16_f32 v114, v162, -v166
    v_cvt_pk_bf16_f32 v122, v166, v162
    v_cvt_pk_bf16_f32 v115, v163, -v167
    v_cvt_pk_bf16_f32 v123, v167, v163
    v_mul_f32 v96, s29, v96
    v_mul_f32 v104, s29, v104
    v_mul_f32 v97, s29, v97
    v_mul_f32 v105, s29, v105
    v_mul_f32 v98, s29, v98
    v_mul_f32 v106, s29, v106
    v_mul_f32 v99, s29, v99
    v_mul_f32 v107, s29, v107
    v_lshlrev_b32 v11, 1, v3
    v_lshl_add_u32 v11, v2, 5, v11
    v_add_u32 v11, 1, v11
    v_cvt_f32_u32 v11, v11
    v_mul_f32 v11, v11, v4
    v_mul_f32 v11, 0x3c000000, v11
    v_mov_b32 v160, v11
    v_add_f32 v161, v9, v11
    v_fmamk_f32 v162, v9, 0x40000000, v11
    v_fmamk_f32 v163, v9, 0x40400000, v11
    v_mul_f32 v100, 0x3d800000, v160
    v_mul_f32 v101, 0x3d800000, v161
    v_mul_f32 v102, 0x3d800000, v162
    v_mul_f32 v103, 0x3d800000, v163
    v_sin_f32 v164, v160
    v_cos_f32 v160, v160
    v_sin_f32 v165, v161
    v_cos_f32 v161, v161
    v_sin_f32 v166, v162
    v_cos_f32 v162, v162
    v_sin_f32 v167, v163
    v_cos_f32 v163, v163
    v_sin_f32 v108, v100
    v_cos_f32 v100, v100
    v_sin_f32 v109, v101
    v_cos_f32 v101, v101
    v_sin_f32 v110, v102
    v_cos_f32 v102, v102
    v_sin_f32 v111, v103
    v_cos_f32 v103, v103
    v_cvt_pk_bf16_f32 v116, v160, -v164
    v_cvt_pk_bf16_f32 v124, v164, v160
    v_cvt_pk_bf16_f32 v117, v161, -v165
    v_cvt_pk_bf16_f32 v125, v165, v161
    v_cvt_pk_bf16_f32 v118, v162, -v166
    v_cvt_pk_bf16_f32 v126, v166, v162
    v_cvt_pk_bf16_f32 v119, v163, -v167
    v_cvt_pk_bf16_f32 v127, v167, v163
    v_mul_f32 v100, s29, v100
    v_mul_f32 v108, s29, v108
    v_mul_f32 v101, s29, v101
    v_mul_f32 v109, s29, v109
    v_mul_f32 v102, s29, v102
    v_mul_f32 v110, s29, v110
    v_mul_f32 v103, s29, v103
    v_mul_f32 v111, s29, v111
    s_lshl_b32 s31, s20, 13
    s_add_u32 s31, s31, 4194304
    s_add_u32 s32, s31, 4096
    v_accvgpr_read_b32 v40, a224
    v_accvgpr_read_b32 v41, a225
    v_accvgpr_read_b32 v42, a226
    v_accvgpr_read_b32 v43, a227
    v_accvgpr_read_b32 v44, a228
    v_accvgpr_read_b32 v45, a229
    v_accvgpr_read_b32 v46, a230
    v_accvgpr_read_b32 v47, a231
    v_lshlrev_b32 v32, 16, v40
    v_and_b32 v40, 0xffff0000, v40
    v_lshlrev_b32 v33, 16, v41
    v_and_b32 v41, 0xffff0000, v41
    v_lshlrev_b32 v34, 16, v42
    v_and_b32 v42, 0xffff0000, v42
    v_lshlrev_b32 v35, 16, v43
    v_and_b32 v43, 0xffff0000, v43
    v_lshlrev_b32 v36, 16, v44
    v_and_b32 v44, 0xffff0000, v44
    v_lshlrev_b32 v37, 16, v45
    v_and_b32 v45, 0xffff0000, v45
    v_lshlrev_b32 v38, 16, v46
    v_and_b32 v46, 0xffff0000, v46
    v_lshlrev_b32 v39, 16, v47
    v_and_b32 v47, 0xffff0000, v47
    s_waitcnt vmcnt(0)
    v_bitop3_b32 v9, v16, v20, s22 bitop3:0x7e
    v_and_b32 v9, 1, v9
    v_cmp_ne_u32 vcc, 0, v9
    s_cbranch_vccnz L_rt_10
L_ok_11:
L_p2j_4:
    ds_write2st64_b32 v177, v16, v17 offset0:0 offset1:4
    ds_write2st64_b32 v177, v18, v19 offset0:8 offset1:12
    ds_write2st64_b32 v177, v20, v21 offset0:2 offset1:6
    ds_write2st64_b32 v177, v22, v23 offset0:10 offset1:14
    v_accvgpr_read_b32 v250, a240
    s_waitcnt lgkmcnt(0)
    s_barrier
    ds_read_b128 v[24:27], v178 offset:0
    ds_read_b128 v[28:31], v178 offset:1024
    s_waitcnt lgkmcnt(1)
    v_mfma_f32_16x16x32_bf16 v[128:131], v[24:27], v[48:51], 0
    v_mfma_f32_16x16x32_bf16 v[136:139], v[24:27], v[56:59], 0
    s_waitcnt lgkmcnt(0)
    v_mfma_f32_16x16x32_bf16 v[132:135], v[28:31], v[52:55], 0
    v_mfma_f32_16x16x32_bf16 v[140:143], v[28:31], v[60:63], 0
    s_nop 3
    v_pk_mul_f32 v[144:145], v[128:129], v[64:65]
    v_pk_mul_f32 v[152:153], v[136:137], v[64:65]
    v_pk_mul_f32 v[146:147], v[130:131], v[66:67]
    v_pk_mul_f32 v[154:155], v[138:139], v[66:67]
    v_pk_fma_f32 v[144:145], v[136:137], v[72:73], v[144:145]
    v_pk_fma_f32 v[152:153], v[128:129], v[72:73], v[152:153] neg_lo:[1,0,0] neg_hi:[1,0,0]
    v_pk_fma_f32 v[146:147], v[138:139], v[74:75], v[146:147]
    v_pk_fma_f32 v[154:155], v[130:131], v[74:75], v[154:155] neg_lo:[1,0,0] neg_hi:[1,0,0]
    v_cvt_pk_bf16_f32 v24, v144, v152
    v_cvt_pk_bf16_f32 v25, v145, v153
    v_cvt_pk_bf16_f32 v26, v146, v154
    v_cvt_pk_bf16_f32 v27, v147, v155
    s_nop 1
    v_mfma_f32_16x16x32_bf16 v[128:131], v[80:83], v[24:27], 0
    v_mfma_f32_16x16x32_bf16 v[136:139], v[84:87], v[24:27], 0
    v_pk_mul_f32 v[148:149], v[132:133], v[68:69]
    v_pk_mul_f32 v[156:157], v[140:141], v[68:69]
    v_pk_mul_f32 v[150:151], v[134:135], v[70:71]
    v_pk_mul_f32 v[158:159], v[142:143], v[70:71]
    v_pk_fma_f32 v[148:149], v[140:141], v[76:77], v[148:149]
    v_pk_fma_f32 v[156:157], v[132:133], v[76:77], v[156:157] neg_lo:[1,0,0] neg_hi:[1,0,0]
    v_pk_fma_f32 v[150:151], v[142:143], v[78:79], v[150:151]
    v_pk_fma_f32 v[158:159], v[134:135], v[78:79], v[158:159] neg_lo:[1,0,0] neg_hi:[1,0,0]
    v_cvt_pk_bf16_f32 v28, v148, v156
    v_cvt_pk_bf16_f32 v29, v149, v157
    v_cvt_pk_bf16_f32 v30, v150, v158
    v_cvt_pk_bf16_f32 v31, v151, v159
    s_nop 1
    v_mfma_f32_16x16x32_bf16 v[132:135], v[80:83], v[28:31], 0
    v_mfma_f32_16x16x32_bf16 v[140:143], v[84:87], v[28:31], 0
    s_cmp_eq_u32 s22, 0
    s_cbranch_scc0 L_p2k_5
    s_waitcnt vmcnt(0)
    buffer_load_dwordx4 a[248:251], v6, s[60:63], s48 offen offset:0
    s_mov_b32 vcc_lo, 0x55555555
    s_mov_b32 vcc_hi, 0x55555555
    v_cndmask_b32_dpp v240, v232, v228, vcc quad_perm:[1,0,3,2] row_mask:0xf bank_mask:0xf
    v_cndmask_b32_dpp v241, v233, v229, vcc quad_perm:[1,0,3,2] row_mask:0xf bank_mask:0xf
    v_cndmask_b32_dpp v242, v234, v230, vcc quad_perm:[1,0,3,2] row_mask:0xf bank_mask:0xf
    v_cndmask_b32_dpp v243, v235, v231, vcc quad_perm:[1,0,3,2] row_mask:0xf bank_mask:0xf
    s_not_b64 vcc, vcc
    v_cndmask_b32_dpp v244, v228, v232, vcc quad_perm:[1,0,3,2] row_mask:0xf bank_mask:0xf
    v_cndmask_b32_dpp v245, v229, v233, vcc quad_perm:[1,0,3,2] row_mask:0xf bank_mask:0xf
    v_cndmask_b32_dpp v246, v230, v234, vcc quad_perm:[1,0,3,2] row_mask:0xf bank_mask:0xf
    v_cndmask_b32_dpp v247, v231, v235, vcc quad_perm:[1,0,3,2] row_mask:0xf bank_mask:0xf
    v_lshlrev_b32 v32, 16, v240
    v_and_b32 v40, 0xffff0000, v240
    v_lshlrev_b32 v33, 16, v241
    v_and_b32 v41, 0xffff0000, v241
    v_lshlrev_b32 v34, 16, v242
    v_and_b32 v42, 0xffff0000, v242
    v_lshlrev_b32 v35, 16, v243
    buffer_load_dwordx4 a[248:251], v6, s[60:63], s48 offen offset:1024
    v_and_b32 v43, 0xffff0000, v243
    v_lshlrev_b32 v36, 16, v244
    v_and_b32 v44, 0xffff0000, v244
    v_lshlrev_b32 v37, 16, v245
    v_and_b32 v45, 0xffff0000, v245
    v_lshlrev_b32 v38, 16, v246
    v_and_b32 v46, 0xffff0000, v246
    v_lshlrev_b32 v39, 16, v247
    v_and_b32 v47, 0xffff0000, v247
    v_accvgpr_write_b32 a224, v240
    v_accvgpr_write_b32 a225, v241
    v_accvgpr_write_b32 a226, v242
    v_accvgpr_write_b32 a227, v243
    v_accvgpr_write_b32 a228, v244
    v_accvgpr_write_b32 a229, v245
    v_accvgpr_write_b32 a230, v246
    v_accvgpr_write_b32 a231, v247
L_p2k_5:
    s_cmp_eq_u32 s22, 0
    s_cbranch_scc0 L_l0_12
    s_add_u32 m0, s40, 24576
    s_add_u32 s39, s38, 0
    buffer_load_dwordx4 v6, s[8:11], s39 offen sc1 lds
    s_add_u32 m0, s40, 25600
    s_add_u32 s39, s38, 4096
    buffer_load_dwordx4 v6, s[8:11], s39 offen sc1 lds
L_l0_12:
    v_pk_mul_f32 v[144:145], v[128:129], v[32:33]
    v_pk_mul_f32 v[152:153], v[136:137], v[32:33]
    v_pk_mul_f32 v[146:147], v[130:131], v[34:35]
    v_pk_mul_f32 v[154:155], v[138:139], v[34:35]
    v_pk_fma_f32 v[144:145], v[136:137], v[40:41], v[144:145] neg_lo:[1,0,0] neg_hi:[1,0,0]
    v_pk_fma_f32 v[152:153], v[128:129], v[40:41], v[152:153]
    v_pk_fma_f32 v[146:147], v[138:139], v[42:43], v[146:147] neg_lo:[1,0,0] neg_hi:[1,0,0]
    v_pk_fma_f32 v[154:155], v[130:131], v[42:43], v[154:155]
    v_cvt_pk_bf16_f32 v24, v144, v152
    v_cvt_pk_bf16_f32 v25, v145, v153
    v_cvt_pk_bf16_f32 v26, v146, v154
    v_cvt_pk_bf16_f32 v27, v147, v155
    s_nop 1
    v_mfma_f32_16x16x32_bf16 v[128:131], v[24:27], v[88:91], 0
    v_mfma_f32_16x16x32_bf16 v[136:139], v[24:27], v[92:95], 0
    v_pk_mul_f32 v[148:149], v[132:133], v[36:37]
    v_pk_mul_f32 v[156:157], v[140:141], v[36:37]
    v_pk_mul_f32 v[150:151], v[134:135], v[38:39]
    v_pk_mul_f32 v[158:159], v[142:143], v[38:39]
    v_pk_fma_f32 v[148:149], v[140:141], v[44:45], v[148:149] neg_lo:[1,0,0] neg_hi:[1,0,0]
    v_pk_fma_f32 v[156:157], v[132:133], v[44:45], v[156:157]
    v_pk_fma_f32 v[150:151], v[142:143], v[46:47], v[150:151] neg_lo:[1,0,0] neg_hi:[1,0,0]
    v_pk_fma_f32 v[158:159], v[134:135], v[46:47], v[158:159]
    v_cvt_pk_bf16_f32 v28, v148, v156
    v_cvt_pk_bf16_f32 v29, v149, v157
    v_cvt_pk_bf16_f32 v30, v150, v158
    v_cvt_pk_bf16_f32 v31, v151, v159
    s_nop 1
    v_mfma_f32_16x16x32_bf16 v[132:135], v[28:31], v[88:91], 0
    v_mfma_f32_16x16x32_bf16 v[140:143], v[28:31], v[92:95], 0
    s_cmp_eq_u32 s22, 0
    s_cbranch_scc0 L_l0_13
    s_add_u32 m0, s40, 26624
    s_add_u32 s39, s38, 8192
    buffer_load_dwordx4 v6, s[8:11], s39 offen sc1 lds
L_l0_13:
    v_pk_mul_f32 v[144:145], v[128:129], v[96:97]
    v_pk_mul_f32 v[152:153], v[136:137], v[96:97]
    v_pk_mul_f32 v[146:147], v[130:131], v[98:99]
    v_pk_mul_f32 v[154:155], v[138:139], v[98:99]
    v_pk_fma_f32 v[144:145], v[136:137], v[104:105], v[144:145] neg_lo:[1,0,0] neg_hi:[1,0,0]
    v_pk_fma_f32 v[152:153], v[128:129], v[104:105], v[152:153]
    v_pk_fma_f32 v[146:147], v[138:139], v[106:107], v[146:147] neg_lo:[1,0,0] neg_hi:[1,0,0]
    v_pk_fma_f32 v[154:155], v[130:131], v[106:107], v[154:155]
    v_cvt_pk_bf16_f32 v24, v144, v152
    v_cvt_pk_bf16_f32 v25, v145, v153
    v_cvt_pk_bf16_f32 v26, v146, v154
    v_cvt_pk_bf16_f32 v27, v147, v155
    s_nop 1
    v_mfma_f32_16x16x32_bf16 v[128:131], v[112:115], v[24:27], 0
    v_mfma_f32_16x16x32_bf16 v[136:139], v[120:123], v[24:27], 0
    v_pk_mul_f32 v[148:149], v[132:133], v[100:101]
    v_pk_mul_f32 v[156:157], v[140:141], v[100:101]
    v_pk_mul_f32 v[150:151], v[134:135], v[102:103]
    v_pk_mul_f32 v[158:159], v[142:143], v[102:103]
    v_pk_fma_f32 v[148:149], v[140:141], v[108:109], v[148:149] neg_lo:[1,0,0] neg_hi:[1,0,0]
    v_pk_fma_f32 v[156:157], v[132:133], v[108:109], v[156:157]
    v_pk_fma_f32 v[150:151], v[142:143], v[110:111], v[150:151] neg_lo:[1,0,0] neg_hi:[1,0,0]
    v_pk_fma_f32 v[158:159], v[134:135], v[110:111], v[158:159]
    v_cvt_pk_bf16_f32 v28, v148, v156
    v_cvt_pk_bf16_f32 v29, v149, v157
    v_cvt_pk_bf16_f32 v30, v150, v158
    v_cvt_pk_bf16_f32 v31, v151, v159
    s_nop 1
    v_mfma_f32_16x16x32_bf16 v[132:135], v[116:119], v[28:31], 0
    v_mfma_f32_16x16x32_bf16 v[140:143], v[124:127], v[28:31], 0
    v_cvt_pk_bf16_f32 v168, v128, v136
    v_cvt_pk_bf16_f32 v169, v129, v137
    v_cvt_pk_bf16_f32 v170, v130, v138
    v_cvt_pk_bf16_f32 v171, v131, v139
    ds_write_b128 v178, v[168:171] offset:0
    s_nop 2
    v_cvt_pk_bf16_f32 v172, v132, v140
    v_cvt_pk_bf16_f32 v173, v133, v141
    v_cvt_pk_bf16_f32 v174, v134, v142
    v_cvt_pk_bf16_f32 v175, v135, v143
    ds_write_b128 v178, v[172:175] offset:1024
    s_waitcnt lgkmcnt(0)
    s_barrier
    ds_read2st64_b32 v[16:17], v177 offset0:0 offset1:4
    ds_read2st64_b32 v[18:19], v177 offset0:8 offset1:12
    ds_read2st64_b32 v[20:21], v177 offset0:2 offset1:6
    ds_read2st64_b32 v[22:23], v177 offset0:10 offset1:14
    s_waitcnt lgkmcnt(2)
    v_bfi_b32 v16, 1, s22, v16
    buffer_store_dwordx4 v[16:19], v7, s[8:11], s31 offen sc1
    s_waitcnt lgkmcnt(0)
    v_bfi_b32 v20, 1, s22, v20
    buffer_store_dwordx4 v[20:23], v7, s[8:11], s32 offen sc1
    s_cmp_eq_u32 s22, 1
    s_cbranch_scc0 L_l1_14
    s_add_u32 m0, s40, 8192
    s_mov_b32 s39, 458752
    buffer_load_dwordx4 v250, s[60:63], s39 offen lds
    s_add_u32 m0, s40, 9216
    s_mov_b32 s39, 516096
    buffer_load_dwordx4 v250, s[60:63], s39 offen lds
L_l1_14:
    v_lshrrev_b32 v244, 1, v0
    v_lshlrev_b32 v244, 13, v244
    v_and_b32 v9, 1, v0
    v_lshl_add_u32 v244, v9, 4, v244
    s_lshl_b32 s33, s20, 5
    s_add_u32 s33, s33, 4194304
    s_add_u32 s34, s33, 1048576
    v_add_u32 v246, 151744, v6
    v_bfe_u32 v9, v0, 1, 6
    s_cmp_eq_u32 s22, 1
    s_cbranch_scc0 L_l1_15
    s_add_u32 m0, s40, 10240
    s_mov_b32 s39, 573440
    buffer_load_dwordx4 v250, s[60:63], s39 offen lds
    s_add_u32 m0, s40, 11264
    s_mov_b32 s39, 630784
    buffer_load_dwordx4 v250, s[60:63], s39 offen lds
L_l1_15:
    v_and_b32 v10, 1, v0
    v_lshlrev_b32 v11, 2, v10
    v_xor_b32 v9, v9, v11
    v_lshlrev_b32 v9, 4, v9
    v_lshl_add_u32 v9, v10, 10, v9
    v_lshrrev_b32 v10, 7, v0
    v_lshl_add_u32 v9, v10, 11, v9
    v_add_u32 v245, 151744, v9
    v_xor_b32 v253, 64, v6
    s_cmp_eq_u32 s22, 0
    s_cbranch_scc0 L_l0_16
    s_add_u32 m0, s40, 27648
    s_add_u32 s39, s38, 12288
    buffer_load_dwordx4 v6, s[8:11], s39 offen sc1 lds
    s_add_u32 m0, s40, 28672
    s_add_u32 s39, s38, 16384
    buffer_load_dwordx4 v6, s[8:11], s39 offen sc1 lds
L_l0_16:
    v_add_u32 v253, 151744, v253
    v_lshrrev_b32 v9, 5, v0
    v_and_b32 v10, 7, v0
    v_xor_b32 v9, v9, v10
    v_lshlrev_b32 v9, 4, v9
    v_and_b32 v11, 31, v0
    v_lshl_add_u32 v247, v11, 7, v9
    v_add_u32 v247, 143488, v247
    v_lshrrev_b32 v9, 3, v0
    s_cmp_eq_u32 s22, 0
    s_cbranch_scc0 L_l0_17
    s_add_u32 m0, s40, 29696
    s_add_u32 s39, s38, 20480
    buffer_load_dwordx4 v6, s[8:11], s39 offen sc1 lds
    s_add_u32 m0, s40, 30720
    s_add_u32 s39, s38, 24576
    buffer_load_dwordx4 v6, s[8:11], s39 offen sc1 lds
L_l0_17:
    v_and_b32 v11, 7, v9
    v_xor_b32 v11, v11, v10
    v_lshlrev_b32 v11, 4, v11
    v_lshl_add_u32 v248, v9, 7, v11
    v_add_u32 v248, 143488, v248
    v_lshlrev_b32 v10, 4, v10
    v_lshl_add_u32 v249, v9, 9, v10
    s_lshr_b32 s35, s20, 2
    s_lshl_b32 s35, s35, 15
    s_cmp_eq_u32 s22, 0
    s_cbranch_scc0 L_l0_18
    s_add_u32 m0, s40, 31744
    s_add_u32 s39, s38, 28672
    buffer_load_dwordx4 v6, s[8:11], s39 offen sc1 lds
    s_add_u32 m0, s40, 32768
    s_add_u32 s39, s38, 32768
    buffer_load_dwordx4 v6, s[8:11], s39 offen sc1 lds
L_l0_18:
    s_and_b32 s36, s20, 3
    s_lshl_b32 s36, s36, 7
    s_add_u32 s35, s35, s36
    s_add_u32 s35, s35, 0
    s_add_u32 s36, s35, 16384
    s_lshl_b32 s37, s25, 10
    s_add_u32 s37, s37, 2097152
    v_lshrrev_b32 v9, 3, v1
    v_lshl_add_u32 v9, v3, 1, v9
    s_cmp_eq_u32 s22, 0
    s_cbranch_scc0 L_l0_19
    s_add_u32 m0, s40, 33792
    s_add_u32 s39, s38, 36864
    buffer_load_dwordx4 v6, s[8:11], s39 offen sc1 lds
    s_add_u32 m0, s40, 34816
    s_add_u32 s39, s38, 40960
    buffer_load_dwordx4 v6, s[8:11], s39 offen sc1 lds
L_l0_19:
    v_cvt_f32_u32 v9, v9
    v_mul_f32 v9, 0x3e000000, v9
    v_and_b32 v10, 7, v1
    v_cvt_f32_u32 v10, v10
    v_mul_f32 v11, v10, v5
    v_mul_f32 v12, 0x3e000000, v11
    v_mov_b32 v176, v12
    v_add_f32 v177, v9, v12
    v_fmamk_f32 v178, v9, 0x40000000, v12
    s_cmp_eq_u32 s22, 0
    s_cbranch_scc0 L_l0_20
    s_add_u32 m0, s40, 16384
    s_add_u32 s39, s38, 65536
    buffer_load_dwordx4 v6, s[8:11], s39 offen sc1 lds
    s_add_u32 m0, s40, 17408
    s_add_u32 s39, s38, 69632
    buffer_load_dwordx4 v6, s[8:11], s39 offen sc1 lds
L_l0_20:
    v_fmamk_f32 v179, v9, 0x40400000, v12
    v_fmamk_f32 v180, v9, 0x40800000, v12
    v_fmamk_f32 v181, v9, 0x40a00000, v12
    v_fmamk_f32 v182, v9, 0x40c00000, v12
    v_fmamk_f32 v183, v9, 0x40e00000, v12
    v_sin_f32 v184, v176
    v_cos_f32 v176, v176
    v_sin_f32 v185, v177
    v_cos_f32 v177, v177
    s_cmp_eq_u32 s22, 0
    s_cbranch_scc0 L_l0_21
    s_add_u32 m0, s40, 18432
    s_add_u32 s39, s38, 73728
    buffer_load_dwordx4 v6, s[8:11], s39 offen sc1 lds
    s_add_u32 m0, s40, 19456
    s_add_u32 s39, s38, 77824
    buffer_load_dwordx4 v6, s[8:11], s39 offen sc1 lds
L_l0_21:
    v_sin_f32 v186, v178
    v_cos_f32 v178, v178
    v_sin_f32 v187, v179
    v_cos_f32 v179, v179
    v_sin_f32 v188, v180
    v_cos_f32 v180, v180
    v_sin_f32 v189, v181
    v_cos_f32 v181, v181
    v_sin_f32 v190, v182
    v_cos_f32 v182, v182
    v_sin_f32 v191, v183
    v_cos_f32 v183, v183
    v_mul_f32 v9, 0x3b000000, v10
    v_cvt_pk_bf16_f32 v64, v176, -v184
    v_cvt_pk_bf16_f32 v72, v184, v176
    v_cvt_pk_bf16_f32 v65, v177, -v185
    v_cvt_pk_bf16_f32 v73, v185, v177
    v_cvt_pk_bf16_f32 v66, v178, -v186
    v_cvt_pk_bf16_f32 v74, v186, v178
    v_cvt_pk_bf16_f32 v67, v179, -v187
    v_cvt_pk_bf16_f32 v75, v187, v179
    v_cvt_pk_bf16_f32 v68, v180, -v188
    v_cvt_pk_bf16_f32 v76, v188, v180
    v_cvt_pk_bf16_f32 v69, v181, -v189
    v_cvt_pk_bf16_f32 v77, v189, v181
    v_cvt_pk_bf16_f32 v70, v182, -v190
    v_cvt_pk_bf16_f32 v78, v190, v182
    v_cvt_pk_bf16_f32 v71, v183, -v191
    v_cvt_pk_bf16_f32 v79, v191, v183
    v_mul_f32 v12, 0x3c000000, v11
    v_mov_b32 v80, v12
    v_add_f32 v81, v9, v12
    v_fmamk_f32 v82, v9, 0x40000000, v12
    v_fmamk_f32 v83, v9, 0x40400000, v12
    v_fmamk_f32 v84, v9, 0x41800000, v12
    v_fmamk_f32 v85, v9, 0x41880000, v12
    v_fmamk_f32 v86, v9, 0x41900000, v12
    v_fmamk_f32 v87, v9, 0x41980000, v12
    v_fmamk_f32 v88, v9, 0x42000000, v12
    v_fmamk_f32 v89, v9, 0x42040000, v12
    v_fmamk_f32 v90, v9, 0x42080000, v12
    v_fmamk_f32 v91, v9, 0x420c0000, v12
    v_fmamk_f32 v92, v9, 0x42400000, v12
    v_fmamk_f32 v93, v9, 0x42440000, v12
    v_fmamk_f32 v94, v9, 0x42480000, v12
    v_fmamk_f32 v95, v9, 0x424c0000, v12
    v_cmp_eq_u32 vcc, 0, v2
    v_mul_f32 v10, 0.5, v10
    v_mul_f32 v9, 0x3c800000, v4
    v_cndmask_b32 v80, v80, v10, vcc
    v_sin_f32 v96, v80
    v_cos_f32 v80, v80
    v_sin_f32 v97, v81
    v_cos_f32 v81, v81
    v_sin_f32 v98, v82
    v_cos_f32 v82, v82
    v_sin_f32 v99, v83
    v_cos_f32 v83, v83
    v_sin_f32 v100, v84
    v_cos_f32 v84, v84
    v_sin_f32 v101, v85
    v_cos_f32 v85, v85
    v_sin_f32 v102, v86
    v_cos_f32 v86, v86
    v_sin_f32 v103, v87
    v_cos_f32 v87, v87
    v_sin_f32 v104, v88
    v_cos_f32 v88, v88
    v_sin_f32 v105, v89
    v_cos_f32 v89, v89
    v_sin_f32 v106, v90
    v_cos_f32 v90, v90
    v_sin_f32 v107, v91
    v_cos_f32 v91, v91
    v_sin_f32 v108, v92
    v_cos_f32 v92, v92
    v_sin_f32 v109, v93
    v_cos_f32 v93, v93
    v_sin_f32 v110, v94
    v_cos_f32 v94, v94
    v_sin_f32 v111, v95
    buffer_load_dwordx4 v[24:27], v244, s[8:11], s33 offen sc1
    buffer_load_dwordx4 v[28:31], v244, s[8:11], s34 offen sc1
    v_cos_f32 v95, v95
    v_mul_f32 v12, v4, v5
    v_mul_f32 v12, 0x3d800000, v12
    v_mov_b32 v176, v12
    v_add_f32 v177, v9, v12
    v_fmamk_f32 v178, v9, 0x40000000, v12
    v_fmamk_f32 v179, v9, 0x40400000, v12
    v_fmamk_f32 v180, v9, 0x41800000, v12
    v_fmamk_f32 v181, v9, 0x41880000, v12
    v_fmamk_f32 v182, v9, 0x41900000, v12
    v_fmamk_f32 v183, v9, 0x41980000, v12
    v_sin_f32 v184, v176
    v_cos_f32 v176, v176
    v_sin_f32 v185, v177
    v_cos_f32 v177, v177
    v_sin_f32 v186, v178
    v_cos_f32 v178, v178
    v_sin_f32 v187, v179
    v_cos_f32 v179, v179
    v_sin_f32 v188, v180
    v_cos_f32 v180, v180
    v_sin_f32 v189, v181
    v_cos_f32 v181, v181
    v_sin_f32 v190, v182
    v_cos_f32 v182, v182
    v_sin_f32 v191, v183
    v_cos_f32 v183, v183
    v_and_b32 v11, 1, v1
    s_mov_b32 s28, 0x80008000
    v_mul_lo_u32 v11, v11, s28
    v_cvt_pk_bf16_f32 v112, v176, -v184
    v_cvt_pk_bf16_f32 v113, v177, -v185
    v_cvt_pk_bf16_f32 v114, v178, -v186
    v_cvt_pk_bf16_f32 v115, v179, -v187
    v_cvt_pk_bf16_f32 v116, v176, -v184
    v_cvt_pk_bf16_f32 v117, -v185, -v177
    v_cvt_pk_bf16_f32 v118, -v178, v186
    v_cvt_pk_bf16_f32 v119, v187, v179
    v_cvt_pk_bf16_f32 v120, v176, -v184
    v_cvt_pk_bf16_f32 v121, -v177, v185
    v_cvt_pk_bf16_f32 v122, v178, -v186
    v_cvt_pk_bf16_f32 v123, -v179, v187
    v_cvt_pk_bf16_f32 v124, v176, -v184
    v_cvt_pk_bf16_f32 v125, v185, v177
    v_cvt_pk_bf16_f32 v126, -v178, v186
    v_cvt_pk_bf16_f32 v127, -v187, -v179
    v_cvt_pk_bf16_f32 v128, v180, -v188
    v_cvt_pk_bf16_f32 v129, v181, -v189
    v_cvt_pk_bf16_f32 v130, v182, -v190
    v_cvt_pk_bf16_f32 v131, v183, -v191
    v_cvt_pk_bf16_f32 v132, v180, -v188
    v_cvt_pk_bf16_f32 v133, -v189, -v181
    v_cvt_pk_bf16_f32 v134, -v182, v190
    v_cvt_pk_bf16_f32 v135, v191, v183
    v_cvt_pk_bf16_f32 v136, v180, -v188
    v_cvt_pk_bf16_f32 v137, -v181, v189
    v_cvt_pk_bf16_f32 v138, v182, -v190
    v_cvt_pk_bf16_f32 v139, -v183, v191
    v_cvt_pk_bf16_f32 v140, v180, -v188
    v_cvt_pk_bf16_f32 v141, v189, v181
    v_cvt_pk_bf16_f32 v142, -v182, v190
    v_cvt_pk_bf16_f32 v143, -v191, -v183
    v_xor_b32 v144, v112, v11
    v_xor_b32 v145, v113, v11
    v_xor_b32 v146, v114, v11
    v_xor_b32 v147, v115, v11
    v_xor_b32 v148, v116, v11
    v_xor_b32 v149, v117, v11
    v_xor_b32 v150, v118, v11
    v_xor_b32 v151, v119, v11
    v_xor_b32 v152, v120, v11
    v_xor_b32 v153, v121, v11
    v_xor_b32 v154, v122, v11
    v_xor_b32 v155, v123, v11
    v_xor_b32 v156, v124, v11
    v_xor_b32 v157, v125, v11
    v_xor_b32 v158, v126, v11
    v_xor_b32 v159, v127, v11
    v_xor_b32 v160, v128, v11
    v_xor_b32 v161, v129, v11
    v_xor_b32 v162, v130, v11
    v_xor_b32 v163, v131, v11
    v_xor_b32 v164, v132, v11
    v_xor_b32 v165, v133, v11
    v_xor_b32 v166, v134, v11
    v_xor_b32 v167, v135, v11
    v_xor_b32 v168, v136, v11
    v_xor_b32 v169, v137, v11
    v_xor_b32 v170, v138, v11
    v_xor_b32 v171, v139, v11
    v_xor_b32 v172, v140, v11
    v_xor_b32 v173, v141, v11
    v_xor_b32 v174, v142, v11
    v_xor_b32 v175, v143, v11
    v_accvgpr_read_b32 v225, a232
    v_accvgpr_read_b32 v227, a233
    v_accvgpr_read_b32 v229, a234
    v_accvgpr_read_b32 v231, a235
    v_accvgpr_read_b32 v233, a236
    v_accvgpr_read_b32 v235, a237
    v_accvgpr_read_b32 v237, a238
    v_accvgpr_read_b32 v239, a239
    v_lshlrev_b32 v224, 16, v225
    v_and_b32 v225, 0xffff0000, v225
    v_lshlrev_b32 v226, 16, v227
    v_and_b32 v227, 0xffff0000, v227
    v_lshlrev_b32 v228, 16, v229
    v_and_b32 v229, 0xffff0000, v229
    v_lshlrev_b32 v230, 16, v231
    v_and_b32 v231, 0xffff0000, v231
    v_lshlrev_b32 v232, 16, v233
    v_and_b32 v233, 0xffff0000, v233
    v_lshlrev_b32 v234, 16, v235
    v_and_b32 v235, 0xffff0000, v235
    v_lshlrev_b32 v236, 16, v237
    v_and_b32 v237, 0xffff0000, v237
    v_lshlrev_b32 v238, 16, v239
    v_and_b32 v239, 0xffff0000, v239
    s_waitcnt vmcnt(0)
    v_bitop3_b32 v9, v24, v28, s22 bitop3:0x7e
    v_and_b32 v9, 1, v9
    v_cmp_ne_u32 vcc, 0, v9
    s_cbranch_vccnz L_rt_22
L_ok_23:
    ds_write_b128 v245, v[24:27] offset:0
    ds_write_b128 v245, v[28:31] offset:4096
    s_waitcnt lgkmcnt(0)
    s_barrier
    ds_read_b128 v[32:35], v246 offset:0
    ds_read_b128 v[36:39], v253 offset:1024
    ds_read_b128 v[40:43], v246 offset:2048
    ds_read_b128 v[44:47], v253 offset:3072
    ds_read_b128 v[48:51], v246 offset:4096
    ds_read_b128 v[52:55], v253 offset:5120
    ds_read_b128 v[56:59], v246 offset:6144
    ds_read_b128 v[60:63], v253 offset:7168
    s_add_u32 m0, s40, 12288
    s_mov_b32 s39, 688128
    buffer_load_dwordx4 v250, s[60:63], s39 offen lds
    s_waitcnt lgkmcnt(6)
    v_mfma_f32_16x16x32_bf16 v[176:179], v[32:35], v[64:67], 0
    v_mfma_f32_16x16x32_bf16 v[192:195], v[32:35], v[72:75], 0
    v_mfma_f32_16x16x32_bf16 v[176:179], v[36:39], v[68:71], v[176:179]
    v_mfma_f32_16x16x32_bf16 v[192:195], v[36:39], v[76:79], v[192:195]
    s_waitcnt lgkmcnt(4)
    v_mfma_f32_16x16x32_bf16 v[180:183], v[40:43], v[64:67], 0
    v_mfma_f32_16x16x32_bf16 v[196:199], v[40:43], v[72:75], 0
    v_mfma_f32_16x16x32_bf16 v[180:183], v[44:47], v[68:71], v[180:183]
    v_mfma_f32_16x16x32_bf16 v[196:199], v[44:47], v[76:79], v[196:199]
    s_waitcnt lgkmcnt(2)
    v_mfma_f32_16x16x32_bf16 v[184:187], v[48:51], v[64:67], 0
    v_mfma_f32_16x16x32_bf16 v[200:203], v[48:51], v[72:75], 0
    v_mfma_f32_16x16x32_bf16 v[184:187], v[52:55], v[68:71], v[184:187]
    v_mfma_f32_16x16x32_bf16 v[200:203], v[52:55], v[76:79], v[200:203]
    s_add_u32 m0, s40, 13312
    s_mov_b32 s39, 745472
    buffer_load_dwordx4 v250, s[60:63], s39 offen lds
    s_waitcnt lgkmcnt(0)
    v_mfma_f32_16x16x32_bf16 v[188:191], v[56:59], v[64:67], 0
    v_mfma_f32_16x16x32_bf16 v[204:207], v[56:59], v[72:75], 0
    v_mfma_f32_16x16x32_bf16 v[188:191], v[60:63], v[68:71], v[188:191]
    v_mfma_f32_16x16x32_bf16 v[204:207], v[60:63], v[76:79], v[204:207]
    v_pk_mul_f32 v[16:17], v[176:177], v[80:81]
    v_pk_mul_f32 v[20:21], v[192:193], v[80:81]
    v_pk_mul_f32 v[18:19], v[178:179], v[82:83]
    v_pk_mul_f32 v[22:23], v[194:195], v[82:83]
    v_pk_fma_f32 v[16:17], v[192:193], v[96:97], v[16:17] neg_lo:[1,0,0] neg_hi:[1,0,0]
    v_pk_fma_f32 v[20:21], v[176:177], v[96:97], v[20:21]
    v_pk_fma_f32 v[18:19], v[194:195], v[98:99], v[18:19] neg_lo:[1,0,0] neg_hi:[1,0,0]
    s_add_u32 m0, s40, 14336
    s_mov_b32 s39, 802816
    buffer_load_dwordx4 v250, s[60:63], s39 offen lds
    v_pk_fma_f32 v[22:23], v[178:179], v[98:99], v[22:23]
    v_cvt_pk_bf16_f32 v208, v16, v20
    v_cvt_pk_bf16_f32 v209, v17, v21
    v_cvt_pk_bf16_f32 v210, v18, v22
    v_cvt_pk_bf16_f32 v211, v19, v23
    s_nop 1
    v_mfma_f32_16x16x32_bf16 v[224:227], v[208:211], v[112:115], v[224:227]
    v_mfma_f32_16x16x32_bf16 v[228:231], v[208:211], v[116:119], v[228:231]
    v_mfma_f32_16x16x32_bf16 v[232:235], v[208:211], v[120:123], v[232:235]
    v_mfma_f32_16x16x32_bf16 v[236:239], v[208:211], v[124:127], v[236:239]
    v_pk_mul_f32 v[24:25], v[180:181], v[84:85]
    v_pk_mul_f32 v[28:29], v[196:197], v[84:85]
    v_pk_mul_f32 v[26:27], v[182:183], v[86:87]
    s_add_u32 m0, s40, 15360
    s_mov_b32 s39, 860160
    buffer_load_dwordx4 v250, s[60:63], s39 offen lds
    v_pk_mul_f32 v[30:31], v[198:199], v[86:87]
    v_pk_fma_f32 v[24:25], v[196:197], v[100:101], v[24:25] neg_lo:[1,0,0] neg_hi:[1,0,0]
    v_pk_fma_f32 v[28:29], v[180:181], v[100:101], v[28:29]
    v_pk_fma_f32 v[26:27], v[198:199], v[102:103], v[26:27] neg_lo:[1,0,0] neg_hi:[1,0,0]
    v_pk_fma_f32 v[30:31], v[182:183], v[102:103], v[30:31]
    v_cvt_pk_bf16_f32 v212, v24, v28
    v_cvt_pk_bf16_f32 v213, v25, v29
    v_cvt_pk_bf16_f32 v214, v26, v30
    v_cvt_pk_bf16_f32 v215, v27, v31
    s_nop 1
    v_mfma_f32_16x16x32_bf16 v[224:227], v[212:215], v[128:131], v[224:227]
    v_mfma_f32_16x16x32_bf16 v[228:231], v[212:215], v[132:135], v[228:231]
    s_cmp_eq_u32 s22, 0
    s_cbranch_scc0 L_l0_24
    s_add_u32 m0, s40, 20480
    s_add_u32 s39, s38, 81920
    buffer_load_dwordx4 v6, s[8:11], s39 offen sc1 lds
    s_add_u32 m0, s40, 21504
    s_add_u32 s39, s38, 86016
    buffer_load_dwordx4 v6, s[8:11], s39 offen sc1 lds
L_l0_24:
    v_mfma_f32_16x16x32_bf16 v[232:235], v[212:215], v[136:139], v[232:235]
    v_mfma_f32_16x16x32_bf16 v[236:239], v[212:215], v[140:143], v[236:239]
    v_pk_mul_f32 v[16:17], v[184:185], v[88:89]
    v_pk_mul_f32 v[20:21], v[200:201], v[88:89]
    v_pk_mul_f32 v[18:19], v[186:187], v[90:91]
    v_pk_mul_f32 v[22:23], v[202:203], v[90:91]
    v_pk_fma_f32 v[16:17], v[200:201], v[104:105], v[16:17] neg_lo:[1,0,0] neg_hi:[1,0,0]
    v_pk_fma_f32 v[20:21], v[184:185], v[104:105], v[20:21]
    v_pk_fma_f32 v[18:19], v[202:203], v[106:107], v[18:19] neg_lo:[1,0,0] neg_hi:[1,0,0]
    v_pk_fma_f32 v[22:23], v[186:187], v[106:107], v[22:23]
    v_cvt_pk_bf16_f32 v216, v16, v20
    v_cvt_pk_bf16_f32 v217, v17, v21
    s_cmp_eq_u32 s22, 0
    s_cbranch_scc0 L_l0_25
    s_add_u32 m0, s40, 22528
    s_add_u32 s39, s38, 90112
    buffer_load_dwordx4 v6, s[8:11], s39 offen sc1 lds
    s_add_u32 m0, s40, 23552
    s_add_u32 s39, s38, 94208
    buffer_load_dwordx4 v6, s[8:11], s39 offen sc1 lds
L_l0_25:
    v_cvt_pk_bf16_f32 v218, v18, v22
    v_cvt_pk_bf16_f32 v219, v19, v23
    s_nop 1
    v_mfma_f32_16x16x32_bf16 v[224:227], v[216:219], v[144:147], v[224:227]
    v_mfma_f32_16x16x32_bf16 v[228:231], v[216:219], v[148:151], v[228:231]
    v_mfma_f32_16x16x32_bf16 v[232:235], v[216:219], v[152:155], v[232:235]
    v_mfma_f32_16x16x32_bf16 v[236:239], v[216:219], v[156:159], v[236:239]
    v_pk_mul_f32 v[24:25], v[188:189], v[92:93]
    v_pk_mul_f32 v[28:29], v[204:205], v[92:93]
    v_pk_mul_f32 v[26:27], v[190:191], v[94:95]
    v_pk_mul_f32 v[30:31], v[206:207], v[94:95]
    v_pk_fma_f32 v[24:25], v[204:205], v[108:109], v[24:25] neg_lo:[1,0,0] neg_hi:[1,0,0]
    s_cmp_eq_u32 s22, 0
    s_cbranch_scc0 L_l0_26
    s_add_u32 s56, s42, 0
    buffer_load_dwordx4 a[0:3], v6, s[8:11], s56 offen offset:0 sc1
    buffer_load_dwordx4 a[4:7], v6, s[8:11], s56 offen offset:1024 sc1
L_l0_26:
    v_pk_fma_f32 v[28:29], v[188:189], v[108:109], v[28:29]
    v_pk_fma_f32 v[26:27], v[206:207], v[110:111], v[26:27] neg_lo:[1,0,0] neg_hi:[1,0,0]
    v_pk_fma_f32 v[30:31], v[190:191], v[110:111], v[30:31]
    v_cvt_pk_bf16_f32 v220, v24, v28
    v_cvt_pk_bf16_f32 v221, v25, v29
    v_cvt_pk_bf16_f32 v222, v26, v30
    v_cvt_pk_bf16_f32 v223, v27, v31
    s_nop 1
    v_mfma_f32_16x16x32_bf16 v[224:227], v[220:223], v[160:163], v[224:227]
    v_mfma_f32_16x16x32_bf16 v[228:231], v[220:223], v[164:167], v[228:231]
    v_mfma_f32_16x16x32_bf16 v[232:235], v[220:223], v[168:171], v[232:235]
    v_mfma_f32_16x16x32_bf16 v[236:239], v[220:223], v[172:175], v[236:239]
    s_nop 4
    v_pk_add_f32 v[240:241], v[224:225], v[226:227]
    v_pk_mul_f32 v[242:243], v[224:225], v[224:225]
    v_pk_fma_f32 v[242:243], v[226:227], v[226:227], v[242:243]
    v_pk_add_f32 v[240:241], v[240:241], v[228:229]
    v_pk_fma_f32 v[242:243], v[228:229], v[228:229], v[242:243]
    v_pk_add_f32 v[240:241], v[240:241], v[230:231]
    v_pk_fma_f32 v[242:243], v[230:231], v[230:231], v[242:243]
    v_pk_add_f32 v[240:241], v[240:241], v[232:233]
    v_pk_fma_f32 v[242:243], v[232:233], v[232:233], v[242:243]
    v_pk_add_f32 v[240:241], v[240:241], v[234:235]
    v_pk_fma_f32 v[242:243], v[234:235], v[234:235], v[242:243]
    v_pk_add_f32 v[240:241], v[240:241], v[236:237]
    v_pk_fma_f32 v[242:243], v[236:237], v[236:237], v[242:243]
    v_pk_add_f32 v[240:241], v[240:241], v[238:239]
    v_pk_fma_f32 v[242:243], v[238:239], v[238:239], v[242:243]
    v_add_f32 v240, v240, v241
    v_add_f32 v242, v242, v243
    v_cvt_pk_bf16_f32 v112, v224, v225
    v_add_f32_dpp v240, v240, v240 row_ror:8 row_mask:0xf bank_mask:0xf
    v_add_f32_dpp v242, v242, v242 row_ror:8 row_mask:0xf bank_mask:0xf
    v_cvt_pk_bf16_f32 v113, v226, v227
    v_cvt_pk_bf16_f32 v114, v228, v229
    v_add_f32_dpp v240, v240, v240 row_ror:4 row_mask:0xf bank_mask:0xf
    v_add_f32_dpp v242, v242, v242 row_ror:4 row_mask:0xf bank_mask:0xf
    v_cvt_pk_bf16_f32 v115, v230, v231
    v_cvt_pk_bf16_f32 v116, v232, v233
    v_add_f32_dpp v240, v240, v240 row_ror:2 row_mask:0xf bank_mask:0xf
    v_add_f32_dpp v242, v242, v242 row_ror:2 row_mask:0xf bank_mask:0xf
    v_cvt_pk_bf16_f32 v117, v234, v235
    v_cvt_pk_bf16_f32 v118, v236, v237
    v_add_f32_dpp v240, v240, v240 row_ror:1 row_mask:0xf bank_mask:0xf
    v_add_f32_dpp v242, v242, v242 row_ror:1 row_mask:0xf bank_mask:0xf
    v_cvt_pk_bf16_f32 v119, v238, v239
    v_mov_b32 v241, v240
    v_mov_b32 v243, v242
    s_nop 0
    v_permlane16_swap_b32 v240, v241
    v_permlane16_swap_b32 v242, v243
    v_add_f32 v240, v240, v241
    v_add_f32 v242, v242, v243
    v_mul_f32 v240, 0x3b000000, v240
    v_mul_f32 v242, 0x3b000000, v242
    v_fma_f32 v242, -v240, v240, v242
    v_max_f32 v242, 0, v242
    v_add_f32 v242, 0x3727c5ac, v242
    v_rsq_f32 v242, v242
    s_nop 0
    v_mul_f32 v243, -v240, v242
    v_pk_fma_f32 v[224:225], v[224:225], v[242:243], v[242:243] op_sel:[0,0,1] op_sel_hi:[1,0,1]
    v_pk_fma_f32 v[226:227], v[226:227], v[242:243], v[242:243] op_sel:[0,0,1] op_sel_hi:[1,0,1]
    v_pk_fma_f32 v[228:229], v[228:229], v[242:243], v[242:243] op_sel:[0,0,1] op_sel_hi:[1,0,1]
    v_pk_fma_f32 v[230:231], v[230:231], v[242:243], v[242:243] op_sel:[0,0,1] op_sel_hi:[1,0,1]
    v_pk_fma_f32 v[232:233], v[232:233], v[242:243], v[242:243] op_sel:[0,0,1] op_sel_hi:[1,0,1]
    v_pk_fma_f32 v[234:235], v[234:235], v[242:243], v[242:243] op_sel:[0,0,1] op_sel_hi:[1,0,1]
    v_pk_fma_f32 v[236:237], v[236:237], v[242:243], v[242:243] op_sel:[0,0,1] op_sel_hi:[1,0,1]
    v_pk_fma_f32 v[238:239], v[238:239], v[242:243], v[242:243] op_sel:[0,0,1] op_sel_hi:[1,0,1]
    v_cvt_pk_bf16_f32 v120, v224, v225
    v_cvt_pk_bf16_f32 v121, v226, v227
    v_cvt_pk_bf16_f32 v122, v228, v229
    v_cvt_pk_bf16_f32 v123, v230, v231
    v_cvt_pk_bf16_f32 v124, v232, v233
    v_cvt_pk_bf16_f32 v125, v234, v235
    v_cvt_pk_bf16_f32 v126, v236, v237
    v_cvt_pk_bf16_f32 v127, v238, v239
    v_permlane16_swap_b32 v120, v122
    v_permlane16_swap_b32 v121, v123
    v_and_b32 v120, -2, v120
    ds_write_b128 v247, v[120:123] offset:0
    v_permlane16_swap_b32 v124, v126
    v_permlane16_swap_b32 v125, v127
    v_and_b32 v124, -2, v124
    ds_write_b128 v247, v[124:127] offset:4096
    v_permlane16_swap_b32 v112, v114
    v_permlane16_swap_b32 v113, v115
    v_permlane16_swap_b32 v116, v118
    v_permlane16_swap_b32 v117, v119
    s_waitcnt lgkmcnt(0)
    s_barrier
    ds_read_b128 v[208:211], v248 offset:0
    ds_read_b128 v[212:215], v248 offset:4096
    s_waitcnt lgkmcnt(1)
    buffer_store_dwordx4 v[208:211], v249, s[8:11], s35 offen sc1
    s_waitcnt lgkmcnt(0)
    buffer_store_dwordx4 v[212:215], v249, s[8:11], s36 offen sc1
    v_accvgpr_write_b32 a232, v112
    v_accvgpr_write_b32 a233, v113
    v_accvgpr_write_b32 a234, v114
    v_accvgpr_write_b32 a235, v115
    v_accvgpr_write_b32 a236, v116
    v_accvgpr_write_b32 a237, v117
    v_accvgpr_write_b32 a238, v118
    v_accvgpr_write_b32 a239, v119
    s_cmp_eq_u32 s22, 0
    s_cbranch_scc0 L_l0_27
    s_add_u32 s56, s43, 0
    buffer_load_dwordx4 a[8:11], v6, s[8:11], s56 offen offset:0 sc1
    buffer_load_dwordx4 a[12:15], v6, s[8:11], s56 offen offset:1024 sc1
    s_add_u32 s56, s49, 0
    buffer_load_dwordx4 a[16:19], v6, s[8:11], s56 offen offset:0 sc1
    buffer_load_dwordx4 a[20:23], v6, s[8:11], s56 offen offset:1024 sc1
    s_add_u32 s56, s51, 0
    buffer_load_dwordx4 a[24:27], v6, s[8:11], s56 offen offset:0 sc1
    buffer_load_dwordx4 a[28:31], v6, s[8:11], s56 offen offset:1024 sc1
L_l0_27:
    s_lshr_b32 s47, s20, 4
    s_lshl_b32 s47, s47, 2
    s_add_u32 s47, s47, s21
    s_lshl_b32 s44, s47, 15
    s_add_u32 s44, s44, 0
    s_mul_i32 s45, s47, 114688
    s_and_b32 s46, s20, 15
    s_mul_i32 s46, s46, 7168
    s_add_u32 s45, s45, s46
    s_add_u32 s45, s45, 6291456
    s_add_u32 s46, s45, 4096
    s_lshr_b32 s48, s20, 3
    s_mul_i32 s50, s48, 229376
    s_mul_i32 s51, s21, 28672
    s_add_u32 s50, s50, s51
    s_add_u32 s50, s50, 6291456
    v_bfe_u32 v13, v0, 3, 2
    v_bfrev_b32 v13, v13
    v_lshrrev_b32 v13, 30, v13
    v_mul_u32_u24 v12, 35872, v13
    v_bfe_u32 v13, v0, 5, 1
    v_lshl_add_u32 v12, v13, 9, v12
    v_bfe_u32 v13, v0, 2, 1
    v_lshl_add_u32 v12, v13, 7, v12
    v_and_b32 v13, 1, v0
    v_lshl_add_u32 v12, v13, 4, v12
    v_bfe_u32 v13, v0, 1, 1
    v_lshl_add_u32 v12, v13, 3, v12
    s_lshr_b32 s52, s20, 4
    s_add_u32 s52, s52, s20
    s_mov_b32 s52, 0
    s_add_u32 s53, s52, 0
    s_and_b32 s53, s53, 3
    s_mul_i32 s54, s53, 7168
    s_add_u32 s28, s50, s54
    s_add_u32 s32, s28, 114688
    s_lshl_b32 s53, s53, 11
    s_add_u32 s42, s53, s23
    s_add_u32 s53, s52, 1
    s_and_b32 s53, s53, 3
    s_mul_i32 s54, s53, 7168
    s_add_u32 s29, s50, s54
    s_add_u32 s33, s29, 114688
    s_lshl_b32 s53, s53, 11
    s_add_u32 s43, s53, s23
    s_add_u32 s53, s52, 2
    s_and_b32 s53, s53, 3
    s_mul_i32 s54, s53, 7168
    s_add_u32 s30, s50, s54
    s_add_u32 s34, s30, 114688
    s_lshl_b32 s53, s53, 11
    s_add_u32 s49, s53, s23
    s_add_u32 s53, s52, 3
    s_and_b32 s53, s53, 3
    s_mul_i32 s54, s53, 7168
    s_add_u32 s31, s50, s54
    s_add_u32 s35, s31, 114688
    s_lshl_b32 s53, s53, 11
    s_add_u32 s51, s53, s23
    v_bfe_u32 v10, v0, 3, 3
    v_lshlrev_b32 v11, 18, v10
    v_and_b32 v10, 7, v0
    v_lshl_add_u32 v11, v10, 4, v11
    s_bfe_u32 s57, s20, 0x10003
    s_lshl_b32 s57, s57, 7
    s_lshr_b32 s58, s20, 4
    s_add_u32 s57, s57, s58
    s_lshl_b32 s58, s21, 4
    s_add_u32 s57, s57, s58
    s_lshl_b32 s57, s57, 10
    s_and_b32 s58, s20, 7
    s_lshl_b32 s58, s58, 7
    s_add_u32 s57, s57, s58
    s_add_u32 s58, s57, 65536
    v_accvgpr_read_b32 v14, a244
    v_accvgpr_read_b32 v15, a245
    v_accvgpr_read_b32 v13, a240
    s_add_u32 s36, s57, 2097152
    s_add_u32 s37, s36, 65536
    s_cmp_eq_u32 s22, 1
    s_cbranch_scc1 L_ffn1
    v_bfe_u32 v10, v0, 3, 3
    v_lshlrev_b32 v11, 10, v10
    v_and_b32 v10, 7, v0
    v_lshl_add_u32 v11, v10, 4, v11
    s_lshl_b32 s57, s48, 16
    s_lshl_b32 s58, s21, 13
    s_add_u32 s57, s57, s58
    s_and_b32 s58, s20, 7
    s_lshl_b32 s58, s58, 7
    s_add_u32 s57, s57, s58
    s_add_u32 s58, s57, 32768
    s_waitcnt vmcnt(0)
    s_add_u32 s53, s44, 0
    buffer_load_dwordx4 v[16:19], v6, s[8:11], s53 offen offset:0 sc1
    buffer_load_dwordx4 v[20:23], v6, s[8:11], s53 offen offset:1024 sc1
    buffer_load_dwordx4 v[24:27], v6, s[8:11], s53 offen offset:2048 sc1
    buffer_load_dwordx4 v[28:31], v6, s[8:11], s53 offen offset:3072 sc1
    s_add_u32 s53, s44, 4096
    buffer_load_dwordx4 v[32:35], v6, s[8:11], s53 offen offset:0 sc1
    buffer_load_dwordx4 v[36:39], v6, s[8:11], s53 offen offset:1024 sc1
    buffer_load_dwordx4 v[40:43], v6, s[8:11], s53 offen offset:2048 sc1
    buffer_load_dwordx4 v[44:47], v6, s[8:11], s53 offen offset:3072 sc1
    s_add_u32 s53, s44, 8192
    buffer_load_dwordx4 v[48:51], v6, s[8:11], s53 offen offset:0 sc1
    buffer_load_dwordx4 v[52:55], v6, s[8:11], s53 offen offset:1024 sc1
    buffer_load_dwordx4 v[56:59], v6, s[8:11], s53 offen offset:2048 sc1
    buffer_load_dwordx4 v[60:63], v6, s[8:11], s53 offen offset:3072 sc1
    s_barrier
    ds_read_b64_tr_b16 v[224:225], v12 offset:0
    ds_read_b64_tr_b16 v[226:227], v12 offset:256
    ds_read_b64_tr_b16 v[228:229], v12 offset:32
    ds_read_b64_tr_b16 v[230:231], v12 offset:288
    ds_read_b64_tr_b16 v[232:233], v12 offset:64
    ds_read_b64_tr_b16 v[234:235], v12 offset:320
    ds_read_b64_tr_b16 v[236:237], v12 offset:96
    ds_read_b64_tr_b16 v[238:239], v12 offset:352
    ds_read_b64_tr_b16 v[240:241], v12 offset:1024
    ds_read_b64_tr_b16 v[242:243], v12 offset:1280
    ds_read_b64_tr_b16 v[244:245], v12 offset:1056
    ds_read_b64_tr_b16 v[246:247], v12 offset:1312
    s_waitcnt vmcnt(8)
    v_or3_b32 v9, v16, v20, v24
    v_or_b32 v9, v9, v28
    v_and_b32 v9, 1, v9
    v_cmp_ne_u32 vcc, 0, v9
    s_cbranch_vccnz L_rt_28
L_ok_29:
    ds_read_b64_tr_b16 v[248:249], v12 offset:1088
    ds_read_b64_tr_b16 v[250:251], v12 offset:1344
    s_waitcnt lgkmcnt(10)
    v_mfma_f32_32x32x16_bf16 v[192:207], v[224:227], v[16:19], 0
    s_add_u32 s53, s44, 12288
    ds_read_b64_tr_b16 v[252:253], v12 offset:1120
    ds_read_b64_tr_b16 v[254:255], v12 offset:1376
    v_mfma_f32_32x32x16_bf16 v[176:191], v[228:231], v[16:19], 0
    buffer_load_dwordx4 v[64:67], v6, s[8:11], s53 offen offset:0 sc1
    ds_read_b64_tr_b16 v[224:225], v12 offset:2048
    ds_read_b64_tr_b16 v[226:227], v12 offset:2304
    s_waitcnt lgkmcnt(10)
    v_mfma_f32_32x32x16_bf16 v[144:159], v[232:235], v[16:19], 0
    ds_read_b64_tr_b16 v[228:229], v12 offset:2080
    ds_read_b64_tr_b16 v[230:231], v12 offset:2336
    v_mfma_f32_32x32x16_bf16 v[160:175], v[236:239], v[16:19], 0
    buffer_load_dwordx4 v[68:71], v6, s[8:11], s53 offen offset:1024 sc1
    ds_read_b64_tr_b16 v[232:233], v12 offset:2112
    ds_read_b64_tr_b16 v[234:235], v12 offset:2368
    s_waitcnt lgkmcnt(10)
    v_mfma_f32_32x32x16_bf16 v[192:207], v[240:243], v[20:23], v[192:207]
    ds_read_b64_tr_b16 v[236:237], v12 offset:2144
    ds_read_b64_tr_b16 v[238:239], v12 offset:2400
    v_mfma_f32_32x32x16_bf16 v[176:191], v[244:247], v[20:23], v[176:191]
    buffer_load_dwordx4 v[72:75], v6, s[8:11], s53 offen offset:2048 sc1
    s_waitcnt vmcnt(7)
    ds_read_b64_tr_b16 v[240:241], v12 offset:3072
    ds_read_b64_tr_b16 v[242:243], v12 offset:3328
    s_waitcnt lgkmcnt(10)
    v_mfma_f32_32x32x16_bf16 v[144:159], v[248:251], v[20:23], v[144:159]
    v_or3_b32 v9, v32, v36, v40
    v_or_b32 v9, v9, v44
    ds_read_b64_tr_b16 v[244:245], v12 offset:3104
    ds_read_b64_tr_b16 v[246:247], v12 offset:3360
    v_mfma_f32_32x32x16_bf16 v[160:175], v[252:255], v[20:23], v[160:175]
    v_and_b32 v9, 1, v9
    buffer_load_dwordx4 v[76:79], v6, s[8:11], s53 offen offset:3072 sc1
    ds_read_b64_tr_b16 v[248:249], v12 offset:3136
    ds_read_b64_tr_b16 v[250:251], v12 offset:3392
    s_waitcnt lgkmcnt(10)
    v_mfma_f32_32x32x16_bf16 v[192:207], v[224:227], v[24:27], v[192:207]
    v_cmp_ne_u32 vcc, 0, v9
    s_add_u32 s53, s44, 16384
    ds_read_b64_tr_b16 v[252:253], v12 offset:3168
    ds_read_b64_tr_b16 v[254:255], v12 offset:3424
    v_mfma_f32_32x32x16_bf16 v[176:191], v[228:231], v[24:27], v[176:191]
    s_cbranch_vccnz L_rt_30
L_ok_31:
    buffer_load_dwordx4 v[80:83], v6, s[8:11], s53 offen offset:0 sc1
    ds_read_b64_tr_b16 v[224:225], v12 offset:4096
    ds_read_b64_tr_b16 v[226:227], v12 offset:4352
    s_waitcnt lgkmcnt(10)
    v_mfma_f32_32x32x16_bf16 v[144:159], v[232:235], v[24:27], v[144:159]
    ds_read_b64_tr_b16 v[228:229], v12 offset:4128
    ds_read_b64_tr_b16 v[230:231], v12 offset:4384
    v_mfma_f32_32x32x16_bf16 v[160:175], v[236:239], v[24:27], v[160:175]
    buffer_load_dwordx4 v[84:87], v6, s[8:11], s53 offen offset:1024 sc1
    ds_read_b64_tr_b16 v[232:233], v12 offset:4160
    ds_read_b64_tr_b16 v[234:235], v12 offset:4416
    s_waitcnt lgkmcnt(10)
    v_mfma_f32_32x32x16_bf16 v[192:207], v[240:243], v[28:31], v[192:207]
    ds_read_b64_tr_b16 v[236:237], v12 offset:4192
    ds_read_b64_tr_b16 v[238:239], v12 offset:4448
    v_mfma_f32_32x32x16_bf16 v[176:191], v[244:247], v[28:31], v[176:191]
    buffer_load_dwordx4 v[88:91], v6, s[8:11], s53 offen offset:2048 sc1
    ds_read_b64_tr_b16 v[240:241], v12 offset:5120
    ds_read_b64_tr_b16 v[242:243], v12 offset:5376
    s_waitcnt lgkmcnt(10)
    v_mfma_f32_32x32x16_bf16 v[144:159], v[248:251], v[28:31], v[144:159]
    ds_read_b64_tr_b16 v[244:245], v12 offset:5152
    ds_read_b64_tr_b16 v[246:247], v12 offset:5408
    v_mfma_f32_32x32x16_bf16 v[160:175], v[252:255], v[28:31], v[160:175]
    buffer_load_dwordx4 v[92:95], v6, s[8:11], s53 offen offset:3072 sc1
    s_add_u32 s53, s44, 20480
    ds_read_b64_tr_b16 v[248:249], v12 offset:5184
    ds_read_b64_tr_b16 v[250:251], v12 offset:5440
    s_waitcnt lgkmcnt(10)
    v_mfma_f32_32x32x16_bf16 v[192:207], v[224:227], v[32:35], v[192:207]
    ds_read_b64_tr_b16 v[252:253], v12 offset:5216
    ds_read_b64_tr_b16 v[254:255], v12 offset:5472
    v_mfma_f32_32x32x16_bf16 v[176:191], v[228:231], v[32:35], v[176:191]
    buffer_load_dwordx4 v[96:99], v6, s[8:11], s53 offen offset:0 sc1
    ds_read_b64_tr_b16 v[224:225], v12 offset:6144
    ds_read_b64_tr_b16 v[226:227], v12 offset:6400
    s_waitcnt lgkmcnt(10)
    v_mfma_f32_32x32x16_bf16 v[144:159], v[232:235], v[32:35], v[144:159]
    ds_read_b64_tr_b16 v[228:229], v12 offset:6176
    ds_read_b64_tr_b16 v[230:231], v12 offset:6432
    v_mfma_f32_32x32x16_bf16 v[160:175], v[236:239], v[32:35], v[160:175]
    buffer_load_dwordx4 v[100:103], v6, s[8:11], s53 offen offset:1024 sc1
    ds_read_b64_tr_b16 v[232:233], v12 offset:6208
    ds_read_b64_tr_b16 v[234:235], v12 offset:6464
    s_waitcnt lgkmcnt(10)
    v_mfma_f32_32x32x16_bf16 v[192:207], v[240:243], v[36:39], v[192:207]
    ds_read_b64_tr_b16 v[236:237], v12 offset:6240
    ds_read_b64_tr_b16 v[238:239], v12 offset:6496
    v_mfma_f32_32x32x16_bf16 v[176:191], v[244:247], v[36:39], v[176:191]
    buffer_load_dwordx4 v[104:107], v6, s[8:11], s53 offen offset:2048 sc1
    s_waitcnt vmcnt(11)
    ds_read_b64_tr_b16 v[240:241], v12 offset:7168
    ds_read_b64_tr_b16 v[242:243], v12 offset:7424
    s_waitcnt lgkmcnt(10)
    v_mfma_f32_32x32x16_bf16 v[144:159], v[248:251], v[36:39], v[144:159]
    v_or3_b32 v9, v48, v52, v56
    v_or_b32 v9, v9, v60
    ds_read_b64_tr_b16 v[244:245], v12 offset:7200
    ds_read_b64_tr_b16 v[246:247], v12 offset:7456
    v_mfma_f32_32x32x16_bf16 v[160:175], v[252:255], v[36:39], v[160:175]
    v_and_b32 v9, 1, v9
    buffer_load_dwordx4 v[108:111], v6, s[8:11], s53 offen offset:3072 sc1
    ds_read_b64_tr_b16 v[248:249], v12 offset:7232
    ds_read_b64_tr_b16 v[250:251], v12 offset:7488
    s_waitcnt lgkmcnt(10)
    v_mfma_f32_32x32x16_bf16 v[192:207], v[224:227], v[40:43], v[192:207]
    v_cmp_ne_u32 vcc, 0, v9
    s_add_u32 s53, s44, 24576
    ds_read_b64_tr_b16 v[252:253], v12 offset:7264
    ds_read_b64_tr_b16 v[254:255], v12 offset:7520
    v_mfma_f32_32x32x16_bf16 v[176:191], v[228:231], v[40:43], v[176:191]
    s_cbranch_vccnz L_rt_32
L_ok_33:
    buffer_load_dwordx4 v[112:115], v6, s[8:11], s53 offen offset:0 sc1
    s_barrier
    ds_read_b64_tr_b16 v[224:225], v12 offset:8192
    ds_read_b64_tr_b16 v[226:227], v12 offset:8448
    s_waitcnt lgkmcnt(10)
    v_mfma_f32_32x32x16_bf16 v[144:159], v[232:235], v[40:43], v[144:159]
    s_add_u32 m0, s40, 0
    s_mov_b32 s39, 917504
    ds_read_b64_tr_b16 v[228:229], v12 offset:8224
    ds_read_b64_tr_b16 v[230:231], v12 offset:8480
    v_mfma_f32_32x32x16_bf16 v[160:175], v[236:239], v[40:43], v[160:175]
    buffer_load_dwordx4 v13, s[60:63], s39 offen lds
    s_add_u32 m0, s40, 1024
    s_mov_b32 s39, 974848
    ds_read_b64_tr_b16 v[232:233], v12 offset:8256
    ds_read_b64_tr_b16 v[234:235], v12 offset:8512
    s_waitcnt lgkmcnt(10)
    v_mfma_f32_32x32x16_bf16 v[192:207], v[240:243], v[44:47], v[192:207]
    ds_read_b64_tr_b16 v[236:237], v12 offset:8288
    ds_read_b64_tr_b16 v[238:239], v12 offset:8544
    v_mfma_f32_32x32x16_bf16 v[176:191], v[244:247], v[44:47], v[176:191]
    buffer_load_dwordx4 v13, s[60:63], s39 offen lds
    s_add_u32 m0, s40, 2048
    s_mov_b32 s39, 1032192
    ds_read_b64_tr_b16 v[240:241], v12 offset:9216
    ds_read_b64_tr_b16 v[242:243], v12 offset:9472
    s_waitcnt lgkmcnt(10)
    v_mfma_f32_32x32x16_bf16 v[144:159], v[248:251], v[44:47], v[144:159]
    ds_read_b64_tr_b16 v[244:245], v12 offset:9248
    ds_read_b64_tr_b16 v[246:247], v12 offset:9504
    v_mfma_f32_32x32x16_bf16 v[160:175], v[252:255], v[44:47], v[160:175]
    buffer_load_dwordx4 v13, s[60:63], s39 offen lds
    s_add_u32 m0, s40, 3072
    s_mov_b32 s39, 1089536
    ds_read_b64_tr_b16 v[248:249], v12 offset:9280
    ds_read_b64_tr_b16 v[250:251], v12 offset:9536
    s_waitcnt lgkmcnt(10)
    v_mfma_f32_32x32x16_bf16 v[192:207], v[224:227], v[48:51], v[192:207]
    s_add_u32 s56, s42, 8192
    buffer_load_dwordx4 a[32:35], v6, s[8:11], s56 offen offset:0 sc1
    ds_read_b64_tr_b16 v[252:253], v12 offset:9312
    ds_read_b64_tr_b16 v[254:255], v12 offset:9568
    v_mfma_f32_32x32x16_bf16 v[176:191], v[228:231], v[48:51], v[176:191]
    buffer_load_dwordx4 v13, s[60:63], s39 offen lds
    s_add_u32 m0, s40, 4096
    s_mov_b32 s39, 1146880
    ds_read_b64_tr_b16 v[224:225], v12 offset:10240
    ds_read_b64_tr_b16 v[226:227], v12 offset:10496
    s_waitcnt lgkmcnt(10)
    v_mfma_f32_32x32x16_bf16 v[144:159], v[232:235], v[48:51], v[144:159]
    ds_read_b64_tr_b16 v[228:229], v12 offset:10272
    ds_read_b64_tr_b16 v[230:231], v12 offset:10528
    v_mfma_f32_32x32x16_bf16 v[160:175], v[236:239], v[48:51], v[160:175]
    buffer_load_dwordx4 v13, s[60:63], s39 offen lds
    s_add_u32 m0, s40, 5120
    s_mov_b32 s39, 1204224
    ds_read_b64_tr_b16 v[232:233], v12 offset:10304
    ds_read_b64_tr_b16 v[234:235], v12 offset:10560
    s_waitcnt lgkmcnt(10)
    v_mfma_f32_32x32x16_bf16 v[192:207], v[240:243], v[52:55], v[192:207]
    ds_read_b64_tr_b16 v[236:237], v12 offset:10336
    ds_read_b64_tr_b16 v[238:239], v12 offset:10592
    v_mfma_f32_32x32x16_bf16 v[176:191], v[244:247], v[52:55], v[176:191]
    buffer_load_dwordx4 v13, s[60:63], s39 offen lds
    s_waitcnt vmcnt(16)
    ds_read_b64_tr_b16 v[240:241], v12 offset:11264
    ds_read_b64_tr_b16 v[242:243], v12 offset:11520
    s_waitcnt lgkmcnt(10)
    v_mfma_f32_32x32x16_bf16 v[144:159], v[248:251], v[52:55], v[144:159]
    v_or3_b32 v9, v64, v68, v72
    v_or_b32 v9, v9, v76
    buffer_load_dwordx4 a[36:39], v6, s[8:11], s56 offen offset:1024 sc1
    ds_read_b64_tr_b16 v[244:245], v12 offset:11296
    ds_read_b64_tr_b16 v[246:247], v12 offset:11552
    v_mfma_f32_32x32x16_bf16 v[160:175], v[252:255], v[52:55], v[160:175]
    v_and_b32 v9, 1, v9
    buffer_load_dwordx4 v[116:119], v6, s[8:11], s53 offen offset:1024 sc1
    ds_read_b64_tr_b16 v[248:249], v12 offset:11328
    ds_read_b64_tr_b16 v[250:251], v12 offset:11584
    s_waitcnt lgkmcnt(10)
    v_mfma_f32_32x32x16_bf16 v[192:207], v[224:227], v[56:59], v[192:207]
    v_cmp_ne_u32 vcc, 0, v9
    ds_read_b64_tr_b16 v[252:253], v12 offset:11360
    ds_read_b64_tr_b16 v[254:255], v12 offset:11616
    v_mfma_f32_32x32x16_bf16 v[176:191], v[228:231], v[56:59], v[176:191]
    s_cbranch_vccnz L_rt_34
L_ok_35:
    buffer_load_dwordx4 v[120:123], v6, s[8:11], s53 offen offset:2048 sc1
    s_barrier
    ds_read_b64_tr_b16 v[224:225], v12 offset:12288
    ds_read_b64_tr_b16 v[226:227], v12 offset:12544
    s_waitcnt lgkmcnt(10)
    v_mfma_f32_32x32x16_bf16 v[144:159], v[232:235], v[56:59], v[144:159]
    s_add_u32 s56, s43, 8192
    buffer_load_dwordx4 a[40:43], v6, s[8:11], s56 offen offset:0 sc1
    s_add_u32 m0, s40, 6144
    s_mov_b32 s39, 1261568
    ds_read_b64_tr_b16 v[228:229], v12 offset:12320
    ds_read_b64_tr_b16 v[230:231], v12 offset:12576
    v_mfma_f32_32x32x16_bf16 v[160:175], v[236:239], v[56:59], v[160:175]
    buffer_load_dwordx4 v13, s[60:63], s39 offen lds
    s_add_u32 m0, s40, 7168
    s_mov_b32 s39, 1318912
    ds_read_b64_tr_b16 v[232:233], v12 offset:12352
    ds_read_b64_tr_b16 v[234:235], v12 offset:12608
    s_waitcnt lgkmcnt(10)
    v_mfma_f32_32x32x16_bf16 v[192:207], v[240:243], v[60:63], v[192:207]
    ds_read_b64_tr_b16 v[236:237], v12 offset:12384
    ds_read_b64_tr_b16 v[238:239], v12 offset:12640
    v_mfma_f32_32x32x16_bf16 v[176:191], v[244:247], v[60:63], v[176:191]
    buffer_load_dwordx4 v13, s[60:63], s39 offen lds
    ds_read_b64_tr_b16 v[240:241], v12 offset:13312
    ds_read_b64_tr_b16 v[242:243], v12 offset:13568
    s_waitcnt lgkmcnt(10)
    v_mfma_f32_32x32x16_bf16 v[144:159], v[248:251], v[60:63], v[144:159]
    buffer_load_dwordx4 a[44:47], v6, s[8:11], s56 offen offset:1024 sc1
    ds_read_b64_tr_b16 v[244:245], v12 offset:13344
    ds_read_b64_tr_b16 v[246:247], v12 offset:13600
    v_mfma_f32_32x32x16_bf16 v[160:175], v[252:255], v[60:63], v[160:175]
    buffer_load_dwordx4 v[124:127], v6, s[8:11], s53 offen offset:3072 sc1
    s_add_u32 m0, s40, 8192
    s_mov_b32 s39, 1376256
    ds_read_b64_tr_b16 v[248:249], v12 offset:13376
    ds_read_b64_tr_b16 v[250:251], v12 offset:13632
    s_waitcnt lgkmcnt(10)
    v_mfma_f32_32x32x16_bf16 v[192:207], v[224:227], v[64:67], v[192:207]
    ds_read_b64_tr_b16 v[252:253], v12 offset:13408
    ds_read_b64_tr_b16 v[254:255], v12 offset:13664
    v_mfma_f32_32x32x16_bf16 v[176:191], v[228:231], v[64:67], v[176:191]
    buffer_load_dwordx4 v13, s[60:63], s39 offen lds
    s_add_u32 m0, s40, 9216
    s_mov_b32 s39, 1433600
    ds_read_b64_tr_b16 v[224:225], v12 offset:14336
    ds_read_b64_tr_b16 v[226:227], v12 offset:14592
    s_waitcnt lgkmcnt(10)
    v_mfma_f32_32x32x16_bf16 v[144:159], v[232:235], v[64:67], v[144:159]
    s_add_u32 s56, s49, 8192
    buffer_load_dwordx4 a[48:51], v6, s[8:11], s56 offen offset:0 sc1
    ds_read_b64_tr_b16 v[228:229], v12 offset:14368
    ds_read_b64_tr_b16 v[230:231], v12 offset:14624
    v_mfma_f32_32x32x16_bf16 v[160:175], v[236:239], v[64:67], v[160:175]
    buffer_load_dwordx4 v13, s[60:63], s39 offen lds
    s_add_u32 s53, s44, 28672
    ds_read_b64_tr_b16 v[232:233], v12 offset:14400
    ds_read_b64_tr_b16 v[234:235], v12 offset:14656
    s_waitcnt lgkmcnt(10)
    v_mfma_f32_32x32x16_bf16 v[192:207], v[240:243], v[68:71], v[192:207]
    ds_read_b64_tr_b16 v[236:237], v12 offset:14432
    ds_read_b64_tr_b16 v[238:239], v12 offset:14688
    v_mfma_f32_32x32x16_bf16 v[176:191], v[244:247], v[68:71], v[176:191]
    buffer_load_dwordx4 v[128:131], v6, s[8:11], s53 offen offset:0 sc1
    s_waitcnt vmcnt(24)
    ds_read_b64_tr_b16 v[240:241], v12 offset:15360
    ds_read_b64_tr_b16 v[242:243], v12 offset:15616
    s_waitcnt lgkmcnt(10)
    v_mfma_f32_32x32x16_bf16 v[144:159], v[248:251], v[68:71], v[144:159]
    v_or3_b32 v9, v80, v84, v88
    v_or_b32 v9, v9, v92
    buffer_load_dwordx4 a[52:55], v6, s[8:11], s56 offen offset:1024 sc1
    ds_read_b64_tr_b16 v[244:245], v12 offset:15392
    ds_read_b64_tr_b16 v[246:247], v12 offset:15648
    v_mfma_f32_32x32x16_bf16 v[160:175], v[252:255], v[68:71], v[160:175]
    v_and_b32 v9, 1, v9
    buffer_load_dwordx4 v[132:135], v6, s[8:11], s53 offen offset:1024 sc1
    ds_read_b64_tr_b16 v[248:249], v12 offset:15424
    ds_read_b64_tr_b16 v[250:251], v12 offset:15680
    s_waitcnt lgkmcnt(10)
    v_mfma_f32_32x32x16_bf16 v[192:207], v[224:227], v[72:75], v[192:207]
    v_cmp_ne_u32 vcc, 0, v9
    ds_read_b64_tr_b16 v[252:253], v12 offset:15456
    ds_read_b64_tr_b16 v[254:255], v12 offset:15712
    v_mfma_f32_32x32x16_bf16 v[176:191], v[228:231], v[72:75], v[176:191]
    s_cbranch_vccnz L_rt_36
L_ok_37:
    buffer_load_dwordx4 v[136:139], v6, s[8:11], s53 offen offset:2048 sc1
    s_waitcnt vmcnt(17)
    s_barrier
    ds_read_b64_tr_b16 v[224:225], v12 offset:0
    ds_read_b64_tr_b16 v[226:227], v12 offset:256
    s_waitcnt lgkmcnt(10)
    v_mfma_f32_32x32x16_bf16 v[144:159], v[232:235], v[72:75], v[144:159]
    s_add_u32 s56, s51, 8192
    buffer_load_dwordx4 a[56:59], v6, s[8:11], s56 offen offset:0 sc1
    s_add_u32 m0, s40, 10240
    s_mov_b32 s39, 1490944
    ds_read_b64_tr_b16 v[228:229], v12 offset:32
    ds_read_b64_tr_b16 v[230:231], v12 offset:288
    v_mfma_f32_32x32x16_bf16 v[160:175], v[236:239], v[72:75], v[160:175]
    buffer_load_dwordx4 v13, s[60:63], s39 offen lds
    s_add_u32 m0, s40, 11264
    s_mov_b32 s39, 1548288
    ds_read_b64_tr_b16 v[232:233], v12 offset:64
    ds_read_b64_tr_b16 v[234:235], v12 offset:320
    s_waitcnt lgkmcnt(10)
    v_mfma_f32_32x32x16_bf16 v[192:207], v[240:243], v[76:79], v[192:207]
    ds_read_b64_tr_b16 v[236:237], v12 offset:96
    ds_read_b64_tr_b16 v[238:239], v12 offset:352
    v_mfma_f32_32x32x16_bf16 v[176:191], v[244:247], v[76:79], v[176:191]
    buffer_load_dwordx4 v13, s[60:63], s39 offen lds
    ds_read_b64_tr_b16 v[240:241], v12 offset:1024
    ds_read_b64_tr_b16 v[242:243], v12 offset:1280
    s_waitcnt lgkmcnt(10)
    v_mfma_f32_32x32x16_bf16 v[144:159], v[248:251], v[76:79], v[144:159]
    buffer_load_dwordx4 a[60:63], v6, s[8:11], s56 offen offset:1024 sc1
    ds_read_b64_tr_b16 v[244:245], v12 offset:1056
    ds_read_b64_tr_b16 v[246:247], v12 offset:1312
    v_mfma_f32_32x32x16_bf16 v[160:175], v[252:255], v[76:79], v[160:175]
    buffer_load_dwordx4 v[140:143], v6, s[8:11], s53 offen offset:3072 sc1
    s_add_u32 m0, s40, 12288
    s_mov_b32 s39, 1605632
    ds_read_b64_tr_b16 v[248:249], v12 offset:1088
    ds_read_b64_tr_b16 v[250:251], v12 offset:1344
    s_waitcnt lgkmcnt(10)
    v_mfma_f32_32x32x16_bf16 v[192:207], v[224:227], v[80:83], v[192:207]
    ds_read_b64_tr_b16 v[252:253], v12 offset:1120
    ds_read_b64_tr_b16 v[254:255], v12 offset:1376
    v_mfma_f32_32x32x16_bf16 v[176:191], v[228:231], v[80:83], v[176:191]
    buffer_load_dwordx4 v13, s[60:63], s39 offen lds
    s_add_u32 m0, s40, 13312
    s_mov_b32 s39, 1662976
    ds_read_b64_tr_b16 v[224:225], v12 offset:2048
    ds_read_b64_tr_b16 v[226:227], v12 offset:2304
    s_waitcnt lgkmcnt(10)
    v_mfma_f32_32x32x16_bf16 v[144:159], v[232:235], v[80:83], v[144:159]
    s_add_u32 s56, s42, 16384
    buffer_load_dwordx4 a[64:67], v6, s[8:11], s56 offen offset:0 sc1
    ds_read_b64_tr_b16 v[228:229], v12 offset:2080
    ds_read_b64_tr_b16 v[230:231], v12 offset:2336
    v_mfma_f32_32x32x16_bf16 v[160:175], v[236:239], v[80:83], v[160:175]
    buffer_load_dwordx4 v13, s[60:63], s39 offen lds
    ds_read_b64_tr_b16 v[232:233], v12 offset:2112
    ds_read_b64_tr_b16 v[234:235], v12 offset:2368
    s_waitcnt lgkmcnt(10)
    v_mfma_f32_32x32x16_bf16 v[192:207], v[240:243], v[84:87], v[192:207]
    ds_read_b64_tr_b16 v[236:237], v12 offset:2144
    ds_read_b64_tr_b16 v[238:239], v12 offset:2400
    v_mfma_f32_32x32x16_bf16 v[176:191], v[244:247], v[84:87], v[176:191]
    s_waitcnt vmcnt(31)
    ds_read_b64_tr_b16 v[240:241], v12 offset:3072
    ds_read_b64_tr_b16 v[242:243], v12 offset:3328
    s_waitcnt lgkmcnt(10)
    v_mfma_f32_32x32x16_bf16 v[144:159], v[248:251], v[84:87], v[144:159]
    v_or3_b32 v9, v96, v100, v104
    v_or_b32 v9, v9, v108
    buffer_load_dwordx4 a[68:71], v6, s[8:11], s56 offen offset:1024 sc1
    ds_read_b64_tr_b16 v[244:245], v12 offset:3104
    ds_read_b64_tr_b16 v[246:247], v12 offset:3360
    v_mfma_f32_32x32x16_bf16 v[160:175], v[252:255], v[84:87], v[160:175]
    v_and_b32 v9, 1, v9
    ds_read_b64_tr_b16 v[248:249], v12 offset:3136
    ds_read_b64_tr_b16 v[250:251], v12 offset:3392
    s_waitcnt lgkmcnt(10)
    v_mfma_f32_32x32x16_bf16 v[192:207], v[224:227], v[88:91], v[192:207]
    v_cmp_ne_u32 vcc, 0, v9
    ds_read_b64_tr_b16 v[252:253], v12 offset:3168
    ds_read_b64_tr_b16 v[254:255], v12 offset:3424
    v_mfma_f32_32x32x16_bf16 v[176:191], v[228:231], v[88:91], v[176:191]
    s_cbranch_vccnz L_rt_38
L_ok_39:
    s_add_u32 m0, s40, 14336
    s_mov_b32 s39, 1720320
    s_waitcnt vmcnt(18)
    s_barrier
    ds_read_b64_tr_b16 v[224:225], v12 offset:4096
    ds_read_b64_tr_b16 v[226:227], v12 offset:4352
    s_waitcnt lgkmcnt(10)
    v_mfma_f32_32x32x16_bf16 v[144:159], v[232:235], v[88:91], v[144:159]
    buffer_load_dwordx4 v13, s[60:63], s39 offen lds
    ds_read_b64_tr_b16 v[228:229], v12 offset:4128
    ds_read_b64_tr_b16 v[230:231], v12 offset:4384
    v_mfma_f32_32x32x16_bf16 v[160:175], v[236:239], v[88:91], v[160:175]
    s_add_u32 s56, s43, 16384
    buffer_load_dwordx4 a[72:75], v6, s[8:11], s56 offen offset:0 sc1
    s_add_u32 m0, s40, 15360
    s_mov_b32 s39, 1777664
    ds_read_b64_tr_b16 v[232:233], v12 offset:4160
    ds_read_b64_tr_b16 v[234:235], v12 offset:4416
    s_waitcnt lgkmcnt(10)
    v_mfma_f32_32x32x16_bf16 v[192:207], v[240:243], v[92:95], v[192:207]
    buffer_load_dwordx4 v13, s[60:63], s39 offen lds
    ds_read_b64_tr_b16 v[236:237], v12 offset:4192
    ds_read_b64_tr_b16 v[238:239], v12 offset:4448
    v_mfma_f32_32x32x16_bf16 v[176:191], v[244:247], v[92:95], v[176:191]
    s_add_u32 m0, s40, 0
    s_add_u32 s39, s38, 45056
    ds_read_b64_tr_b16 v[240:241], v12 offset:5120
    ds_read_b64_tr_b16 v[242:243], v12 offset:5376
    s_waitcnt lgkmcnt(10)
    v_mfma_f32_32x32x16_bf16 v[144:159], v[248:251], v[92:95], v[144:159]
    buffer_load_dwordx4 v6, s[8:11], s39 offen sc1 lds
    ds_read_b64_tr_b16 v[244:245], v12 offset:5152
    ds_read_b64_tr_b16 v[246:247], v12 offset:5408
    v_mfma_f32_32x32x16_bf16 v[160:175], v[252:255], v[92:95], v[160:175]
    buffer_load_dwordx4 a[76:79], v6, s[8:11], s56 offen offset:1024 sc1
    s_add_u32 m0, s40, 1024
    s_add_u32 s39, s38, 49152
    ds_read_b64_tr_b16 v[248:249], v12 offset:5184
    ds_read_b64_tr_b16 v[250:251], v12 offset:5440
    s_waitcnt lgkmcnt(10)
    v_mfma_f32_32x32x16_bf16 v[192:207], v[224:227], v[96:99], v[192:207]
    buffer_load_dwordx4 v6, s[8:11], s39 offen sc1 lds
    ds_read_b64_tr_b16 v[252:253], v12 offset:5216
    ds_read_b64_tr_b16 v[254:255], v12 offset:5472
    v_mfma_f32_32x32x16_bf16 v[176:191], v[228:231], v[96:99], v[176:191]
    ds_read_b64_tr_b16 v[224:225], v12 offset:6144
    ds_read_b64_tr_b16 v[226:227], v12 offset:6400
    s_waitcnt lgkmcnt(10)
    v_mfma_f32_32x32x16_bf16 v[144:159], v[232:235], v[96:99], v[144:159]
    ds_read_b64_tr_b16 v[228:229], v12 offset:6176
    ds_read_b64_tr_b16 v[230:231], v12 offset:6432
    v_mfma_f32_32x32x16_bf16 v[160:175], v[236:239], v[96:99], v[160:175]
    s_add_u32 s56, s49, 16384
    buffer_load_dwordx4 a[80:83], v6, s[8:11], s56 offen offset:0 sc1
    ds_read_b64_tr_b16 v[232:233], v12 offset:6208
    ds_read_b64_tr_b16 v[234:235], v12 offset:6464
    s_waitcnt lgkmcnt(10)
    v_mfma_f32_32x32x16_bf16 v[192:207], v[240:243], v[100:103], v[192:207]
    ds_read_b64_tr_b16 v[236:237], v12 offset:6240
    ds_read_b64_tr_b16 v[238:239], v12 offset:6496
    v_mfma_f32_32x32x16_bf16 v[176:191], v[244:247], v[100:103], v[176:191]
    s_waitcnt vmcnt(23)
    ds_read_b64_tr_b16 v[240:241], v12 offset:7168
    ds_read_b64_tr_b16 v[242:243], v12 offset:7424
    s_waitcnt lgkmcnt(10)
    v_mfma_f32_32x32x16_bf16 v[144:159], v[248:251], v[100:103], v[144:159]
    v_or3_b32 v9, v112, v116, v120
    v_or_b32 v9, v9, v124
    ds_read_b64_tr_b16 v[244:245], v12 offset:7200
    ds_read_b64_tr_b16 v[246:247], v12 offset:7456
    v_mfma_f32_32x32x16_bf16 v[160:175], v[252:255], v[100:103], v[160:175]
    v_and_b32 v9, 1, v9
    buffer_load_dwordx4 a[84:87], v6, s[8:11], s56 offen offset:1024 sc1
    ds_read_b64_tr_b16 v[248:249], v12 offset:7232
    ds_read_b64_tr_b16 v[250:251], v12 offset:7488
    s_waitcnt lgkmcnt(10)
    v_mfma_f32_32x32x16_bf16 v[192:207], v[224:227], v[104:107], v[192:207]
    v_cmp_ne_u32 vcc, 0, v9
    ds_read_b64_tr_b16 v[252:253], v12 offset:7264
    ds_read_b64_tr_b16 v[254:255], v12 offset:7520
    v_mfma_f32_32x32x16_bf16 v[176:191], v[228:231], v[104:107], v[176:191]
    s_cbranch_vccnz L_rt_40
L_ok_41:
    s_add_u32 m0, s40, 2048
    s_add_u32 s39, s38, 53248
    s_waitcnt vmcnt(14)
    s_barrier
    ds_read_b64_tr_b16 v[224:225], v12 offset:8192
    ds_read_b64_tr_b16 v[226:227], v12 offset:8448
    s_waitcnt lgkmcnt(10)
    v_mfma_f32_32x32x16_bf16 v[144:159], v[232:235], v[104:107], v[144:159]
    buffer_load_dwordx4 v6, s[8:11], s39 offen sc1 lds
    ds_read_b64_tr_b16 v[228:229], v12 offset:8224
    ds_read_b64_tr_b16 v[230:231], v12 offset:8480
    v_mfma_f32_32x32x16_bf16 v[160:175], v[236:239], v[104:107], v[160:175]
    s_add_u32 s56, s51, 16384
    buffer_load_dwordx4 a[88:91], v6, s[8:11], s56 offen offset:0 sc1
    s_add_u32 m0, s40, 3072
    s_add_u32 s39, s38, 57344
    ds_read_b64_tr_b16 v[232:233], v12 offset:8256
    ds_read_b64_tr_b16 v[234:235], v12 offset:8512
    s_waitcnt lgkmcnt(10)
    v_mfma_f32_32x32x16_bf16 v[192:207], v[240:243], v[108:111], v[192:207]
    buffer_load_dwordx4 v6, s[8:11], s39 offen sc1 lds
    ds_read_b64_tr_b16 v[236:237], v12 offset:8288
    ds_read_b64_tr_b16 v[238:239], v12 offset:8544
    v_mfma_f32_32x32x16_bf16 v[176:191], v[244:247], v[108:111], v[176:191]
    s_add_u32 m0, s40, 4096
    s_add_u32 s39, s38, 61440
    ds_read_b64_tr_b16 v[240:241], v12 offset:9216
    ds_read_b64_tr_b16 v[242:243], v12 offset:9472
    s_waitcnt lgkmcnt(10)
    v_mfma_f32_32x32x16_bf16 v[144:159], v[248:251], v[108:111], v[144:159]
    buffer_load_dwordx4 v6, s[8:11], s39 offen sc1 lds
    ds_read_b64_tr_b16 v[244:245], v12 offset:9248
    ds_read_b64_tr_b16 v[246:247], v12 offset:9504
    v_mfma_f32_32x32x16_bf16 v[160:175], v[252:255], v[108:111], v[160:175]
    buffer_load_dwordx4 a[92:95], v6, s[8:11], s56 offen offset:1024 sc1
    ds_read_b64_tr_b16 v[248:249], v12 offset:9280
    ds_read_b64_tr_b16 v[250:251], v12 offset:9536
    s_waitcnt lgkmcnt(10)
    v_mfma_f32_32x32x16_bf16 v[192:207], v[224:227], v[112:115], v[192:207]
    ds_read_b64_tr_b16 v[252:253], v12 offset:9312
    ds_read_b64_tr_b16 v[254:255], v12 offset:9568
    v_mfma_f32_32x32x16_bf16 v[176:191], v[228:231], v[112:115], v[176:191]
    ds_read_b64_tr_b16 v[224:225], v12 offset:10240
    ds_read_b64_tr_b16 v[226:227], v12 offset:10496
    s_waitcnt lgkmcnt(10)
    v_mfma_f32_32x32x16_bf16 v[144:159], v[232:235], v[112:115], v[144:159]
    ds_read_b64_tr_b16 v[228:229], v12 offset:10272
    ds_read_b64_tr_b16 v[230:231], v12 offset:10528
    v_mfma_f32_32x32x16_bf16 v[160:175], v[236:239], v[112:115], v[160:175]
    ds_read_b64_tr_b16 v[232:233], v12 offset:10304
    ds_read_b64_tr_b16 v[234:235], v12 offset:10560
    s_waitcnt lgkmcnt(10)
    v_mfma_f32_32x32x16_bf16 v[192:207], v[240:243], v[116:119], v[192:207]
    s_add_u32 s56, s42, 24576
    buffer_load_dwordx4 a[96:99], v6, s[8:11], s56 offen offset:0 sc1
    ds_read_b64_tr_b16 v[236:237], v12 offset:10336
    ds_read_b64_tr_b16 v[238:239], v12 offset:10592
    v_mfma_f32_32x32x16_bf16 v[176:191], v[244:247], v[116:119], v[176:191]
    s_waitcnt vmcnt(18)
    ds_read_b64_tr_b16 v[240:241], v12 offset:11264
    ds_read_b64_tr_b16 v[242:243], v12 offset:11520
    s_waitcnt lgkmcnt(10)
    v_mfma_f32_32x32x16_bf16 v[144:159], v[248:251], v[116:119], v[144:159]
    v_or3_b32 v9, v128, v132, v136
    v_or_b32 v9, v9, v140
    ds_read_b64_tr_b16 v[244:245], v12 offset:11296
    ds_read_b64_tr_b16 v[246:247], v12 offset:11552
    v_mfma_f32_32x32x16_bf16 v[160:175], v[252:255], v[116:119], v[160:175]
    v_and_b32 v9, 1, v9
    ds_read_b64_tr_b16 v[248:249], v12 offset:11328
    ds_read_b64_tr_b16 v[250:251], v12 offset:11584
    s_waitcnt lgkmcnt(10)
    v_mfma_f32_32x32x16_bf16 v[192:207], v[224:227], v[120:123], v[192:207]
    v_cmp_ne_u32 vcc, 0, v9
    buffer_load_dwordx4 a[100:103], v6, s[8:11], s56 offen offset:1024 sc1
    ds_read_b64_tr_b16 v[252:253], v12 offset:11360
    ds_read_b64_tr_b16 v[254:255], v12 offset:11616
    v_mfma_f32_32x32x16_bf16 v[176:191], v[228:231], v[120:123], v[176:191]
    s_cbranch_vccnz L_rt_42
L_ok_43:
    s_waitcnt vmcnt(12)
    s_barrier
    ds_read_b64_tr_b16 v[224:225], v12 offset:12288
    ds_read_b64_tr_b16 v[226:227], v12 offset:12544
    s_waitcnt lgkmcnt(10)
    v_mfma_f32_32x32x16_bf16 v[144:159], v[232:235], v[120:123], v[144:159]
    ds_read_b64_tr_b16 v[228:229], v12 offset:12320
    ds_read_b64_tr_b16 v[230:231], v12 offset:12576
    v_mfma_f32_32x32x16_bf16 v[160:175], v[236:239], v[120:123], v[160:175]
    ds_read_b64_tr_b16 v[232:233], v12 offset:12352
    ds_read_b64_tr_b16 v[234:235], v12 offset:12608
    s_waitcnt lgkmcnt(10)
    v_mfma_f32_32x32x16_bf16 v[192:207], v[240:243], v[124:127], v[192:207]
    s_add_u32 s56, s43, 24576
    buffer_load_dwordx4 a[104:107], v6, s[8:11], s56 offen offset:0 sc1
    ds_read_b64_tr_b16 v[236:237], v12 offset:12384
    ds_read_b64_tr_b16 v[238:239], v12 offset:12640
    v_mfma_f32_32x32x16_bf16 v[176:191], v[244:247], v[124:127], v[176:191]
    ds_read_b64_tr_b16 v[240:241], v12 offset:13312
    ds_read_b64_tr_b16 v[242:243], v12 offset:13568
    s_waitcnt lgkmcnt(10)
    v_mfma_f32_32x32x16_bf16 v[144:159], v[248:251], v[124:127], v[144:159]
    ds_read_b64_tr_b16 v[244:245], v12 offset:13344
    ds_read_b64_tr_b16 v[246:247], v12 offset:13600
    v_mfma_f32_32x32x16_bf16 v[160:175], v[252:255], v[124:127], v[160:175]
    ds_read_b64_tr_b16 v[248:249], v12 offset:13376
    ds_read_b64_tr_b16 v[250:251], v12 offset:13632
    s_waitcnt lgkmcnt(10)
    v_mfma_f32_32x32x16_bf16 v[192:207], v[224:227], v[128:131], v[192:207]
    buffer_load_dwordx4 a[108:111], v6, s[8:11], s56 offen offset:1024 sc1
    ds_read_b64_tr_b16 v[252:253], v12 offset:13408
    ds_read_b64_tr_b16 v[254:255], v12 offset:13664
    v_mfma_f32_32x32x16_bf16 v[176:191], v[228:231], v[128:131], v[176:191]
    ds_read_b64_tr_b16 v[224:225], v12 offset:14336
    ds_read_b64_tr_b16 v[226:227], v12 offset:14592
    s_waitcnt lgkmcnt(10)
    v_mfma_f32_32x32x16_bf16 v[144:159], v[232:235], v[128:131], v[144:159]
    ds_read_b64_tr_b16 v[228:229], v12 offset:14368
    ds_read_b64_tr_b16 v[230:231], v12 offset:14624
    v_mfma_f32_32x32x16_bf16 v[160:175], v[236:239], v[128:131], v[160:175]
    ds_read_b64_tr_b16 v[232:233], v12 offset:14400
    ds_read_b64_tr_b16 v[234:235], v12 offset:14656
    s_waitcnt lgkmcnt(10)
    v_mfma_f32_32x32x16_bf16 v[192:207], v[240:243], v[132:135], v[192:207]
    s_add_u32 s56, s49, 24576
    buffer_load_dwordx4 a[112:115], v6, s[8:11], s56 offen offset:0 sc1
    ds_read_b64_tr_b16 v[236:237], v12 offset:14432
    ds_read_b64_tr_b16 v[238:239], v12 offset:14688
    v_mfma_f32_32x32x16_bf16 v[176:191], v[244:247], v[132:135], v[176:191]
    ds_read_b64_tr_b16 v[240:241], v12 offset:15360
    ds_read_b64_tr_b16 v[242:243], v12 offset:15616
    s_waitcnt lgkmcnt(10)
    v_mfma_f32_32x32x16_bf16 v[144:159], v[248:251], v[132:135], v[144:159]
    ds_read_b64_tr_b16 v[244:245], v12 offset:15392
    ds_read_b64_tr_b16 v[246:247], v12 offset:15648
    v_mfma_f32_32x32x16_bf16 v[160:175], v[252:255], v[132:135], v[160:175]
    ds_read_b64_tr_b16 v[248:249], v12 offset:15424
    ds_read_b64_tr_b16 v[250:251], v12 offset:15680
    s_waitcnt lgkmcnt(10)
    v_mfma_f32_32x32x16_bf16 v[192:207], v[224:227], v[136:139], v[192:207]
    ds_read_b64_tr_b16 v[252:253], v12 offset:15456
    ds_read_b64_tr_b16 v[254:255], v12 offset:15712
    v_mfma_f32_32x32x16_bf16 v[176:191], v[228:231], v[136:139], v[176:191]
    buffer_load_dwordx4 a[116:119], v6, s[8:11], s56 offen offset:1024 sc1
    ds_read_b64_tr_b16 v[224:225], v12 offset:24576
    ds_read_b64_tr_b16 v[226:227], v12 offset:24832
    s_waitcnt lgkmcnt(10)
    v_mfma_f32_32x32x16_bf16 v[144:159], v[232:235], v[136:139], v[144:159]
    ds_read_b64_tr_b16 v[228:229], v12 offset:24640
    ds_read_b64_tr_b16 v[230:231], v12 offset:24896
    v_mfma_f32_32x32x16_bf16 v[160:175], v[236:239], v[136:139], v[160:175]
    ds_read_b64_tr_b16 v[232:233], v12 offset:25600
    ds_read_b64_tr_b16 v[234:235], v12 offset:25856
    s_waitcnt lgkmcnt(10)
    v_mfma_f32_32x32x16_bf16 v[192:207], v[240:243], v[140:143], v[192:207]
    ds_read_b64_tr_b16 v[236:237], v12 offset:25664
    ds_read_b64_tr_b16 v[238:239], v12 offset:25920
    v_mfma_f32_32x32x16_bf16 v[176:191], v[244:247], v[140:143], v[176:191]
    s_add_u32 s56, s51, 24576
    buffer_load_dwordx4 a[120:123], v6, s[8:11], s56 offen offset:0 sc1
    ds_read_b64_tr_b16 v[240:241], v12 offset:26624
    ds_read_b64_tr_b16 v[242:243], v12 offset:26880
    s_waitcnt lgkmcnt(10)
    v_mfma_f32_32x32x16_bf16 v[144:159], v[248:251], v[140:143], v[144:159]
    ds_read_b64_tr_b16 v[244:245], v12 offset:26688
    ds_read_b64_tr_b16 v[246:247], v12 offset:26944
    v_mfma_f32_32x32x16_bf16 v[160:175], v[252:255], v[140:143], v[160:175]
    ds_read_b64_tr_b16 v[248:249], v12 offset:27648
    ds_read_b64_tr_b16 v[250:251], v12 offset:27904
    s_waitcnt lgkmcnt(10)
    v_mfma_f32_32x32x16_bf16 v[208:223], v[224:227], v[16:19], 0
    ds_read_b64_tr_b16 v[252:253], v12 offset:27712
    ds_read_b64_tr_b16 v[254:255], v12 offset:27968
    v_mfma_f32_32x32x16_bf16 v[208:223], v[228:231], v[20:23], v[208:223]
    buffer_load_dwordx4 a[124:127], v6, s[8:11], s56 offen offset:1024 sc1
    ds_read_b64_tr_b16 v[224:225], v12 offset:28672
    ds_read_b64_tr_b16 v[226:227], v12 offset:28928
    s_waitcnt lgkmcnt(10)
    v_mfma_f32_32x32x16_bf16 v[208:223], v[232:235], v[24:27], v[208:223]
    v_max_f32 v192, 0, v192
    v_max_f32 v193, 0, v193
    ds_read_b64_tr_b16 v[228:229], v12 offset:28736
    ds_read_b64_tr_b16 v[230:231], v12 offset:28992
    v_mfma_f32_32x32x16_bf16 v[208:223], v[236:239], v[28:31], v[208:223]
    v_max_f32 v194, 0, v194
    v_max_f32 v195, 0, v195
    v_max_f32 v196, 0, v196
    ds_read_b64_tr_b16 v[232:233], v12 offset:29696
    ds_read_b64_tr_b16 v[234:235], v12 offset:29952
    s_waitcnt lgkmcnt(10)
    v_mfma_f32_32x32x16_bf16 v[208:223], v[240:243], v[32:35], v[208:223]
    v_max_f32 v197, 0, v197
    v_max_f32 v198, 0, v198
    ds_read_b64_tr_b16 v[236:237], v12 offset:29760
    ds_read_b64_tr_b16 v[238:239], v12 offset:30016
    v_mfma_f32_32x32x16_bf16 v[208:223], v[244:247], v[36:39], v[208:223]
    s_add_u32 s56, s42, 32768
    buffer_load_dwordx4 a[128:131], v6, s[8:11], s56 offen offset:0 sc1
    v_max_f32 v199, 0, v199
    v_mul_f32 v192, v192, v200
    v_mul_f32 v193, v193, v201
    ds_read_b64_tr_b16 v[240:241], v12 offset:30720
    ds_read_b64_tr_b16 v[242:243], v12 offset:30976
    s_waitcnt lgkmcnt(10)
    v_mfma_f32_32x32x16_bf16 v[208:223], v[248:251], v[40:43], v[208:223]
    v_mul_f32 v194, v194, v202
    v_mul_f32 v195, v195, v203
    ds_read_b64_tr_b16 v[244:245], v12 offset:30784
    ds_read_b64_tr_b16 v[246:247], v12 offset:31040
    v_mfma_f32_32x32x16_bf16 v[208:223], v[252:255], v[44:47], v[208:223]
    v_mul_f32 v196, v196, v204
    v_mul_f32 v197, v197, v205
    v_mul_f32 v198, v198, v206
    ds_read_b64_tr_b16 v[248:249], v12 offset:31744
    ds_read_b64_tr_b16 v[250:251], v12 offset:32000
    s_waitcnt lgkmcnt(10)
    v_mfma_f32_32x32x16_bf16 v[208:223], v[224:227], v[48:51], v[208:223]
    v_mul_f32 v199, v199, v207
    v_cvt_pk_bf16_f32 v200, v192, v193
    ds_read_b64_tr_b16 v[252:253], v12 offset:31808
    ds_read_b64_tr_b16 v[254:255], v12 offset:32064
    v_mfma_f32_32x32x16_bf16 v[208:223], v[228:231], v[52:55], v[208:223]
    buffer_load_dwordx4 a[132:135], v6, s[8:11], s56 offen offset:1024 sc1
    v_cvt_pk_bf16_f32 v201, v194, v195
    v_cvt_pk_bf16_f32 v202, v196, v197
    v_cvt_pk_bf16_f32 v203, v198, v199
    ds_read_b64_tr_b16 v[224:225], v12 offset:32768
    ds_read_b64_tr_b16 v[226:227], v12 offset:33024
    s_waitcnt lgkmcnt(10)
    v_mfma_f32_32x32x16_bf16 v[208:223], v[232:235], v[56:59], v[208:223]
    v_add_u32 v200, 0x20002, v200
    v_add_u32 v201, 0x20002, v201
    ds_read_b64_tr_b16 v[228:229], v12 offset:32832
    ds_read_b64_tr_b16 v[230:231], v12 offset:33088
    v_mfma_f32_32x32x16_bf16 v[208:223], v[236:239], v[60:63], v[208:223]
    v_bfi_b32 v200, s92, v14, v200
    v_bfi_b32 v201, s92, v15, v201
    buffer_store_dwordx4 v[200:203], v6, s[8:11], s45 offen offset:0 sc1
    ds_read_b64_tr_b16 v[232:233], v12 offset:33792
    ds_read_b64_tr_b16 v[234:235], v12 offset:34048
    s_waitcnt lgkmcnt(10)
    v_mfma_f32_32x32x16_bf16 v[208:223], v[240:243], v[64:67], v[208:223]
    v_max_f32 v176, 0, v176
    v_max_f32 v177, 0, v177
    ds_read_b64_tr_b16 v[236:237], v12 offset:33856
    ds_read_b64_tr_b16 v[238:239], v12 offset:34112
    v_mfma_f32_32x32x16_bf16 v[208:223], v[244:247], v[68:71], v[208:223]
    v_max_f32 v178, 0, v178
    v_max_f32 v179, 0, v179
    v_max_f32 v180, 0, v180
    ds_read_b64_tr_b16 v[240:241], v12 offset:34816
    ds_read_b64_tr_b16 v[242:243], v12 offset:35072
    s_waitcnt lgkmcnt(10)
    v_mfma_f32_32x32x16_bf16 v[208:223], v[248:251], v[72:75], v[208:223]
    s_add_u32 s56, s43, 32768
    buffer_load_dwordx4 a[136:139], v6, s[8:11], s56 offen offset:0 sc1
    v_max_f32 v181, 0, v181
    v_max_f32 v182, 0, v182
    ds_read_b64_tr_b16 v[244:245], v12 offset:34880
    ds_read_b64_tr_b16 v[246:247], v12 offset:35136
    v_mfma_f32_32x32x16_bf16 v[208:223], v[252:255], v[76:79], v[208:223]
    v_max_f32 v183, 0, v183
    v_mul_f32 v176, v176, v184
    v_mul_f32 v177, v177, v185
    s_waitcnt vmcnt(13)
    s_barrier
    ds_read_b64_tr_b16 v[248:249], v12 offset:0
    ds_read_b64_tr_b16 v[250:251], v12 offset:256
    s_waitcnt lgkmcnt(10)
    v_mfma_f32_32x32x16_bf16 v[208:223], v[224:227], v[80:83], v[208:223]
    v_mul_f32 v178, v178, v186
    v_mul_f32 v179, v179, v187
    ds_read_b64_tr_b16 v[252:253], v12 offset:64
    ds_read_b64_tr_b16 v[254:255], v12 offset:320
    v_mfma_f32_32x32x16_bf16 v[208:223], v[228:231], v[84:87], v[208:223]
    v_mul_f32 v180, v180, v188
    v_mul_f32 v181, v181, v189
    v_mul_f32 v182, v182, v190
    ds_read_b64_tr_b16 v[224:225], v12 offset:1024
    ds_read_b64_tr_b16 v[226:227], v12 offset:1280
    s_waitcnt lgkmcnt(10)
    v_mfma_f32_32x32x16_bf16 v[208:223], v[232:235], v[88:91], v[208:223]
    buffer_load_dwordx4 a[140:143], v6, s[8:11], s56 offen offset:1024 sc1
    v_mul_f32 v183, v183, v191
    v_cvt_pk_bf16_f32 v184, v176, v177
    ds_read_b64_tr_b16 v[228:229], v12 offset:1088
    ds_read_b64_tr_b16 v[230:231], v12 offset:1344
    v_mfma_f32_32x32x16_bf16 v[208:223], v[236:239], v[92:95], v[208:223]
    v_cvt_pk_bf16_f32 v185, v178, v179
    v_cvt_pk_bf16_f32 v186, v180, v181
    v_cvt_pk_bf16_f32 v187, v182, v183
    ds_read_b64_tr_b16 v[232:233], v12 offset:2048
    ds_read_b64_tr_b16 v[234:235], v12 offset:2304
    s_waitcnt lgkmcnt(10)
    v_mfma_f32_32x32x16_bf16 v[208:223], v[240:243], v[96:99], v[208:223]
    v_add_u32 v184, 0x20002, v184
    v_add_u32 v185, 0x20002, v185
    ds_read_b64_tr_b16 v[236:237], v12 offset:2112
    ds_read_b64_tr_b16 v[238:239], v12 offset:2368
    v_mfma_f32_32x32x16_bf16 v[208:223], v[244:247], v[100:103], v[208:223]
    v_bfi_b32 v184, s92, v14, v184
    v_bfi_b32 v185, s92, v15, v185
    buffer_store_dwordx4 v[184:187], v6, s[8:11], s45 offen offset:1024 sc1
    ds_read_b64_tr_b16 v[240:241], v12 offset:3072
    ds_read_b64_tr_b16 v[242:243], v12 offset:3328
    s_waitcnt lgkmcnt(10)
    v_mfma_f32_32x32x16_bf16 v[208:223], v[248:251], v[104:107], v[208:223]
    s_add_u32 s56, s49, 32768
    buffer_load_dwordx4 a[144:147], v6, s[8:11], s56 offen offset:0 sc1
    v_max_f32 v144, 0, v144
    v_max_f32 v145, 0, v145
    ds_read_b64_tr_b16 v[244:245], v12 offset:3136
    ds_read_b64_tr_b16 v[246:247], v12 offset:3392
    v_mfma_f32_32x32x16_bf16 v[208:223], v[252:255], v[108:111], v[208:223]
    v_max_f32 v146, 0, v146
    v_max_f32 v147, 0, v147
    v_max_f32 v148, 0, v148
    ds_read_b64_tr_b16 v[248:249], v12 offset:4096
    ds_read_b64_tr_b16 v[250:251], v12 offset:4352
    s_waitcnt lgkmcnt(10)
    v_mfma_f32_32x32x16_bf16 v[208:223], v[224:227], v[112:115], v[208:223]
    v_max_f32 v149, 0, v149
    v_max_f32 v150, 0, v150
    ds_read_b64_tr_b16 v[252:253], v12 offset:4160
    ds_read_b64_tr_b16 v[254:255], v12 offset:4416
    v_mfma_f32_32x32x16_bf16 v[208:223], v[228:231], v[116:119], v[208:223]
    v_max_f32 v151, 0, v151
    v_mul_f32 v144, v144, v152
    v_mul_f32 v145, v145, v153
    ds_read_b64_tr_b16 v[224:225], v12 offset:24608
    ds_read_b64_tr_b16 v[226:227], v12 offset:24864
    s_waitcnt lgkmcnt(10)
    v_mfma_f32_32x32x16_bf16 v[208:223], v[232:235], v[120:123], v[208:223]
    buffer_load_dwordx4 a[148:151], v6, s[8:11], s56 offen offset:1024 sc1
    v_mul_f32 v146, v146, v154
    v_mul_f32 v147, v147, v155
    ds_read_b64_tr_b16 v[228:229], v12 offset:24672
    ds_read_b64_tr_b16 v[230:231], v12 offset:24928
    v_mfma_f32_32x32x16_bf16 v[208:223], v[236:239], v[124:127], v[208:223]
    v_mul_f32 v148, v148, v156
    v_mul_f32 v149, v149, v157
    v_mul_f32 v150, v150, v158
    ds_read_b64_tr_b16 v[232:233], v12 offset:25632
    ds_read_b64_tr_b16 v[234:235], v12 offset:25888
    s_waitcnt lgkmcnt(10)
    v_mfma_f32_32x32x16_bf16 v[208:223], v[240:243], v[128:131], v[208:223]
    v_mul_f32 v151, v151, v159
    v_cvt_pk_bf16_f32 v152, v144, v145
    ds_read_b64_tr_b16 v[236:237], v12 offset:25696
    ds_read_b64_tr_b16 v[238:239], v12 offset:25952
    v_mfma_f32_32x32x16_bf16 v[208:223], v[244:247], v[132:135], v[208:223]
    v_cvt_pk_bf16_f32 v153, v146, v147
    v_cvt_pk_bf16_f32 v154, v148, v149
    v_cvt_pk_bf16_f32 v155, v150, v151
    ds_read_b64_tr_b16 v[240:241], v12 offset:26656
    ds_read_b64_tr_b16 v[242:243], v12 offset:26912
    s_waitcnt lgkmcnt(10)
    v_mfma_f32_32x32x16_bf16 v[208:223], v[248:251], v[136:139], v[208:223]
    s_add_u32 s56, s51, 32768
    buffer_load_dwordx4 a[152:155], v6, s[8:11], s56 offen offset:0 sc1
    v_add_u32 v152, 0x20002, v152
    v_add_u32 v153, 0x20002, v153
    ds_read_b64_tr_b16 v[244:245], v12 offset:26720
    ds_read_b64_tr_b16 v[246:247], v12 offset:26976
    v_mfma_f32_32x32x16_bf16 v[208:223], v[252:255], v[140:143], v[208:223]
    v_bfi_b32 v152, s92, v14, v152
    v_bfi_b32 v153, s92, v15, v153
    buffer_store_dwordx4 v[152:155], v6, s[8:11], s45 offen offset:2048 sc1
    ds_read_b64_tr_b16 v[248:249], v12 offset:27680
    ds_read_b64_tr_b16 v[250:251], v12 offset:27936
    s_waitcnt lgkmcnt(10)
    v_mfma_f32_32x32x16_bf16 v[192:207], v[224:227], v[16:19], 0
    v_max_f32 v160, 0, v160
    v_max_f32 v161, 0, v161
    ds_read_b64_tr_b16 v[252:253], v12 offset:27744
    ds_read_b64_tr_b16 v[254:255], v12 offset:28000
    v_mfma_f32_32x32x16_bf16 v[192:207], v[228:231], v[20:23], v[192:207]
    v_max_f32 v162, 0, v162
    v_max_f32 v163, 0, v163
    v_max_f32 v164, 0, v164
    ds_read_b64_tr_b16 v[224:225], v12 offset:28704
    ds_read_b64_tr_b16 v[226:227], v12 offset:28960
    s_waitcnt lgkmcnt(10)
    v_mfma_f32_32x32x16_bf16 v[192:207], v[232:235], v[24:27], v[192:207]
    v_max_f32 v165, 0, v165
    v_max_f32 v166, 0, v166
    ds_read_b64_tr_b16 v[228:229], v12 offset:28768
    ds_read_b64_tr_b16 v[230:231], v12 offset:29024
    v_mfma_f32_32x32x16_bf16 v[192:207], v[236:239], v[28:31], v[192:207]
    buffer_load_dwordx4 a[156:159], v6, s[8:11], s56 offen offset:1024 sc1
    v_max_f32 v167, 0, v167
    v_mul_f32 v160, v160, v168
    v_mul_f32 v161, v161, v169
    ds_read_b64_tr_b16 v[232:233], v12 offset:29728
    ds_read_b64_tr_b16 v[234:235], v12 offset:29984
    s_waitcnt lgkmcnt(10)
    v_mfma_f32_32x32x16_bf16 v[192:207], v[240:243], v[32:35], v[192:207]
    v_mul_f32 v162, v162, v170
    v_mul_f32 v163, v163, v171
    ds_read_b64_tr_b16 v[236:237], v12 offset:29792
    ds_read_b64_tr_b16 v[238:239], v12 offset:30048
    v_mfma_f32_32x32x16_bf16 v[192:207], v[244:247], v[36:39], v[192:207]
    v_mul_f32 v164, v164, v172
    v_mul_f32 v165, v165, v173
    v_mul_f32 v166, v166, v174
    ds_read_b64_tr_b16 v[240:241], v12 offset:30752
    ds_read_b64_tr_b16 v[242:243], v12 offset:31008
    s_waitcnt lgkmcnt(10)
    v_mfma_f32_32x32x16_bf16 v[192:207], v[248:251], v[40:43], v[192:207]
    v_mul_f32 v167, v167, v175
    v_cvt_pk_bf16_f32 v168, v160, v161
    ds_read_b64_tr_b16 v[244:245], v12 offset:30816
    ds_read_b64_tr_b16 v[246:247], v12 offset:31072
    v_mfma_f32_32x32x16_bf16 v[192:207], v[252:255], v[44:47], v[192:207]
    s_add_u32 s56, s42, 40960
    buffer_load_dwordx4 a[160:163], v6, s[8:11], s56 offen offset:0 sc1
    v_cvt_pk_bf16_f32 v169, v162, v163
    v_cvt_pk_bf16_f32 v170, v164, v165
    v_cvt_pk_bf16_f32 v171, v166, v167
    ds_read_b64_tr_b16 v[248:249], v12 offset:31776
    ds_read_b64_tr_b16 v[250:251], v12 offset:32032
    s_waitcnt lgkmcnt(10)
    v_mfma_f32_32x32x16_bf16 v[192:207], v[224:227], v[48:51], v[192:207]
    v_add_u32 v168, 0x20002, v168
    v_add_u32 v169, 0x20002, v169
    ds_read_b64_tr_b16 v[252:253], v12 offset:31840
    ds_read_b64_tr_b16 v[254:255], v12 offset:32096
    v_mfma_f32_32x32x16_bf16 v[192:207], v[228:231], v[52:55], v[192:207]
    v_bfi_b32 v168, s92, v14, v168
    v_bfi_b32 v169, s92, v15, v169
    buffer_store_dwordx4 v[168:171], v6, s[8:11], s45 offen offset:3072 sc1
    ds_read_b64_tr_b16 v[224:225], v12 offset:32800
    ds_read_b64_tr_b16 v[226:227], v12 offset:33056
    s_waitcnt lgkmcnt(10)
    v_mfma_f32_32x32x16_bf16 v[192:207], v[232:235], v[56:59], v[192:207]
    v_max_f32 v208, 0, v208
    v_max_f32 v209, 0, v209
    ds_read_b64_tr_b16 v[228:229], v12 offset:32864
    ds_read_b64_tr_b16 v[230:231], v12 offset:33120
    v_mfma_f32_32x32x16_bf16 v[192:207], v[236:239], v[60:63], v[192:207]
    buffer_load_dwordx4 a[164:167], v6, s[8:11], s56 offen offset:1024 sc1
    v_max_f32 v210, 0, v210
    v_max_f32 v211, 0, v211
    v_max_f32 v212, 0, v212
    ds_read_b64_tr_b16 v[232:233], v12 offset:33824
    ds_read_b64_tr_b16 v[234:235], v12 offset:34080
    s_waitcnt lgkmcnt(10)
    v_mfma_f32_32x32x16_bf16 v[192:207], v[240:243], v[64:67], v[192:207]
    v_max_f32 v213, 0, v213
    v_max_f32 v214, 0, v214
    ds_read_b64_tr_b16 v[236:237], v12 offset:33888
    ds_read_b64_tr_b16 v[238:239], v12 offset:34144
    v_mfma_f32_32x32x16_bf16 v[192:207], v[244:247], v[68:71], v[192:207]
    v_max_f32 v215, 0, v215
    v_mul_f32 v208, v208, v216
    v_mul_f32 v209, v209, v217
    ds_read_b64_tr_b16 v[240:241], v12 offset:34848
    ds_read_b64_tr_b16 v[242:243], v12 offset:35104
    s_waitcnt lgkmcnt(10)
    v_mfma_f32_32x32x16_bf16 v[192:207], v[248:251], v[72:75], v[192:207]
    v_mul_f32 v210, v210, v218
    v_mul_f32 v211, v211, v219
    ds_read_b64_tr_b16 v[244:245], v12 offset:34912
    ds_read_b64_tr_b16 v[246:247], v12 offset:35168
    v_mfma_f32_32x32x16_bf16 v[192:207], v[252:255], v[76:79], v[192:207]
    s_add_u32 s56, s43, 40960
    buffer_load_dwordx4 a[168:171], v6, s[8:11], s56 offen offset:0 sc1
    v_mul_f32 v212, v212, v220
    v_mul_f32 v213, v213, v221
    v_mul_f32 v214, v214, v222
    ds_read_b64_tr_b16 v[248:249], v12 offset:32
    ds_read_b64_tr_b16 v[250:251], v12 offset:288
    s_waitcnt lgkmcnt(10)
    v_mfma_f32_32x32x16_bf16 v[192:207], v[224:227], v[80:83], v[192:207]
    v_mul_f32 v215, v215, v223
    v_cvt_pk_bf16_f32 v216, v208, v209
    ds_read_b64_tr_b16 v[252:253], v12 offset:96
    ds_read_b64_tr_b16 v[254:255], v12 offset:352
    v_mfma_f32_32x32x16_bf16 v[192:207], v[228:231], v[84:87], v[192:207]
    v_cvt_pk_bf16_f32 v217, v210, v211
    v_cvt_pk_bf16_f32 v218, v212, v213
    v_cvt_pk_bf16_f32 v219, v214, v215
    ds_read_b64_tr_b16 v[224:225], v12 offset:1056
    ds_read_b64_tr_b16 v[226:227], v12 offset:1312
    s_waitcnt lgkmcnt(10)
    v_mfma_f32_32x32x16_bf16 v[192:207], v[232:235], v[88:91], v[192:207]
    v_add_u32 v216, 0x20002, v216
    v_add_u32 v217, 0x20002, v217
    ds_read_b64_tr_b16 v[228:229], v12 offset:1120
    ds_read_b64_tr_b16 v[230:231], v12 offset:1376
    v_mfma_f32_32x32x16_bf16 v[192:207], v[236:239], v[92:95], v[192:207]
    buffer_load_dwordx4 a[172:175], v6, s[8:11], s56 offen offset:1024 sc1
    v_bfi_b32 v216, s92, v14, v216
    v_bfi_b32 v217, s92, v15, v217
    buffer_store_dwordx4 v[216:219], v6, s[8:11], s46 offen offset:0 sc1
    ds_read_b64_tr_b16 v[232:233], v12 offset:2080
    ds_read_b64_tr_b16 v[234:235], v12 offset:2336
    s_waitcnt lgkmcnt(10)
    v_mfma_f32_32x32x16_bf16 v[192:207], v[240:243], v[96:99], v[192:207]
    ds_read_b64_tr_b16 v[236:237], v12 offset:2144
    ds_read_b64_tr_b16 v[238:239], v12 offset:2400
    v_mfma_f32_32x32x16_bf16 v[192:207], v[244:247], v[100:103], v[192:207]
    ds_read_b64_tr_b16 v[240:241], v12 offset:3104
    ds_read_b64_tr_b16 v[242:243], v12 offset:3360
    s_waitcnt lgkmcnt(10)
    v_mfma_f32_32x32x16_bf16 v[192:207], v[248:251], v[104:107], v[192:207]
    ds_read_b64_tr_b16 v[244:245], v12 offset:3168
    ds_read_b64_tr_b16 v[246:247], v12 offset:3424
    v_mfma_f32_32x32x16_bf16 v[192:207], v[252:255], v[108:111], v[192:207]
    ds_read_b64_tr_b16 v[248:249], v12 offset:4128
    ds_read_b64_tr_b16 v[250:251], v12 offset:4384
    s_waitcnt lgkmcnt(10)
    v_mfma_f32_32x32x16_bf16 v[192:207], v[224:227], v[112:115], v[192:207]
    s_add_u32 s56, s49, 40960
    buffer_load_dwordx4 a[176:179], v6, s[8:11], s56 offen offset:0 sc1
    ds_read_b64_tr_b16 v[252:253], v12 offset:4192
    ds_read_b64_tr_b16 v[254:255], v12 offset:4448
    v_mfma_f32_32x32x16_bf16 v[192:207], v[228:231], v[116:119], v[192:207]
    buffer_load_dwordx4 v[144:147], v6, s[8:11], s28 offen offset:0 sc1
    ds_read_b64_tr_b16 v[224:225], v12 offset:16384
    ds_read_b64_tr_b16 v[226:227], v12 offset:16640
    s_waitcnt lgkmcnt(10)
    v_mfma_f32_32x32x16_bf16 v[192:207], v[232:235], v[120:123], v[192:207]
    ds_read_b64_tr_b16 v[228:229], v12 offset:16416
    ds_read_b64_tr_b16 v[230:231], v12 offset:16672
    v_mfma_f32_32x32x16_bf16 v[192:207], v[236:239], v[124:127], v[192:207]
    buffer_load_dwordx4 v[148:151], v6, s[8:11], s32 offen offset:0 sc1
    ds_read_b64_tr_b16 v[232:233], v12 offset:16448
    ds_read_b64_tr_b16 v[234:235], v12 offset:16704
    s_waitcnt lgkmcnt(10)
    v_mfma_f32_32x32x16_bf16 v[192:207], v[240:243], v[128:131], v[192:207]
    buffer_load_dwordx4 a[180:183], v6, s[8:11], s56 offen offset:1024 sc1
    ds_read_b64_tr_b16 v[236:237], v12 offset:16480
    ds_read_b64_tr_b16 v[238:239], v12 offset:16736
    v_mfma_f32_32x32x16_bf16 v[192:207], v[244:247], v[132:135], v[192:207]
    buffer_load_dwordx4 v[152:155], v6, s[8:11], s29 offen offset:0 sc1
    ds_read_b64_tr_b16 v[240:241], v12 offset:17408
    ds_read_b64_tr_b16 v[242:243], v12 offset:17664
    s_waitcnt lgkmcnt(10)
    v_mfma_f32_32x32x16_bf16 v[192:207], v[248:251], v[136:139], v[192:207]
    ds_read_b64_tr_b16 v[244:245], v12 offset:17440
    ds_read_b64_tr_b16 v[246:247], v12 offset:17696
    v_mfma_f32_32x32x16_bf16 v[192:207], v[252:255], v[140:143], v[192:207]
    buffer_load_dwordx4 v[156:159], v6, s[8:11], s33 offen offset:0 sc1
    ds_read_b64_tr_b16 v[248:249], v12 offset:17472
    ds_read_b64_tr_b16 v[250:251], v12 offset:17728
    s_waitcnt lgkmcnt(10)
    v_mfma_f32_32x32x16_bf16 v[176:191], v[224:227], v[16:19], 0
    s_add_u32 s56, s51, 40960
    buffer_load_dwordx4 a[184:187], v6, s[8:11], s56 offen offset:0 sc1
    ds_read_b64_tr_b16 v[252:253], v12 offset:17504
    ds_read_b64_tr_b16 v[254:255], v12 offset:17760
    v_mfma_f32_32x32x16_bf16 v[176:191], v[228:231], v[20:23], v[176:191]
    buffer_load_dwordx4 v[160:163], v6, s[8:11], s30 offen offset:0 sc1
    ds_read_b64_tr_b16 v[224:225], v12 offset:18432
    ds_read_b64_tr_b16 v[226:227], v12 offset:18688
    s_waitcnt lgkmcnt(10)
    v_mfma_f32_32x32x16_bf16 v[176:191], v[232:235], v[24:27], v[176:191]
    v_max_f32 v192, 0, v192
    v_max_f32 v193, 0, v193
    ds_read_b64_tr_b16 v[228:229], v12 offset:18464
    ds_read_b64_tr_b16 v[230:231], v12 offset:18720
    v_mfma_f32_32x32x16_bf16 v[176:191], v[236:239], v[28:31], v[176:191]
    buffer_load_dwordx4 v[164:167], v6, s[8:11], s34 offen offset:0 sc1
    v_max_f32 v194, 0, v194
    v_max_f32 v195, 0, v195
    ds_read_b64_tr_b16 v[232:233], v12 offset:18496
    ds_read_b64_tr_b16 v[234:235], v12 offset:18752
    s_waitcnt lgkmcnt(10)
    v_mfma_f32_32x32x16_bf16 v[176:191], v[240:243], v[32:35], v[176:191]
    buffer_load_dwordx4 a[188:191], v6, s[8:11], s56 offen offset:1024 sc1
    v_max_f32 v196, 0, v196
    v_max_f32 v197, 0, v197
    ds_read_b64_tr_b16 v[236:237], v12 offset:18528
    ds_read_b64_tr_b16 v[238:239], v12 offset:18784
    v_mfma_f32_32x32x16_bf16 v[176:191], v[244:247], v[36:39], v[176:191]
    buffer_load_dwordx4 v[168:171], v6, s[8:11], s31 offen offset:0 sc1
    v_max_f32 v198, 0, v198
    v_max_f32 v199, 0, v199
    ds_read_b64_tr_b16 v[240:241], v12 offset:19456
    ds_read_b64_tr_b16 v[242:243], v12 offset:19712
    s_waitcnt lgkmcnt(10)
    v_mfma_f32_32x32x16_bf16 v[176:191], v[248:251], v[40:43], v[176:191]
    v_mul_f32 v192, v192, v200
    v_mul_f32 v193, v193, v201
    ds_read_b64_tr_b16 v[244:245], v12 offset:19488
    ds_read_b64_tr_b16 v[246:247], v12 offset:19744
    v_mfma_f32_32x32x16_bf16 v[176:191], v[252:255], v[44:47], v[176:191]
    buffer_load_dwordx4 v[172:175], v6, s[8:11], s35 offen offset:0 sc1
    v_mul_f32 v194, v194, v202
    v_mul_f32 v195, v195, v203
    ds_read_b64_tr_b16 v[248:249], v12 offset:19520
    ds_read_b64_tr_b16 v[250:251], v12 offset:19776
    s_waitcnt lgkmcnt(10)
    v_mfma_f32_32x32x16_bf16 v[176:191], v[224:227], v[48:51], v[176:191]
    s_add_u32 s56, s42, 49152
    buffer_load_dwordx4 a[192:195], v6, s[8:11], s56 offen offset:0 sc1
    v_mul_f32 v196, v196, v204
    v_mul_f32 v197, v197, v205
    ds_read_b64_tr_b16 v[252:253], v12 offset:19552
    ds_read_b64_tr_b16 v[254:255], v12 offset:19808
    v_mfma_f32_32x32x16_bf16 v[176:191], v[228:231], v[52:55], v[176:191]
    buffer_load_dwordx4 v[16:19], v6, s[8:11], s28 offen offset:1024 sc1
    v_mul_f32 v198, v198, v206
    v_mul_f32 v199, v199, v207
    ds_read_b64_tr_b16 v[224:225], v12 offset:20480
    ds_read_b64_tr_b16 v[226:227], v12 offset:20736
    s_waitcnt lgkmcnt(10)
    v_mfma_f32_32x32x16_bf16 v[176:191], v[232:235], v[56:59], v[176:191]
    v_cvt_pk_bf16_f32 v200, v192, v193
    v_cvt_pk_bf16_f32 v201, v194, v195
    ds_read_b64_tr_b16 v[228:229], v12 offset:20512
    ds_read_b64_tr_b16 v[230:231], v12 offset:20768
    v_mfma_f32_32x32x16_bf16 v[176:191], v[236:239], v[60:63], v[176:191]
    buffer_load_dwordx4 v[20:23], v6, s[8:11], s32 offen offset:1024 sc1
    v_cvt_pk_bf16_f32 v202, v196, v197
    v_cvt_pk_bf16_f32 v203, v198, v199
    ds_read_b64_tr_b16 v[232:233], v12 offset:20544
    ds_read_b64_tr_b16 v[234:235], v12 offset:20800
    s_waitcnt lgkmcnt(10)
    v_mfma_f32_32x32x16_bf16 v[176:191], v[240:243], v[64:67], v[176:191]
    v_add_u32 v200, 0x20002, v200
    v_add_u32 v201, 0x20002, v201
    ds_read_b64_tr_b16 v[236:237], v12 offset:20576
    ds_read_b64_tr_b16 v[238:239], v12 offset:20832
    v_mfma_f32_32x32x16_bf16 v[176:191], v[244:247], v[68:71], v[176:191]
    buffer_load_dwordx4 v[24:27], v6, s[8:11], s29 offen offset:1024 sc1
    v_bfi_b32 v200, s92, v14, v200
    v_bfi_b32 v201, s92, v15, v201
    ds_read_b64_tr_b16 v[240:241], v12 offset:21504
    ds_read_b64_tr_b16 v[242:243], v12 offset:21760
    s_waitcnt lgkmcnt(10)
    v_mfma_f32_32x32x16_bf16 v[176:191], v[248:251], v[72:75], v[176:191]
    buffer_load_dwordx4 a[196:199], v6, s[8:11], s56 offen offset:1024 sc1
    buffer_store_dwordx4 v[200:203], v6, s[8:11], s46 offen offset:1024 sc1
    ds_read_b64_tr_b16 v[244:245], v12 offset:21536
    ds_read_b64_tr_b16 v[246:247], v12 offset:21792
    v_mfma_f32_32x32x16_bf16 v[176:191], v[252:255], v[76:79], v[176:191]
    ds_read_b64_tr_b16 v[248:249], v12 offset:21568
    ds_read_b64_tr_b16 v[250:251], v12 offset:21824
    s_waitcnt lgkmcnt(10)
    v_mfma_f32_32x32x16_bf16 v[176:191], v[224:227], v[80:83], v[176:191]
    buffer_load_dwordx4 v[28:31], v6, s[8:11], s33 offen offset:1024 sc1
    ds_read_b64_tr_b16 v[252:253], v12 offset:21600
    ds_read_b64_tr_b16 v[254:255], v12 offset:21856
    v_mfma_f32_32x32x16_bf16 v[176:191], v[228:231], v[84:87], v[176:191]
    s_add_u32 s56, s43, 49152
    buffer_load_dwordx4 a[200:203], v6, s[8:11], s56 offen offset:0 sc1
    ds_read_b64_tr_b16 v[224:225], v12 offset:22528
    ds_read_b64_tr_b16 v[226:227], v12 offset:22784
    s_waitcnt lgkmcnt(10)
    v_mfma_f32_32x32x16_bf16 v[176:191], v[232:235], v[88:91], v[176:191]
    buffer_load_dwordx4 v[32:35], v6, s[8:11], s30 offen offset:1024 sc1
    ds_read_b64_tr_b16 v[228:229], v12 offset:22560
    ds_read_b64_tr_b16 v[230:231], v12 offset:22816
    v_mfma_f32_32x32x16_bf16 v[176:191], v[236:239], v[92:95], v[176:191]
    ds_read_b64_tr_b16 v[232:233], v12 offset:22592
    ds_read_b64_tr_b16 v[234:235], v12 offset:22848
    s_waitcnt lgkmcnt(10)
    v_mfma_f32_32x32x16_bf16 v[176:191], v[240:243], v[96:99], v[176:191]
    buffer_load_dwordx4 v[36:39], v6, s[8:11], s34 offen offset:1024 sc1
    ds_read_b64_tr_b16 v[236:237], v12 offset:22624
    ds_read_b64_tr_b16 v[238:239], v12 offset:22880
    v_mfma_f32_32x32x16_bf16 v[176:191], v[244:247], v[100:103], v[176:191]
    buffer_load_dwordx4 a[204:207], v6, s[8:11], s56 offen offset:1024 sc1
    ds_read_b64_tr_b16 v[240:241], v12 offset:23552
    ds_read_b64_tr_b16 v[242:243], v12 offset:23808
    s_waitcnt lgkmcnt(10)
    v_mfma_f32_32x32x16_bf16 v[176:191], v[248:251], v[104:107], v[176:191]
    buffer_load_dwordx4 v[40:43], v6, s[8:11], s31 offen offset:1024 sc1
    ds_read_b64_tr_b16 v[244:245], v12 offset:23584
    ds_read_b64_tr_b16 v[246:247], v12 offset:23840
    v_mfma_f32_32x32x16_bf16 v[176:191], v[252:255], v[108:111], v[176:191]
    ds_read_b64_tr_b16 v[248:249], v12 offset:23616
    ds_read_b64_tr_b16 v[250:251], v12 offset:23872
    s_waitcnt lgkmcnt(10)
    v_mfma_f32_32x32x16_bf16 v[176:191], v[224:227], v[112:115], v[176:191]
    s_waitcnt vmcnt(18)
    v_xor_b32 v148, v148, v14
    v_xor_b32 v149, v149, v15
    v_or_b32 v9, v148, v149
    buffer_load_dwordx4 v[44:47], v6, s[8:11], s35 offen offset:1024 sc1
    ds_read_b64_tr_b16 v[252:253], v12 offset:23648
    ds_read_b64_tr_b16 v[254:255], v12 offset:23904
    v_mfma_f32_32x32x16_bf16 v[176:191], v[228:231], v[116:119], v[176:191]
    v_xor_b32 v144, v144, v14
    v_xor_b32 v145, v145, v15
    v_or3_b32 v9, v9, v144, v145
    s_add_u32 s56, s49, 49152
    buffer_load_dwordx4 a[208:211], v6, s[8:11], s56 offen offset:0 sc1
    s_waitcnt lgkmcnt(8)
    v_mfma_f32_32x32x16_bf16 v[176:191], v[232:235], v[120:123], v[176:191]
    v_xor_b32 v156, v156, v14
    v_xor_b32 v157, v157, v15
    v_or3_b32 v9, v9, v156, v157
    v_mfma_f32_32x32x16_bf16 v[176:191], v[236:239], v[124:127], v[176:191]
    v_xor_b32 v152, v152, v14
    v_xor_b32 v153, v153, v15
    s_waitcnt lgkmcnt(4)
    v_mfma_f32_32x32x16_bf16 v[176:191], v[240:243], v[128:131], v[176:191]
    v_or3_b32 v9, v9, v152, v153
    v_and_b32 v9, 0x30003, v9
    buffer_load_dwordx4 v[48:51], v6, s[8:11], s28 offen offset:2048 sc1
    v_mfma_f32_32x32x16_bf16 v[176:191], v[244:247], v[132:135], v[176:191]
    v_cmp_ne_u32 vcc, 0, v9
    buffer_load_dwordx4 a[212:215], v6, s[8:11], s56 offen offset:1024 sc1
    s_waitcnt lgkmcnt(0)
    v_mfma_f32_32x32x16_bf16 v[176:191], v[248:251], v[136:139], v[176:191]
    s_cbranch_vccnz L_rt_44
L_ok_45:
    buffer_load_dwordx4 v[52:55], v6, s[8:11], s32 offen offset:2048 sc1
    v_mfma_f32_32x32x16_bf16 v[176:191], v[252:255], v[140:143], v[176:191]
    v_mfma_f32_32x32x16_bf16 v[192:207], a[0:3], v[148:151], 0
    s_waitcnt vmcnt(17)
    v_xor_b32 v164, v164, v14
    v_xor_b32 v165, v165, v15
    v_or_b32 v9, v164, v165
    buffer_load_dwordx4 v[56:59], v6, s[8:11], s29 offen offset:2048 sc1
    v_mfma_f32_32x32x16_bf16 v[208:223], a[4:7], v[148:151], 0
    v_xor_b32 v160, v160, v14
    v_xor_b32 v161, v161, v15
    v_or3_b32 v9, v9, v160, v161
    v_mfma_f32_32x32x16_bf16 v[224:239], a[0:3], v[144:147], 0
    v_xor_b32 v172, v172, v14
    v_xor_b32 v173, v173, v15
    v_or3_b32 v9, v9, v172, v173
    buffer_load_dwordx4 v[60:63], v6, s[8:11], s33 offen offset:2048 sc1
    v_mfma_f32_32x32x16_bf16 v[240:255], a[4:7], v[144:147], 0
    v_xor_b32 v168, v168, v14
    v_xor_b32 v169, v169, v15
    s_add_u32 s56, s51, 49152
    buffer_load_dwordx4 a[216:219], v6, s[8:11], s56 offen offset:0 sc1
    v_max_f32 v176, 0, v176
    v_max_f32 v177, 0, v177
    v_mfma_f32_32x32x16_bf16 v[192:207], a[8:11], v[156:159], v[192:207]
    v_or3_b32 v9, v9, v168, v169
    v_and_b32 v9, 0x30003, v9
    buffer_load_dwordx4 v[64:67], v6, s[8:11], s30 offen offset:2048 sc1
    v_max_f32 v178, 0, v178
    v_max_f32 v179, 0, v179
    v_mfma_f32_32x32x16_bf16 v[208:223], a[12:15], v[156:159], v[208:223]
    v_cmp_ne_u32 vcc, 0, v9
    v_max_f32 v180, 0, v180
    v_max_f32 v181, 0, v181
    v_max_f32 v182, 0, v182
    v_mfma_f32_32x32x16_bf16 v[224:239], a[8:11], v[152:155], v[224:239]
    s_cbranch_vccnz L_rt_46
L_ok_47:
    buffer_load_dwordx4 v[68:71], v6, s[8:11], s34 offen offset:2048 sc1
    v_max_f32 v183, 0, v183
    v_mul_f32 v176, v176, v184
    v_mfma_f32_32x32x16_bf16 v[240:255], a[12:15], v[152:155], v[240:255]
    buffer_load_dwordx4 a[220:223], v6, s[8:11], s56 offen offset:1024 sc1
    v_mul_f32 v177, v177, v185
    v_mul_f32 v178, v178, v186
    v_mul_f32 v179, v179, v187
    v_mul_f32 v180, v180, v188
    v_mfma_f32_32x32x16_bf16 v[192:207], a[16:19], v[164:167], v[192:207]
    s_waitcnt vmcnt(16)
    v_xor_b32 v20, v20, v14
    v_xor_b32 v21, v21, v15
    v_or_b32 v9, v20, v21
    buffer_load_dwordx4 v[72:75], v6, s[8:11], s31 offen offset:2048 sc1
    v_mul_f32 v181, v181, v189
    v_mul_f32 v182, v182, v190
    v_mfma_f32_32x32x16_bf16 v[208:223], a[20:23], v[164:167], v[208:223]
    v_xor_b32 v16, v16, v14
    v_xor_b32 v17, v17, v15
    v_or3_b32 v9, v9, v16, v17
    v_mul_f32 v183, v183, v191
    v_cvt_pk_bf16_f32 v184, v176, v177
    v_mfma_f32_32x32x16_bf16 v[224:239], a[16:19], v[160:163], v[224:239]
    v_xor_b32 v28, v28, v14
    v_xor_b32 v29, v29, v15
    v_or3_b32 v9, v9, v28, v29
    buffer_load_dwordx4 v[76:79], v6, s[8:11], s35 offen offset:2048 sc1
    v_cvt_pk_bf16_f32 v185, v178, v179
    v_cvt_pk_bf16_f32 v186, v180, v181
    v_mfma_f32_32x32x16_bf16 v[240:255], a[20:23], v[160:163], v[240:255]
    v_xor_b32 v24, v24, v14
    v_xor_b32 v25, v25, v15
    v_cvt_pk_bf16_f32 v187, v182, v183
    v_add_u32 v184, 0x20002, v184
    v_mfma_f32_32x32x16_bf16 v[192:207], a[24:27], v[172:175], v[192:207]
    v_or3_b32 v9, v9, v24, v25
    v_and_b32 v9, 0x30003, v9
    buffer_load_dwordx4 v[80:83], v6, s[8:11], s28 offen offset:3072 sc1
    v_add_u32 v185, 0x20002, v185
    v_bfi_b32 v184, s92, v14, v184
    v_mfma_f32_32x32x16_bf16 v[208:223], a[28:31], v[172:175], v[208:223]
    v_cmp_ne_u32 vcc, 0, v9
    v_bfi_b32 v185, s92, v15, v185
    buffer_store_dwordx4 v[184:187], v6, s[8:11], s46 offen offset:2048 sc1
    v_mfma_f32_32x32x16_bf16 v[224:239], a[24:27], v[168:171], v[224:239]
    s_cbranch_vccnz L_rt_48
L_ok_49:
    v_mfma_f32_32x32x16_bf16 v[240:255], a[28:31], v[168:171], v[240:255]
    buffer_load_dwordx4 v[84:87], v6, s[8:11], s32 offen offset:3072 sc1
    v_mfma_f32_32x32x16_bf16 v[192:207], a[32:35], v[20:23], v[192:207]
    s_waitcnt vmcnt(15)
    v_xor_b32 v36, v36, v14
    v_xor_b32 v37, v37, v15
    v_or_b32 v9, v36, v37
    v_mfma_f32_32x32x16_bf16 v[208:223], a[36:39], v[20:23], v[208:223]
    v_xor_b32 v32, v32, v14
    v_xor_b32 v33, v33, v15
    v_or3_b32 v9, v9, v32, v33
    buffer_load_dwordx4 v[88:91], v6, s[8:11], s29 offen offset:3072 sc1
    v_mfma_f32_32x32x16_bf16 v[224:239], a[32:35], v[16:19], v[224:239]
    v_xor_b32 v44, v44, v14
    v_xor_b32 v45, v45, v15
    v_or3_b32 v9, v9, v44, v45
    v_mfma_f32_32x32x16_bf16 v[240:255], a[36:39], v[16:19], v[240:255]
    v_xor_b32 v40, v40, v14
    v_xor_b32 v41, v41, v15
    buffer_load_dwordx4 v[92:95], v6, s[8:11], s33 offen offset:3072 sc1
    v_mfma_f32_32x32x16_bf16 v[192:207], a[40:43], v[28:31], v[192:207]
    v_or3_b32 v9, v9, v40, v41
    v_and_b32 v9, 0x30003, v9
    v_mfma_f32_32x32x16_bf16 v[208:223], a[44:47], v[28:31], v[208:223]
    v_cmp_ne_u32 vcc, 0, v9
    buffer_load_dwordx4 v[96:99], v6, s[8:11], s30 offen offset:3072 sc1
    v_mfma_f32_32x32x16_bf16 v[224:239], a[40:43], v[24:27], v[224:239]
    s_cbranch_vccnz L_rt_50
L_ok_51:
    v_mfma_f32_32x32x16_bf16 v[240:255], a[44:47], v[24:27], v[240:255]
    buffer_load_dwordx4 v[100:103], v6, s[8:11], s34 offen offset:3072 sc1
    s_barrier
    v_mfma_f32_32x32x16_bf16 v[192:207], a[48:51], v[36:39], v[192:207]
    s_waitcnt vmcnt(13)
    v_xor_b32 v52, v52, v14
    v_xor_b32 v53, v53, v15
    v_or_b32 v9, v52, v53
    v_bfe_u32 v188, v0, 3, 3
    v_and_b32 v184, 7, v0
    v_mfma_f32_32x32x16_bf16 v[208:223], a[52:55], v[36:39], v[208:223]
    v_xor_b32 v48, v48, v14
    v_xor_b32 v49, v49, v15
    v_or3_b32 v9, v9, v48, v49
    buffer_load_dwordx4 v[104:107], v6, s[8:11], s31 offen offset:3072 sc1
    v_lshlrev_b32 v184, 1, v184
    v_xor_b32 v184, v184, v188
    v_mfma_f32_32x32x16_bf16 v[224:239], a[48:51], v[32:35], v[224:239]
    v_xor_b32 v60, v60, v14
    v_xor_b32 v61, v61, v15
    v_or3_b32 v9, v9, v60, v61
    v_lshlrev_b32 v184, 4, v184
    v_lshl_add_u32 v184, v188, 8, v184
    v_mfma_f32_32x32x16_bf16 v[240:255], a[52:55], v[32:35], v[240:255]
    v_xor_b32 v56, v56, v14
    v_xor_b32 v57, v57, v15
    buffer_load_dwordx4 v[108:111], v6, s[8:11], s35 offen offset:3072 sc1
    v_lshl_add_u32 v184, v3, 11, v184
    v_xor_b32 v185, 16, v184
    v_mfma_f32_32x32x16_bf16 v[192:207], a[56:59], v[44:47], v[192:207]
    v_or3_b32 v9, v9, v56, v57
    v_and_b32 v9, 0x30003, v9
    s_add_u32 s52, s28, 4096
    v_bfe_u32 v188, v0, 5, 1
    v_and_b32 v186, 7, v0
    v_mfma_f32_32x32x16_bf16 v[208:223], a[60:63], v[44:47], v[208:223]
    v_cmp_ne_u32 vcc, 0, v9
    buffer_load_dwordx4 v[112:115], v6, s[8:11], s52 offen offset:0 sc1
    s_add_u32 s52, s32, 4096
    v_xor_b32 v188, v188, v186
    v_lshlrev_b32 v188, 4, v188
    v_mfma_f32_32x32x16_bf16 v[224:239], a[56:59], v[40:43], v[224:239]
    s_cbranch_vccnz L_rt_52
L_ok_53:
    v_and_b32 v186, 31, v0
    v_lshl_add_u32 v188, v186, 8, v188
    v_xor_b32 v189, 32, v188
    v_mfma_f32_32x32x16_bf16 v[240:255], a[60:63], v[40:43], v[240:255]
    buffer_load_dwordx4 v[116:119], v6, s[8:11], s52 offen offset:0 sc1
    s_add_u32 s52, s29, 4096
    v_xor_b32 v190, 64, v188
    v_xor_b32 v191, 96, v188
    v_mfma_f32_32x32x16_bf16 v[192:207], a[64:67], v[52:55], v[192:207]
    s_waitcnt vmcnt(11)
    v_xor_b32 v68, v68, v14
    v_xor_b32 v69, v69, v15
    v_or_b32 v9, v68, v69
    v_add_u32 v188, s40, v188
    v_add_u32 v189, s40, v189
    v_mfma_f32_32x32x16_bf16 v[208:223], a[68:71], v[52:55], v[208:223]
    v_xor_b32 v64, v64, v14
    v_xor_b32 v65, v65, v15
    v_or3_b32 v9, v9, v64, v65
    buffer_load_dwordx4 v[120:123], v6, s[8:11], s52 offen offset:0 sc1
    v_add_u32 v190, s40, v190
    v_add_u32 v191, s40, v191
    v_mfma_f32_32x32x16_bf16 v[224:239], a[64:67], v[48:51], v[224:239]
    v_xor_b32 v76, v76, v14
    v_xor_b32 v77, v77, v15
    v_or3_b32 v9, v9, v76, v77
    s_add_u32 s52, s33, 4096
    v_add_u32 v186, 71744, v184
    v_add_u32 v187, 71744, v185
    v_mfma_f32_32x32x16_bf16 v[240:255], a[68:71], v[48:51], v[240:255]
    v_xor_b32 v72, v72, v14
    v_xor_b32 v73, v73, v15
    buffer_load_dwordx4 v[124:127], v6, s[8:11], s52 offen offset:0 sc1
    v_mfma_f32_32x32x16_bf16 v[192:207], a[72:75], v[60:63], v[192:207]
    v_or3_b32 v9, v9, v72, v73
    v_and_b32 v9, 0x30003, v9
    s_add_u32 s52, s30, 4096
    v_mfma_f32_32x32x16_bf16 v[208:223], a[76:79], v[60:63], v[208:223]
    v_cmp_ne_u32 vcc, 0, v9
    buffer_load_dwordx4 v[128:131], v6, s[8:11], s52 offen offset:0 sc1
    s_add_u32 s52, s31, 4096
    v_mfma_f32_32x32x16_bf16 v[224:239], a[72:75], v[56:59], v[224:239]
    s_cbranch_vccnz L_rt_54
L_ok_55:
    v_mfma_f32_32x32x16_bf16 v[240:255], a[76:79], v[56:59], v[240:255]
    buffer_load_dwordx4 v[136:139], v6, s[8:11], s52 offen offset:0 sc1
    s_add_u32 s52, s28, 4096
    v_mfma_f32_32x32x16_bf16 v[192:207], a[80:83], v[68:71], v[192:207]
    s_waitcnt vmcnt(10)
    v_xor_b32 v84, v84, v14
    v_xor_b32 v85, v85, v15
    v_or_b32 v9, v84, v85
    v_mfma_f32_32x32x16_bf16 v[208:223], a[84:87], v[68:71], v[208:223]
    v_xor_b32 v80, v80, v14
    v_xor_b32 v81, v81, v15
    v_or3_b32 v9, v9, v80, v81
    buffer_load_dwordx4 v[144:147], v6, s[8:11], s52 offen offset:1024 sc1
    v_mfma_f32_32x32x16_bf16 v[224:239], a[80:83], v[64:67], v[224:239]
    v_xor_b32 v92, v92, v14
    v_xor_b32 v93, v93, v15
    v_or3_b32 v9, v9, v92, v93
    s_add_u32 s52, s29, 4096
    v_mfma_f32_32x32x16_bf16 v[240:255], a[84:87], v[64:67], v[240:255]
    v_xor_b32 v88, v88, v14
    v_xor_b32 v89, v89, v15
    buffer_load_dwordx4 v[152:155], v6, s[8:11], s52 offen offset:1024 sc1
    v_mfma_f32_32x32x16_bf16 v[192:207], a[88:91], v[76:79], v[192:207]
    v_or3_b32 v9, v9, v88, v89
    v_and_b32 v9, 0x30003, v9
    s_add_u32 s52, s30, 4096
    v_mfma_f32_32x32x16_bf16 v[208:223], a[92:95], v[76:79], v[208:223]
    v_cmp_ne_u32 vcc, 0, v9
    buffer_load_dwordx4 v[160:163], v6, s[8:11], s52 offen offset:1024 sc1
    s_add_u32 s52, s31, 4096
    v_mfma_f32_32x32x16_bf16 v[224:239], a[88:91], v[72:75], v[224:239]
    s_cbranch_vccnz L_rt_56
L_ok_57:
    v_mfma_f32_32x32x16_bf16 v[240:255], a[92:95], v[72:75], v[240:255]
    buffer_load_dwordx4 v[168:171], v6, s[8:11], s52 offen offset:1024 sc1
    s_add_u32 s52, s28, 4096
    v_mfma_f32_32x32x16_bf16 v[192:207], a[96:99], v[84:87], v[192:207]
    s_waitcnt vmcnt(10)
    v_xor_b32 v100, v100, v14
    v_xor_b32 v101, v101, v15
    v_or_b32 v9, v100, v101
    v_mfma_f32_32x32x16_bf16 v[208:223], a[100:103], v[84:87], v[208:223]
    v_xor_b32 v96, v96, v14
    v_xor_b32 v97, v97, v15
    v_or3_b32 v9, v9, v96, v97
    buffer_load_dwordx4 v[16:19], v6, s[8:11], s52 offen offset:2048 sc1
    v_mfma_f32_32x32x16_bf16 v[224:239], a[96:99], v[80:83], v[224:239]
    v_xor_b32 v108, v108, v14
    v_xor_b32 v109, v109, v15
    v_or3_b32 v9, v9, v108, v109
    s_add_u32 s52, s29, 4096
    v_mfma_f32_32x32x16_bf16 v[240:255], a[100:103], v[80:83], v[240:255]
    v_xor_b32 v104, v104, v14
    v_xor_b32 v105, v105, v15
    buffer_load_dwordx4 v[24:27], v6, s[8:11], s52 offen offset:2048 sc1
    v_mfma_f32_32x32x16_bf16 v[192:207], a[104:107], v[92:95], v[192:207]
    v_or3_b32 v9, v9, v104, v105
    v_and_b32 v9, 0x30003, v9
    s_add_u32 s52, s34, 4096
    v_mfma_f32_32x32x16_bf16 v[208:223], a[108:111], v[92:95], v[208:223]
    v_cmp_ne_u32 vcc, 0, v9
    buffer_load_dwordx4 v[132:135], v6, s[8:11], s52 offen offset:0 sc1
    s_add_u32 s52, s35, 4096
    v_mfma_f32_32x32x16_bf16 v[224:239], a[104:107], v[88:91], v[224:239]
    s_cbranch_vccnz L_rt_58
L_ok_59:
    v_mfma_f32_32x32x16_bf16 v[240:255], a[108:111], v[88:91], v[240:255]
    buffer_load_dwordx4 v[140:143], v6, s[8:11], s52 offen offset:0 sc1
    s_add_u32 s52, s30, 4096
    v_mfma_f32_32x32x16_bf16 v[192:207], a[112:115], v[100:103], v[192:207]
    s_waitcnt vmcnt(10)
    v_xor_b32 v116, v116, v14
    v_xor_b32 v117, v117, v15
    v_or_b32 v9, v116, v117
    v_mfma_f32_32x32x16_bf16 v[208:223], a[116:119], v[100:103], v[208:223]
    v_xor_b32 v112, v112, v14
    v_xor_b32 v113, v113, v15
    v_or3_b32 v9, v9, v112, v113
    buffer_load_dwordx4 v[32:35], v6, s[8:11], s52 offen offset:2048 sc1
    v_mfma_f32_32x32x16_bf16 v[224:239], a[112:115], v[96:99], v[224:239]
    v_xor_b32 v124, v124, v14
    v_xor_b32 v125, v125, v15
    v_or3_b32 v9, v9, v124, v125
    s_add_u32 s52, s31, 4096
    v_mfma_f32_32x32x16_bf16 v[240:255], a[116:119], v[96:99], v[240:255]
    v_xor_b32 v120, v120, v14
    v_xor_b32 v121, v121, v15
    buffer_load_dwordx4 v[40:43], v6, s[8:11], s52 offen offset:2048 sc1
    v_mfma_f32_32x32x16_bf16 v[192:207], a[120:123], v[108:111], v[192:207]
    v_or3_b32 v9, v9, v120, v121
    v_and_b32 v9, 0x30003, v9
    s_add_u32 s52, s32, 4096
    v_mfma_f32_32x32x16_bf16 v[208:223], a[124:127], v[108:111], v[208:223]
    v_cmp_ne_u32 vcc, 0, v9
    buffer_load_dwordx4 v[148:151], v6, s[8:11], s52 offen offset:1024 sc1
    s_add_u32 s52, s33, 4096
    v_mfma_f32_32x32x16_bf16 v[224:239], a[120:123], v[104:107], v[224:239]
    s_cbranch_vccnz L_rt_60
L_ok_61:
    v_mfma_f32_32x32x16_bf16 v[240:255], a[124:127], v[104:107], v[240:255]
    buffer_load_dwordx4 v[156:159], v6, s[8:11], s52 offen offset:1024 sc1
    s_add_u32 s52, s34, 4096
    v_mfma_f32_32x32x16_bf16 v[192:207], a[128:131], v[116:119], v[192:207]
    s_waitcnt vmcnt(10)
    v_xor_b32 v128, v128, v14
    v_xor_b32 v129, v129, v15
    v_or_b32 v9, v128, v129
    v_mfma_f32_32x32x16_bf16 v[208:223], a[132:135], v[116:119], v[208:223]
    v_xor_b32 v136, v136, v14
    v_xor_b32 v137, v137, v15
    v_or3_b32 v9, v9, v136, v137
    buffer_load_dwordx4 v[164:167], v6, s[8:11], s52 offen offset:1024 sc1
    v_mfma_f32_32x32x16_bf16 v[224:239], a[128:131], v[112:115], v[224:239]
    v_xor_b32 v144, v144, v14
    v_xor_b32 v145, v145, v15
    v_or3_b32 v9, v9, v144, v145
    s_add_u32 s52, s35, 4096
    v_mfma_f32_32x32x16_bf16 v[240:255], a[132:135], v[112:115], v[240:255]
    v_xor_b32 v152, v152, v14
    v_xor_b32 v153, v153, v15
    buffer_load_dwordx4 v[172:175], v6, s[8:11], s52 offen offset:1024 sc1
    v_mfma_f32_32x32x16_bf16 v[192:207], a[136:139], v[124:127], v[192:207]
    v_or3_b32 v9, v9, v152, v153
    v_and_b32 v9, 0x30003, v9
    s_add_u32 s52, s32, 4096
    v_mfma_f32_32x32x16_bf16 v[208:223], a[140:143], v[124:127], v[208:223]
    v_cmp_ne_u32 vcc, 0, v9
    buffer_load_dwordx4 v[20:23], v6, s[8:11], s52 offen offset:2048 sc1
    s_add_u32 s52, s33, 4096
    v_mfma_f32_32x32x16_bf16 v[224:239], a[136:139], v[120:123], v[224:239]
    s_cbranch_vccnz L_rt_62
L_ok_63:
    v_mfma_f32_32x32x16_bf16 v[240:255], a[140:143], v[120:123], v[240:255]
    buffer_load_dwordx4 v[28:31], v6, s[8:11], s52 offen offset:2048 sc1
    s_add_u32 s52, s34, 4096
    v_mfma_f32_32x32x16_bf16 v[224:239], a[144:147], v[128:131], v[224:239]
    s_waitcnt vmcnt(10)
    v_xor_b32 v160, v160, v14
    v_xor_b32 v161, v161, v15
    v_or_b32 v9, v160, v161
    v_mfma_f32_32x32x16_bf16 v[240:255], a[148:151], v[128:131], v[240:255]
    v_xor_b32 v168, v168, v14
    v_xor_b32 v169, v169, v15
    v_or3_b32 v9, v9, v168, v169
    buffer_load_dwordx4 v[36:39], v6, s[8:11], s52 offen offset:2048 sc1
    v_mfma_f32_32x32x16_bf16 v[224:239], a[152:155], v[136:139], v[224:239]
    v_xor_b32 v16, v16, v14
    v_xor_b32 v17, v17, v15
    v_or3_b32 v9, v9, v16, v17
    s_add_u32 s52, s35, 4096
    v_mfma_f32_32x32x16_bf16 v[240:255], a[156:159], v[136:139], v[240:255]
    v_xor_b32 v24, v24, v14
    v_xor_b32 v25, v25, v15
    buffer_load_dwordx4 v[44:47], v6, s[8:11], s52 offen offset:2048 sc1
    v_mfma_f32_32x32x16_bf16 v[224:239], a[160:163], v[144:147], v[224:239]
    v_or3_b32 v9, v9, v24, v25
    v_and_b32 v9, 0x30003, v9
    v_mfma_f32_32x32x16_bf16 v[240:255], a[164:167], v[144:147], v[240:255]
    v_cmp_ne_u32 vcc, 0, v9
    v_mfma_f32_32x32x16_bf16 v[224:239], a[168:171], v[152:155], v[224:239]
    s_cbranch_vccnz L_rt_64
L_ok_65:
    s_waitcnt vmcnt(8)
    v_xor_b32 v32, v32, v14
    v_xor_b32 v33, v33, v15
    v_or_b32 v9, v32, v33
    v_mfma_f32_32x32x16_bf16 v[240:255], a[172:175], v[152:155], v[240:255]
    v_xor_b32 v40, v40, v14
    v_xor_b32 v41, v41, v15
    v_or3_b32 v9, v9, v40, v41
    v_mfma_f32_32x32x16_bf16 v[224:239], a[176:179], v[160:163], v[224:239]
    v_xor_b32 v132, v132, v14
    v_xor_b32 v133, v133, v15
    v_or3_b32 v9, v9, v132, v133
    v_mfma_f32_32x32x16_bf16 v[240:255], a[180:183], v[160:163], v[240:255]
    v_xor_b32 v140, v140, v14
    v_xor_b32 v141, v141, v15
    v_mfma_f32_32x32x16_bf16 v[224:239], a[184:187], v[168:171], v[224:239]
    v_or3_b32 v9, v9, v140, v141
    v_and_b32 v9, 0x30003, v9
    v_mfma_f32_32x32x16_bf16 v[240:255], a[188:191], v[168:171], v[240:255]
    v_cmp_ne_u32 vcc, 0, v9
    v_mfma_f32_32x32x16_bf16 v[224:239], a[192:195], v[16:19], v[224:239]
    s_cbranch_vccnz L_rt_66
L_ok_67:
    v_mfma_f32_32x32x16_bf16 v[224:239], a[200:203], v[24:27], v[224:239]
    v_mfma_f32_32x32x16_bf16 v[224:239], a[208:211], v[32:35], v[224:239]
    v_mfma_f32_32x32x16_bf16 v[224:239], a[216:219], v[40:43], v[224:239]
    v_mfma_f32_32x32x16_bf16 v[240:255], a[196:199], v[16:19], v[240:255]
    s_waitcnt vmcnt(4)
    v_xor_b32 v148, v148, v14
    v_xor_b32 v149, v149, v15
    v_or_b32 v9, v148, v149
    v_mfma_f32_32x32x16_bf16 v[240:255], a[204:207], v[24:27], v[240:255]
    v_xor_b32 v156, v156, v14
    v_xor_b32 v157, v157, v15
    v_or3_b32 v9, v9, v156, v157
    v_mfma_f32_32x32x16_bf16 v[240:255], a[212:215], v[32:35], v[240:255]
    v_xor_b32 v164, v164, v14
    v_xor_b32 v165, v165, v15
    v_or3_b32 v9, v9, v164, v165
    v_mfma_f32_32x32x16_bf16 v[240:255], a[220:223], v[40:43], v[240:255]
    v_xor_b32 v172, v172, v14
    v_xor_b32 v173, v173, v15
    ds_write_b128 v188, v[224:227] offset:0
    ds_write_b128 v189, v[228:231] offset:0
    v_mfma_f32_32x32x16_bf16 v[192:207], a[144:147], v[132:135], v[192:207]
    v_or3_b32 v9, v9, v172, v173
    v_and_b32 v9, 0x30003, v9
    ds_write_b128 v190, v[232:235] offset:0
    ds_write_b128 v191, v[236:239] offset:0
    v_mfma_f32_32x32x16_bf16 v[208:223], a[148:151], v[132:135], v[208:223]
    v_cmp_ne_u32 vcc, 0, v9
    v_mfma_f32_32x32x16_bf16 v[192:207], a[152:155], v[140:143], v[192:207]
    s_cbranch_vccnz L_rt_68
L_ok_69:
    v_mfma_f32_32x32x16_bf16 v[208:223], a[156:159], v[140:143], v[208:223]
    ds_write_b128 v188, v[240:243] offset:128
    ds_write_b128 v189, v[244:247] offset:128
    ds_write_b128 v190, v[248:251] offset:128
    ds_write_b128 v191, v[252:255] offset:128
    v_mfma_f32_32x32x16_bf16 v[192:207], a[160:163], v[148:151], v[192:207]
    s_waitcnt vmcnt(0)
    v_xor_b32 v20, v20, v14
    v_xor_b32 v21, v21, v15
    v_or_b32 v9, v20, v21
    s_waitcnt lgkmcnt(0)
    s_barrier
    ds_read_b128 v[64:67], v184 offset:0
    v_mfma_f32_32x32x16_bf16 v[208:223], a[164:167], v[148:151], v[208:223]
    v_xor_b32 v28, v28, v14
    v_xor_b32 v29, v29, v15
    v_or3_b32 v9, v9, v28, v29
    ds_read_b128 v[68:71], v185 offset:0
    ds_read_b128 v[72:75], v184 offset:35872
    v_mfma_f32_32x32x16_bf16 v[192:207], a[168:171], v[156:159], v[192:207]
    v_xor_b32 v36, v36, v14
    v_xor_b32 v37, v37, v15
    v_or3_b32 v9, v9, v36, v37
    ds_read_b128 v[76:79], v185 offset:35872
    ds_read_b128 v[80:83], v186 offset:0
    v_mfma_f32_32x32x16_bf16 v[208:223], a[172:175], v[156:159], v[208:223]
    v_xor_b32 v44, v44, v14
    v_xor_b32 v45, v45, v15
    ds_read_b128 v[84:87], v187 offset:0
    ds_read_b128 v[88:91], v186 offset:35872
    v_mfma_f32_32x32x16_bf16 v[192:207], a[176:179], v[164:167], v[192:207]
    v_or3_b32 v9, v9, v44, v45
    v_and_b32 v9, 0x30003, v9
    ds_read_b128 v[92:95], v187 offset:35872
    v_mfma_f32_32x32x16_bf16 v[208:223], a[180:183], v[164:167], v[208:223]
    v_cmp_ne_u32 vcc, 0, v9
    v_mfma_f32_32x32x16_bf16 v[192:207], a[184:187], v[172:175], v[192:207]
    s_cbranch_vccnz L_rt_70
L_ok_71:
    v_mfma_f32_32x32x16_bf16 v[208:223], a[188:191], v[172:175], v[208:223]
    s_waitcnt lgkmcnt(4)
    v_pk_add_f32 v[48:49], v[64:65], v[72:73]
    v_pk_add_f32 v[50:51], v[66:67], v[74:75]
    v_pk_add_f32 v[52:53], v[68:69], v[76:77]
    v_pk_add_f32 v[54:55], v[70:71], v[78:79]
    v_mfma_f32_32x32x16_bf16 v[192:207], a[192:195], v[20:23], v[192:207]
    s_waitcnt lgkmcnt(2)
    v_pk_add_f32 v[48:49], v[48:49], v[80:81]
    v_pk_add_f32 v[50:51], v[50:51], v[82:83]
    v_pk_add_f32 v[52:53], v[52:53], v[84:85]
    v_pk_add_f32 v[54:55], v[54:55], v[86:87]
    v_mfma_f32_32x32x16_bf16 v[192:207], a[200:203], v[28:31], v[192:207]
    s_waitcnt lgkmcnt(0)
    v_pk_add_f32 v[48:49], v[48:49], v[88:89]
    v_pk_add_f32 v[50:51], v[50:51], v[90:91]
    v_pk_add_f32 v[52:53], v[52:53], v[92:93]
    v_pk_add_f32 v[54:55], v[54:55], v[94:95]
    v_mfma_f32_32x32x16_bf16 v[192:207], a[208:211], v[36:39], v[192:207]
    v_cvt_pk_bf16_f32 v176, v48, v49
    v_cvt_pk_bf16_f32 v177, v50, v51
    v_cvt_pk_bf16_f32 v178, v52, v53
    v_cvt_pk_bf16_f32 v179, v54, v55
    v_mfma_f32_32x32x16_bf16 v[192:207], a[216:219], v[44:47], v[192:207]
    v_or_b32 v176, 1, v176
    buffer_store_dwordx4 v[176:179], v11, s[8:11], s57 offen sc1
    v_mfma_f32_32x32x16_bf16 v[208:223], a[196:199], v[20:23], v[208:223]
    v_mfma_f32_32x32x16_bf16 v[208:223], a[204:207], v[28:31], v[208:223]
    v_mfma_f32_32x32x16_bf16 v[208:223], a[212:215], v[36:39], v[208:223]
    v_mfma_f32_32x32x16_bf16 v[208:223], a[220:223], v[44:47], v[208:223]
    s_nop 5
    ds_write_b128 v188, v[192:195] offset:8192
    ds_write_b128 v189, v[196:199] offset:8192
    ds_write_b128 v190, v[200:203] offset:8192
    ds_write_b128 v191, v[204:207] offset:8192
    s_nop 1
    ds_write_b128 v188, v[208:211] offset:8320
    ds_write_b128 v189, v[212:215] offset:8320
    ds_write_b128 v190, v[216:219] offset:8320
    ds_write_b128 v191, v[220:223] offset:8320
    s_waitcnt lgkmcnt(0)
    s_barrier
    ds_read_b128 v[64:67], v184 offset:8192
    ds_read_b128 v[68:71], v185 offset:8192
    ds_read_b128 v[72:75], v184 offset:44064
    ds_read_b128 v[76:79], v185 offset:44064
    ds_read_b128 v[80:83], v186 offset:8192
    ds_read_b128 v[84:87], v187 offset:8192
    ds_read_b128 v[88:91], v186 offset:44064
    ds_read_b128 v[92:95], v187 offset:44064
    s_waitcnt lgkmcnt(4)
    v_pk_add_f32 v[56:57], v[64:65], v[72:73]
    v_pk_add_f32 v[58:59], v[66:67], v[74:75]
    v_pk_add_f32 v[60:61], v[68:69], v[76:77]
    v_pk_add_f32 v[62:63], v[70:71], v[78:79]
    s_waitcnt lgkmcnt(2)
    v_pk_add_f32 v[56:57], v[56:57], v[80:81]
    v_pk_add_f32 v[58:59], v[58:59], v[82:83]
    v_pk_add_f32 v[60:61], v[60:61], v[84:85]
    v_pk_add_f32 v[62:63], v[62:63], v[86:87]
    s_waitcnt lgkmcnt(0)
    v_pk_add_f32 v[56:57], v[56:57], v[88:89]
    v_pk_add_f32 v[58:59], v[58:59], v[90:91]
    v_pk_add_f32 v[60:61], v[60:61], v[92:93]
    v_pk_add_f32 v[62:63], v[62:63], v[94:95]
    v_cvt_pk_bf16_f32 v180, v56, v57
    v_cvt_pk_bf16_f32 v181, v58, v59
    v_cvt_pk_bf16_f32 v182, v60, v61
    v_cvt_pk_bf16_f32 v183, v62, v63
    v_or_b32 v180, 1, v180
    buffer_store_dwordx4 v[180:183], v11, s[8:11], s58 offen sc1
    s_getpc_b64 s[28:29]
L_pc1:
    s_bfe_u32 s30, s2, 0x20003
    s_lshl_b32 s30, s30, 12
    v_lshrrev_b32 v9, 3, v0
    v_lshlrev_b32 v9, 7, v9
    v_add_u32 v9, s30, v9
    v_add_u32 v9, L_ffn1 - L_pc1, v9
    v_min_u32 v9, L_exit - L_pc1, v9
    v_mov_b32 v11, s29
    v_add_co_u32 v10, vcc, s28, v9
    s_nop 1
    v_addc_co_u32 v11, vcc, 0, v11, vcc
    global_load_dword v254, v[10:11], off
    v_accvgpr_read_b32 v250, a240
    s_barrier
    s_add_u32 m0, s40, 0
    s_mov_b32 s39, 0
    buffer_load_dwordx4 v250, s[60:63], s39 offen lds
    v_lshrrev_b32 v9, 5, v0
    v_and_b32 v10, 1, v9
    v_lshlrev_b32 v10, 3, v10
    v_and_b32 v11, 31, v0
    v_xor_b32 v10, v10, v11
    v_lshlrev_b32 v10, 4, v10
    v_lshl_add_u32 v208, v9, 10, v10
    v_add_u32 v208, 151744, v208
    v_lshrrev_b32 v9, 2, v1
    v_lshl_add_u32 v9, v2, 2, v9
    v_bfe_u32 v10, v1, 1, 1
    v_lshlrev_b32 v11, 3, v10
    v_xor_b32 v9, v9, v11
    v_lshlrev_b32 v9, 4, v9
    v_lshl_add_u32 v9, v10, 10, v9
    s_add_u32 m0, s40, 1024
    s_mov_b32 s39, 57344
    buffer_load_dwordx4 v250, s[60:63], s39 offen lds
    v_and_b32 v10, 1, v1
    v_lshl_add_u32 v209, v10, 3, v9
    v_add_u32 v209, 151744, v209
    v_lshrrev_b32 v9, 1, v2
    v_lshlrev_b32 v10, 4, v2
    v_lshl_add_u32 v211, v3, 2, v10
    v_add_u32 v211, 159936, v211
    v_lshlrev_b32 v15, 5, v9
    v_add_u32 v15, 159936, v15
    v_mov_b32 v213, 0x3f803f80
    v_lshl_add_u32 v12, v3, 4, v1
    v_cvt_f32_u32 v9, v12
    v_mul_f32 v10, 0x3c800000, v9
    v_mul_f32 v11, v9, v5
    v_mul_f32 v11, 0x3d800000, v11
    s_add_u32 m0, s40, 2048
    s_mov_b32 s39, 114688
    buffer_load_dwordx4 v250, s[60:63], s39 offen lds
    v_mov_b32 v72, v11
    v_add_f32 v73, v10, v11
    v_fmamk_f32 v74, v10, 0x40000000, v11
    v_fmamk_f32 v75, v10, 0x40400000, v11
    v_fmamk_f32 v76, v10, 0x41800000, v11
    v_fmamk_f32 v77, v10, 0x41880000, v11
    v_fmamk_f32 v78, v10, 0x41900000, v11
    v_fmamk_f32 v79, v10, 0x41980000, v11
    v_sin_f32 v80, v72
    v_cos_f32 v72, v72
    v_sin_f32 v81, v73
    v_cos_f32 v73, v73
    v_sin_f32 v82, v74
    v_cos_f32 v74, v74
    v_sin_f32 v83, v75
    s_add_u32 m0, s40, 3072
    s_mov_b32 s39, 172032
    buffer_load_dwordx4 v250, s[60:63], s39 offen lds
    v_cos_f32 v75, v75
    v_sin_f32 v84, v76
    v_cos_f32 v76, v76
    v_sin_f32 v85, v77
    v_cos_f32 v77, v77
    v_sin_f32 v86, v78
    v_cos_f32 v78, v78
    v_sin_f32 v87, v79
    v_cos_f32 v79, v79
    v_and_b32 v13, 1, v1
    s_mov_b32 s28, 0x80008000
    v_mul_lo_u32 v13, v13, s28
    v_cvt_pk_bf16_f32 v56, v72, v73
    v_cvt_pk_bf16_f32 v64, -v80, -v81
    v_cvt_pk_bf16_f32 v57, v74, v75
    v_cvt_pk_bf16_f32 v65, -v82, -v83
    v_cvt_pk_bf16_f32 v58, v76, v77
    v_cvt_pk_bf16_f32 v66, -v84, -v85
    v_cvt_pk_bf16_f32 v59, v78, v79
    v_cvt_pk_bf16_f32 v67, -v86, -v87
    v_xor_b32 v60, v56, v13
    v_xor_b32 v68, v64, v13
    v_xor_b32 v61, v57, v13
    v_xor_b32 v69, v65, v13
    v_xor_b32 v62, v58, v13
    v_xor_b32 v70, v66, v13
    v_xor_b32 v63, v59, v13
    v_xor_b32 v71, v67, v13
    v_cmp_eq_u32 vcc, 0, v12
    v_mov_b32 v10, 0x43800000
    s_nop 0
    v_cndmask_b32 v128, 0, 1.0, vcc
    v_cndmask_b32 v9, v9, v10, vcc
    v_cndmask_b32 v129, 0, -1.0, vcc
    v_cndmask_b32 v130, 0, 1.0, vcc
    v_cndmask_b32 v131, 0, -1.0, vcc
    v_mul_f32 v9, 0x3b000000, v9
    v_and_b32 v10, 1, v2
    v_cvt_f32_u32 v14, v10
    v_mul_f32 v10, v14, v9
    v_mul_f32 v10, 4.0, v10
    v_mov_b32 v104, v10
    v_add_f32 v105, v9, v10
    v_fmamk_f32 v106, v9, 0x40000000, v10
    v_fmamk_f32 v107, v9, 0x40400000, v10
    v_sin_f32 v108, v104
    v_cos_f32 v104, v104
    v_sin_f32 v109, v105
    v_cos_f32 v105, v105
    v_sin_f32 v110, v106
    v_cos_f32 v106, v106
    v_sin_f32 v111, v107
    v_cos_f32 v107, v107
    v_and_b32 v9, 3, v1
    v_cvt_f32_u32 v9, v9
    v_mul_f32 v9, 0x3e000000, v9
    v_lshrrev_b32 v10, 2, v1
    v_cvt_f32_u32 v10, v10
    v_mul_f32 v10, 0x3e000000, v10
    v_lshrrev_b32 v12, 1, v2
    v_cvt_f32_u32 v11, v12
    v_mul_f32 v11, v11, v9
    v_mul_f32 v14, v14, v10
    v_fmamk_f32 v11, v14, 0x40800000, v11
    v_mul_lo_u32 v14, v12, s28
    v_fmamk_f32 v12, v9, 0x40000000, v11
    v_mov_b32 v72, v11
    v_add_f32 v73, v10, v11
    v_fmamk_f32 v74, v10, 0x40000000, v11
    v_fmamk_f32 v75, v10, 0x40400000, v11
    v_mov_b32 v76, v12
    v_add_f32 v77, v10, v12
    v_fmamk_f32 v78, v10, 0x40000000, v12
    v_fmamk_f32 v79, v10, 0x40400000, v12
    s_lshl_b32 s30, s20, 13
    v_lshrrev_b32 v248, 5, v0
    v_lshlrev_b32 v248, 10, v248
    v_and_b32 v249, 31, v0
    v_lshl_add_u32 v248, v249, 4, v248
    buffer_load_dwordx4 v[16:19], v248, s[8:11], s30 offen offset:0 sc1
    buffer_load_dwordx4 v[20:23], v248, s[8:11], s30 offen offset:512 sc1
    v_sin_f32 v80, v72
    v_cos_f32 v72, v72
    v_sin_f32 v81, v73
    v_cos_f32 v73, v73
    v_sin_f32 v82, v74
    v_cos_f32 v74, v74
    v_sin_f32 v83, v75
    v_cos_f32 v75, v75
    v_sin_f32 v84, v76
    v_cos_f32 v76, v76
    v_sin_f32 v85, v77
    v_cos_f32 v77, v77
    v_sin_f32 v86, v78
    v_cos_f32 v78, v78
    v_sin_f32 v87, v79
    v_cos_f32 v79, v79
    v_xor_b32 v12, v13, v14
    v_cvt_pk_bf16_f32 v144, v72, v73
    v_cvt_pk_bf16_f32 v160, v80, v81
    v_cvt_pk_bf16_f32 v176, -v80, -v81
    v_cvt_pk_bf16_f32 v145, v74, v75
    v_cvt_pk_bf16_f32 v161, v82, v83
    v_cvt_pk_bf16_f32 v177, -v82, -v83
    v_cvt_pk_bf16_f32 v146, v76, v77
    v_cvt_pk_bf16_f32 v162, v84, v85
    v_cvt_pk_bf16_f32 v178, -v84, -v85
    v_cvt_pk_bf16_f32 v147, v78, v79
    v_cvt_pk_bf16_f32 v163, v86, v87
    v_cvt_pk_bf16_f32 v179, -v86, -v87
    v_xor_b32 v148, v144, v13
    v_xor_b32 v164, v160, v13
    v_xor_b32 v180, v176, v13
    v_xor_b32 v149, v145, v13
    v_xor_b32 v165, v161, v13
    v_xor_b32 v181, v177, v13
    v_xor_b32 v150, v146, v13
    v_xor_b32 v166, v162, v13
    v_xor_b32 v182, v178, v13
    v_xor_b32 v151, v147, v13
    v_xor_b32 v167, v163, v13
    v_xor_b32 v183, v179, v13
    v_xor_b32 v152, v144, v14
    v_xor_b32 v168, v160, v14
    v_xor_b32 v184, v176, v14
    v_xor_b32 v153, v145, v14
    v_xor_b32 v169, v161, v14
    v_xor_b32 v185, v177, v14
    v_xor_b32 v154, v146, v14
    v_xor_b32 v170, v162, v14
    v_xor_b32 v186, v178, v14
    v_xor_b32 v155, v147, v14
    v_xor_b32 v171, v163, v14
    v_xor_b32 v187, v179, v14
    v_xor_b32 v156, v144, v12
    v_xor_b32 v172, v160, v12
    v_xor_b32 v188, v176, v12
    v_xor_b32 v157, v145, v12
    v_xor_b32 v173, v161, v12
    v_xor_b32 v189, v177, v12
    v_xor_b32 v158, v146, v12
    v_xor_b32 v174, v162, v12
    v_xor_b32 v190, v178, v12
    v_xor_b32 v159, v147, v12
    v_xor_b32 v175, v163, v12
    v_xor_b32 v191, v179, v12
    s_mov_b32 s22, 1
    s_add_u32 s31, s30, 2097152
    s_add_u32 s32, s31, 4096
    v_accvgpr_read_b32 v250, a240
    v_accvgpr_read_b32 v217, a232
    v_accvgpr_read_b32 v219, a233
    v_accvgpr_read_b32 v221, a234
    v_accvgpr_read_b32 v223, a235
    v_accvgpr_read_b32 v225, a236
    v_accvgpr_read_b32 v227, a237
    v_accvgpr_read_b32 v229, a238
    v_accvgpr_read_b32 v231, a239
    v_lshlrev_b32 v216, 16, v217
    v_and_b32 v217, 0xffff0000, v217
    v_lshlrev_b32 v218, 16, v219
    v_and_b32 v219, 0xffff0000, v219
    v_lshlrev_b32 v220, 16, v221
    v_and_b32 v221, 0xffff0000, v221
    v_lshlrev_b32 v222, 16, v223
    v_and_b32 v223, 0xffff0000, v223
    v_lshlrev_b32 v224, 16, v225
    v_and_b32 v225, 0xffff0000, v225
    v_lshlrev_b32 v226, 16, v227
    v_and_b32 v227, 0xffff0000, v227
    v_lshlrev_b32 v228, 16, v229
    v_and_b32 v229, 0xffff0000, v229
    v_lshlrev_b32 v230, 16, v231
    v_and_b32 v231, 0xffff0000, v231
    s_waitcnt vmcnt(0)
    v_bitop3_b32 v9, v16, v20, s22 bitop3:0x7e
    v_and_b32 v9, 1, v9
    v_cmp_ne_u32 vcc, 0, v9
    s_cbranch_vccnz L_rt_72
L_ok_73:
    v_lshlrev_b32 v232, 16, v16
    v_and_b32 v233, 0xffff0000, v16
    v_lshlrev_b32 v234, 16, v17
    v_and_b32 v235, 0xffff0000, v17
    v_lshlrev_b32 v236, 16, v18
    v_and_b32 v237, 0xffff0000, v18
    v_lshlrev_b32 v238, 16, v19
    v_and_b32 v239, 0xffff0000, v19
    v_lshlrev_b32 v240, 16, v20
    v_and_b32 v241, 0xffff0000, v20
    v_lshlrev_b32 v242, 16, v21
    v_and_b32 v243, 0xffff0000, v21
    v_lshlrev_b32 v244, 16, v22
    v_and_b32 v245, 0xffff0000, v22
    v_lshlrev_b32 v246, 16, v23
    v_and_b32 v247, 0xffff0000, v23
    v_pk_add_f32 v[216:217], v[216:217], v[232:233]
    v_pk_add_f32 v[218:219], v[218:219], v[234:235]
    v_pk_add_f32 v[220:221], v[220:221], v[236:237]
    v_pk_add_f32 v[222:223], v[222:223], v[238:239]
    v_pk_add_f32 v[224:225], v[224:225], v[240:241]
    v_pk_add_f32 v[226:227], v[226:227], v[242:243]
    v_pk_add_f32 v[228:229], v[228:229], v[244:245]
    v_pk_add_f32 v[230:231], v[230:231], v[246:247]
    v_cvt_pk_bf16_f32 v16, v216, v217
    v_cvt_pk_bf16_f32 v17, v218, v219
    v_cvt_pk_bf16_f32 v18, v220, v221
    v_cvt_pk_bf16_f32 v19, v222, v223
    v_cvt_pk_bf16_f32 v20, v224, v225
    v_cvt_pk_bf16_f32 v21, v226, v227
    v_cvt_pk_bf16_f32 v22, v228, v229
    v_cvt_pk_bf16_f32 v23, v230, v231
    s_branch L_p1_data
L_ffn1:
    s_lshl_b32 s56, s25, 10
    s_add_u32 s56, s56, 2097152
    s_waitcnt vmcnt(0)
    s_add_u32 s53, s44, 0
    buffer_load_dwordx4 v[16:19], v6, s[8:11], s53 offen offset:0 sc1
    buffer_load_dwordx4 v[20:23], v6, s[8:11], s53 offen offset:1024 sc1
    buffer_load_dwordx4 v[24:27], v6, s[8:11], s53 offen offset:2048 sc1
    buffer_load_dwordx4 v[28:31], v6, s[8:11], s53 offen offset:3072 sc1
    s_add_u32 s53, s44, 4096
    buffer_load_dwordx4 v[32:35], v6, s[8:11], s53 offen offset:0 sc1
    buffer_load_dwordx4 v[36:39], v6, s[8:11], s53 offen offset:1024 sc1
    buffer_load_dwordx4 v[40:43], v6, s[8:11], s53 offen offset:2048 sc1
    buffer_load_dwordx4 v[44:47], v6, s[8:11], s53 offen offset:3072 sc1
    s_add_u32 s53, s44, 8192
    buffer_load_dwordx4 v[48:51], v6, s[8:11], s53 offen offset:0 sc1
    buffer_load_dwordx4 v[52:55], v6, s[8:11], s53 offen offset:1024 sc1
    buffer_load_dwordx4 v[56:59], v6, s[8:11], s53 offen offset:2048 sc1
    buffer_load_dwordx4 v[60:63], v6, s[8:11], s53 offen offset:3072 sc1
    s_barrier
    ds_read_b64_tr_b16 v[224:225], v12 offset:0
    ds_read_b64_tr_b16 v[226:227], v12 offset:256
    ds_read_b64_tr_b16 v[228:229], v12 offset:32
    ds_read_b64_tr_b16 v[230:231], v12 offset:288
    ds_read_b64_tr_b16 v[232:233], v12 offset:64
    ds_read_b64_tr_b16 v[234:235], v12 offset:320
    ds_read_b64_tr_b16 v[236:237], v12 offset:96
    ds_read_b64_tr_b16 v[238:239], v12 offset:352
    ds_read_b64_tr_b16 v[240:241], v12 offset:1024
    ds_read_b64_tr_b16 v[242:243], v12 offset:1280
    ds_read_b64_tr_b16 v[244:245], v12 offset:1056
    ds_read_b64_tr_b16 v[246:247], v12 offset:1312
    s_waitcnt vmcnt(8)
    v_or3_b32 v9, v16, v20, v24
    v_or_b32 v9, v9, v28
    v_and_b32 v9, 1, v9
    v_cmp_ne_u32 vcc, 0, v9
    s_cbranch_vccnz L_rt_74
L_ok_75:
    ds_read_b64_tr_b16 v[248:249], v12 offset:1088
    ds_read_b64_tr_b16 v[250:251], v12 offset:1344
    s_waitcnt lgkmcnt(10)
    v_mfma_f32_32x32x16_bf16 v[192:207], v[224:227], v[16:19], 0
    s_add_u32 s53, s44, 12288
    ds_read_b64_tr_b16 v[252:253], v12 offset:1120
    ds_read_b64_tr_b16 v[254:255], v12 offset:1376
    v_mfma_f32_32x32x16_bf16 v[176:191], v[228:231], v[16:19], 0
    buffer_load_dwordx4 v[64:67], v6, s[8:11], s53 offen offset:0 sc1
    ds_read_b64_tr_b16 v[224:225], v12 offset:2048
    ds_read_b64_tr_b16 v[226:227], v12 offset:2304
    s_waitcnt lgkmcnt(10)
    v_mfma_f32_32x32x16_bf16 v[144:159], v[232:235], v[16:19], 0
    ds_read_b64_tr_b16 v[228:229], v12 offset:2080
    ds_read_b64_tr_b16 v[230:231], v12 offset:2336
    v_mfma_f32_32x32x16_bf16 v[160:175], v[236:239], v[16:19], 0
    buffer_load_dwordx4 v[68:71], v6, s[8:11], s53 offen offset:1024 sc1
    ds_read_b64_tr_b16 v[232:233], v12 offset:2112
    ds_read_b64_tr_b16 v[234:235], v12 offset:2368
    s_waitcnt lgkmcnt(10)
    v_mfma_f32_32x32x16_bf16 v[192:207], v[240:243], v[20:23], v[192:207]
    ds_read_b64_tr_b16 v[236:237], v12 offset:2144
    ds_read_b64_tr_b16 v[238:239], v12 offset:2400
    v_mfma_f32_32x32x16_bf16 v[176:191], v[244:247], v[20:23], v[176:191]
    buffer_load_dwordx4 v[72:75], v6, s[8:11], s53 offen offset:2048 sc1
    s_waitcnt vmcnt(7)
    ds_read_b64_tr_b16 v[240:241], v12 offset:3072
    ds_read_b64_tr_b16 v[242:243], v12 offset:3328
    s_waitcnt lgkmcnt(10)
    v_mfma_f32_32x32x16_bf16 v[144:159], v[248:251], v[20:23], v[144:159]
    v_or3_b32 v9, v32, v36, v40
    v_or_b32 v9, v9, v44
    ds_read_b64_tr_b16 v[244:245], v12 offset:3104
    ds_read_b64_tr_b16 v[246:247], v12 offset:3360
    v_mfma_f32_32x32x16_bf16 v[160:175], v[252:255], v[20:23], v[160:175]
    v_and_b32 v9, 1, v9
    buffer_load_dwordx4 v[76:79], v6, s[8:11], s53 offen offset:3072 sc1
    ds_read_b64_tr_b16 v[248:249], v12 offset:3136
    ds_read_b64_tr_b16 v[250:251], v12 offset:3392
    s_waitcnt lgkmcnt(10)
    v_mfma_f32_32x32x16_bf16 v[192:207], v[224:227], v[24:27], v[192:207]
    v_cmp_ne_u32 vcc, 0, v9
    s_add_u32 s53, s44, 16384
    ds_read_b64_tr_b16 v[252:253], v12 offset:3168
    ds_read_b64_tr_b16 v[254:255], v12 offset:3424
    v_mfma_f32_32x32x16_bf16 v[176:191], v[228:231], v[24:27], v[176:191]
    s_cbranch_vccnz L_rt_76
L_ok_77:
    buffer_load_dwordx4 v[80:83], v6, s[8:11], s53 offen offset:0 sc1
    ds_read_b64_tr_b16 v[224:225], v12 offset:4096
    ds_read_b64_tr_b16 v[226:227], v12 offset:4352
    s_waitcnt lgkmcnt(10)
    v_mfma_f32_32x32x16_bf16 v[144:159], v[232:235], v[24:27], v[144:159]
    ds_read_b64_tr_b16 v[228:229], v12 offset:4128
    ds_read_b64_tr_b16 v[230:231], v12 offset:4384
    v_mfma_f32_32x32x16_bf16 v[160:175], v[236:239], v[24:27], v[160:175]
    buffer_load_dwordx4 v[84:87], v6, s[8:11], s53 offen offset:1024 sc1
    ds_read_b64_tr_b16 v[232:233], v12 offset:4160
    ds_read_b64_tr_b16 v[234:235], v12 offset:4416
    s_waitcnt lgkmcnt(10)
    v_mfma_f32_32x32x16_bf16 v[192:207], v[240:243], v[28:31], v[192:207]
    ds_read_b64_tr_b16 v[236:237], v12 offset:4192
    ds_read_b64_tr_b16 v[238:239], v12 offset:4448
    v_mfma_f32_32x32x16_bf16 v[176:191], v[244:247], v[28:31], v[176:191]
    buffer_load_dwordx4 v[88:91], v6, s[8:11], s53 offen offset:2048 sc1
    ds_read_b64_tr_b16 v[240:241], v12 offset:5120
    ds_read_b64_tr_b16 v[242:243], v12 offset:5376
    s_waitcnt lgkmcnt(10)
    v_mfma_f32_32x32x16_bf16 v[144:159], v[248:251], v[28:31], v[144:159]
    ds_read_b64_tr_b16 v[244:245], v12 offset:5152
    ds_read_b64_tr_b16 v[246:247], v12 offset:5408
    v_mfma_f32_32x32x16_bf16 v[160:175], v[252:255], v[28:31], v[160:175]
    buffer_load_dwordx4 v[92:95], v6, s[8:11], s53 offen offset:3072 sc1
    s_add_u32 s53, s44, 20480
    ds_read_b64_tr_b16 v[248:249], v12 offset:5184
    ds_read_b64_tr_b16 v[250:251], v12 offset:5440
    s_waitcnt lgkmcnt(10)
    v_mfma_f32_32x32x16_bf16 v[192:207], v[224:227], v[32:35], v[192:207]
    ds_read_b64_tr_b16 v[252:253], v12 offset:5216
    ds_read_b64_tr_b16 v[254:255], v12 offset:5472
    v_mfma_f32_32x32x16_bf16 v[176:191], v[228:231], v[32:35], v[176:191]
    buffer_load_dwordx4 v[96:99], v6, s[8:11], s53 offen offset:0 sc1
    ds_read_b64_tr_b16 v[224:225], v12 offset:6144
    ds_read_b64_tr_b16 v[226:227], v12 offset:6400
    s_waitcnt lgkmcnt(10)
    v_mfma_f32_32x32x16_bf16 v[144:159], v[232:235], v[32:35], v[144:159]
    ds_read_b64_tr_b16 v[228:229], v12 offset:6176
    ds_read_b64_tr_b16 v[230:231], v12 offset:6432
    v_mfma_f32_32x32x16_bf16 v[160:175], v[236:239], v[32:35], v[160:175]
    buffer_load_dwordx4 v[100:103], v6, s[8:11], s53 offen offset:1024 sc1
    ds_read_b64_tr_b16 v[232:233], v12 offset:6208
    ds_read_b64_tr_b16 v[234:235], v12 offset:6464
    s_waitcnt lgkmcnt(10)
    v_mfma_f32_32x32x16_bf16 v[192:207], v[240:243], v[36:39], v[192:207]
    ds_read_b64_tr_b16 v[236:237], v12 offset:6240
    ds_read_b64_tr_b16 v[238:239], v12 offset:6496
    v_mfma_f32_32x32x16_bf16 v[176:191], v[244:247], v[36:39], v[176:191]
    buffer_load_dwordx4 v[104:107], v6, s[8:11], s53 offen offset:2048 sc1
    s_waitcnt vmcnt(11)
    ds_read_b64_tr_b16 v[240:241], v12 offset:7168
    ds_read_b64_tr_b16 v[242:243], v12 offset:7424
    s_waitcnt lgkmcnt(10)
    v_mfma_f32_32x32x16_bf16 v[144:159], v[248:251], v[36:39], v[144:159]
    v_or3_b32 v9, v48, v52, v56
    v_or_b32 v9, v9, v60
    ds_read_b64_tr_b16 v[244:245], v12 offset:7200
    ds_read_b64_tr_b16 v[246:247], v12 offset:7456
    v_mfma_f32_32x32x16_bf16 v[160:175], v[252:255], v[36:39], v[160:175]
    v_and_b32 v9, 1, v9
    buffer_load_dwordx4 v[108:111], v6, s[8:11], s53 offen offset:3072 sc1
    ds_read_b64_tr_b16 v[248:249], v12 offset:7232
    ds_read_b64_tr_b16 v[250:251], v12 offset:7488
    s_waitcnt lgkmcnt(10)
    v_mfma_f32_32x32x16_bf16 v[192:207], v[224:227], v[40:43], v[192:207]
    v_cmp_ne_u32 vcc, 0, v9
    s_add_u32 s53, s44, 24576
    ds_read_b64_tr_b16 v[252:253], v12 offset:7264
    ds_read_b64_tr_b16 v[254:255], v12 offset:7520
    v_mfma_f32_32x32x16_bf16 v[176:191], v[228:231], v[40:43], v[176:191]
    s_cbranch_vccnz L_rt_78
L_ok_79:
    buffer_load_dwordx4 v[112:115], v6, s[8:11], s53 offen offset:0 sc1
    s_barrier
    ds_read_b64_tr_b16 v[224:225], v12 offset:8192
    ds_read_b64_tr_b16 v[226:227], v12 offset:8448
    s_waitcnt lgkmcnt(10)
    v_mfma_f32_32x32x16_bf16 v[144:159], v[232:235], v[40:43], v[144:159]
    s_add_u32 m0, s40, 0
    s_mov_b32 s39, 917504
    ds_read_b64_tr_b16 v[228:229], v12 offset:8224
    ds_read_b64_tr_b16 v[230:231], v12 offset:8480
    v_mfma_f32_32x32x16_bf16 v[160:175], v[236:239], v[40:43], v[160:175]
    buffer_load_dwordx4 v13, s[60:63], s39 offen lds
    s_add_u32 m0, s40, 1024
    s_mov_b32 s39, 974848
    ds_read_b64_tr_b16 v[232:233], v12 offset:8256
    ds_read_b64_tr_b16 v[234:235], v12 offset:8512
    s_waitcnt lgkmcnt(10)
    v_mfma_f32_32x32x16_bf16 v[192:207], v[240:243], v[44:47], v[192:207]
    ds_read_b64_tr_b16 v[236:237], v12 offset:8288
    ds_read_b64_tr_b16 v[238:239], v12 offset:8544
    v_mfma_f32_32x32x16_bf16 v[176:191], v[244:247], v[44:47], v[176:191]
    buffer_load_dwordx4 v13, s[60:63], s39 offen lds
    s_add_u32 m0, s40, 2048
    s_mov_b32 s39, 1032192
    ds_read_b64_tr_b16 v[240:241], v12 offset:9216
    ds_read_b64_tr_b16 v[242:243], v12 offset:9472
    s_waitcnt lgkmcnt(10)
    v_mfma_f32_32x32x16_bf16 v[144:159], v[248:251], v[44:47], v[144:159]
    ds_read_b64_tr_b16 v[244:245], v12 offset:9248
    ds_read_b64_tr_b16 v[246:247], v12 offset:9504
    v_mfma_f32_32x32x16_bf16 v[160:175], v[252:255], v[44:47], v[160:175]
    buffer_load_dwordx4 v13, s[60:63], s39 offen lds
    s_add_u32 m0, s40, 3072
    s_mov_b32 s39, 1089536
    ds_read_b64_tr_b16 v[248:249], v12 offset:9280
    ds_read_b64_tr_b16 v[250:251], v12 offset:9536
    s_waitcnt lgkmcnt(10)
    v_mfma_f32_32x32x16_bf16 v[192:207], v[224:227], v[48:51], v[192:207]
    ds_read_b64_tr_b16 v[252:253], v12 offset:9312
    ds_read_b64_tr_b16 v[254:255], v12 offset:9568
    v_mfma_f32_32x32x16_bf16 v[176:191], v[228:231], v[48:51], v[176:191]
    buffer_load_dwordx4 v13, s[60:63], s39 offen lds
    s_add_u32 m0, s40, 4096
    s_mov_b32 s39, 1146880
    ds_read_b64_tr_b16 v[224:225], v12 offset:10240
    ds_read_b64_tr_b16 v[226:227], v12 offset:10496
    s_waitcnt lgkmcnt(10)
    v_mfma_f32_32x32x16_bf16 v[144:159], v[232:235], v[48:51], v[144:159]
    ds_read_b64_tr_b16 v[228:229], v12 offset:10272
    ds_read_b64_tr_b16 v[230:231], v12 offset:10528
    v_mfma_f32_32x32x16_bf16 v[160:175], v[236:239], v[48:51], v[160:175]
    buffer_load_dwordx4 v13, s[60:63], s39 offen lds
    s_add_u32 m0, s40, 5120
    s_mov_b32 s39, 1204224
    ds_read_b64_tr_b16 v[232:233], v12 offset:10304
    ds_read_b64_tr_b16 v[234:235], v12 offset:10560
    s_waitcnt lgkmcnt(10)
    v_mfma_f32_32x32x16_bf16 v[192:207], v[240:243], v[52:55], v[192:207]
    ds_read_b64_tr_b16 v[236:237], v12 offset:10336
    ds_read_b64_tr_b16 v[238:239], v12 offset:10592
    v_mfma_f32_32x32x16_bf16 v[176:191], v[244:247], v[52:55], v[176:191]
    buffer_load_dwordx4 v13, s[60:63], s39 offen lds
    s_waitcnt vmcnt(15)
    ds_read_b64_tr_b16 v[240:241], v12 offset:11264
    ds_read_b64_tr_b16 v[242:243], v12 offset:11520
    s_waitcnt lgkmcnt(10)
    v_mfma_f32_32x32x16_bf16 v[144:159], v[248:251], v[52:55], v[144:159]
    v_or3_b32 v9, v64, v68, v72
    v_or_b32 v9, v9, v76
    ds_read_b64_tr_b16 v[244:245], v12 offset:11296
    ds_read_b64_tr_b16 v[246:247], v12 offset:11552
    v_mfma_f32_32x32x16_bf16 v[160:175], v[252:255], v[52:55], v[160:175]
    v_and_b32 v9, 1, v9
    buffer_load_dwordx4 v[116:119], v6, s[8:11], s53 offen offset:1024 sc1
    ds_read_b64_tr_b16 v[248:249], v12 offset:11328
    ds_read_b64_tr_b16 v[250:251], v12 offset:11584
    s_waitcnt lgkmcnt(10)
    v_mfma_f32_32x32x16_bf16 v[192:207], v[224:227], v[56:59], v[192:207]
    v_cmp_ne_u32 vcc, 0, v9
    ds_read_b64_tr_b16 v[252:253], v12 offset:11360
    ds_read_b64_tr_b16 v[254:255], v12 offset:11616
    v_mfma_f32_32x32x16_bf16 v[176:191], v[228:231], v[56:59], v[176:191]
    s_cbranch_vccnz L_rt_80
L_ok_81:
    buffer_load_dwordx4 v[120:123], v6, s[8:11], s53 offen offset:2048 sc1
    s_barrier
    ds_read_b64_tr_b16 v[224:225], v12 offset:12288
    ds_read_b64_tr_b16 v[226:227], v12 offset:12544
    s_waitcnt lgkmcnt(10)
    v_mfma_f32_32x32x16_bf16 v[144:159], v[232:235], v[56:59], v[144:159]
    s_add_u32 m0, s40, 6144
    s_mov_b32 s39, 1261568
    ds_read_b64_tr_b16 v[228:229], v12 offset:12320
    ds_read_b64_tr_b16 v[230:231], v12 offset:12576
    v_mfma_f32_32x32x16_bf16 v[160:175], v[236:239], v[56:59], v[160:175]
    buffer_load_dwordx4 v13, s[60:63], s39 offen lds
    s_add_u32 m0, s40, 7168
    s_mov_b32 s39, 1318912
    ds_read_b64_tr_b16 v[232:233], v12 offset:12352
    ds_read_b64_tr_b16 v[234:235], v12 offset:12608
    s_waitcnt lgkmcnt(10)
    v_mfma_f32_32x32x16_bf16 v[192:207], v[240:243], v[60:63], v[192:207]
    ds_read_b64_tr_b16 v[236:237], v12 offset:12384
    ds_read_b64_tr_b16 v[238:239], v12 offset:12640
    v_mfma_f32_32x32x16_bf16 v[176:191], v[244:247], v[60:63], v[176:191]
    buffer_load_dwordx4 v13, s[60:63], s39 offen lds
    ds_read_b64_tr_b16 v[240:241], v12 offset:13312
    ds_read_b64_tr_b16 v[242:243], v12 offset:13568
    s_waitcnt lgkmcnt(10)
    v_mfma_f32_32x32x16_bf16 v[144:159], v[248:251], v[60:63], v[144:159]
    ds_read_b64_tr_b16 v[244:245], v12 offset:13344
    ds_read_b64_tr_b16 v[246:247], v12 offset:13600
    v_mfma_f32_32x32x16_bf16 v[160:175], v[252:255], v[60:63], v[160:175]
    buffer_load_dwordx4 v[124:127], v6, s[8:11], s53 offen offset:3072 sc1
    s_add_u32 m0, s40, 8192
    s_mov_b32 s39, 1376256
    ds_read_b64_tr_b16 v[248:249], v12 offset:13376
    ds_read_b64_tr_b16 v[250:251], v12 offset:13632
    s_waitcnt lgkmcnt(10)
    v_mfma_f32_32x32x16_bf16 v[192:207], v[224:227], v[64:67], v[192:207]
    ds_read_b64_tr_b16 v[252:253], v12 offset:13408
    ds_read_b64_tr_b16 v[254:255], v12 offset:13664
    v_mfma_f32_32x32x16_bf16 v[176:191], v[228:231], v[64:67], v[176:191]
    buffer_load_dwordx4 v13, s[60:63], s39 offen lds
    s_add_u32 m0, s40, 9216
    s_mov_b32 s39, 1433600
    ds_read_b64_tr_b16 v[224:225], v12 offset:14336
    ds_read_b64_tr_b16 v[226:227], v12 offset:14592
    s_waitcnt lgkmcnt(10)
    v_mfma_f32_32x32x16_bf16 v[144:159], v[232:235], v[64:67], v[144:159]
    ds_read_b64_tr_b16 v[228:229], v12 offset:14368
    ds_read_b64_tr_b16 v[230:231], v12 offset:14624
    v_mfma_f32_32x32x16_bf16 v[160:175], v[236:239], v[64:67], v[160:175]
    buffer_load_dwordx4 v13, s[60:63], s39 offen lds
    ds_read_b64_tr_b16 v[232:233], v12 offset:14400
    ds_read_b64_tr_b16 v[234:235], v12 offset:14656
    s_waitcnt lgkmcnt(10)
    v_mfma_f32_32x32x16_bf16 v[192:207], v[240:243], v[68:71], v[192:207]
    ds_read_b64_tr_b16 v[236:237], v12 offset:14432
    ds_read_b64_tr_b16 v[238:239], v12 offset:14688
    v_mfma_f32_32x32x16_bf16 v[176:191], v[244:247], v[68:71], v[176:191]
    buffer_store_dwordx4 a[232:235], v8, s[8:11], s56 offen offset:0 sc1
    s_add_u32 s53, s44, 28672
    s_waitcnt vmcnt(19)
    ds_read_b64_tr_b16 v[240:241], v12 offset:15360
    ds_read_b64_tr_b16 v[242:243], v12 offset:15616
    s_waitcnt lgkmcnt(10)
    v_mfma_f32_32x32x16_bf16 v[144:159], v[248:251], v[68:71], v[144:159]
    v_or3_b32 v9, v80, v84, v88
    v_or_b32 v9, v9, v92
    ds_read_b64_tr_b16 v[244:245], v12 offset:15392
    ds_read_b64_tr_b16 v[246:247], v12 offset:15648
    v_mfma_f32_32x32x16_bf16 v[160:175], v[252:255], v[68:71], v[160:175]
    v_and_b32 v9, 1, v9
    buffer_load_dwordx4 v[128:131], v6, s[8:11], s53 offen offset:0 sc1
    ds_read_b64_tr_b16 v[248:249], v12 offset:15424
    ds_read_b64_tr_b16 v[250:251], v12 offset:15680
    s_waitcnt lgkmcnt(10)
    v_mfma_f32_32x32x16_bf16 v[192:207], v[224:227], v[72:75], v[192:207]
    v_cmp_ne_u32 vcc, 0, v9
    ds_read_b64_tr_b16 v[252:253], v12 offset:15456
    ds_read_b64_tr_b16 v[254:255], v12 offset:15712
    v_mfma_f32_32x32x16_bf16 v[176:191], v[228:231], v[72:75], v[176:191]
    s_cbranch_vccnz L_rt_82
L_ok_83:
    buffer_load_dwordx4 v[132:135], v6, s[8:11], s53 offen offset:1024 sc1
    s_waitcnt vmcnt(12)
    s_barrier
    ds_read_b64_tr_b16 v[224:225], v12 offset:0
    ds_read_b64_tr_b16 v[226:227], v12 offset:256
    s_waitcnt lgkmcnt(10)
    v_mfma_f32_32x32x16_bf16 v[144:159], v[232:235], v[72:75], v[144:159]
    s_add_u32 m0, s40, 10240
    s_mov_b32 s39, 1490944
    ds_read_b64_tr_b16 v[228:229], v12 offset:32
    ds_read_b64_tr_b16 v[230:231], v12 offset:288
    v_mfma_f32_32x32x16_bf16 v[160:175], v[236:239], v[72:75], v[160:175]
    buffer_load_dwordx4 v13, s[60:63], s39 offen lds
    s_add_u32 m0, s40, 11264
    s_mov_b32 s39, 1548288
    ds_read_b64_tr_b16 v[232:233], v12 offset:64
    ds_read_b64_tr_b16 v[234:235], v12 offset:320
    s_waitcnt lgkmcnt(10)
    v_mfma_f32_32x32x16_bf16 v[192:207], v[240:243], v[76:79], v[192:207]
    ds_read_b64_tr_b16 v[236:237], v12 offset:96
    ds_read_b64_tr_b16 v[238:239], v12 offset:352
    v_mfma_f32_32x32x16_bf16 v[176:191], v[244:247], v[76:79], v[176:191]
    buffer_load_dwordx4 v13, s[60:63], s39 offen lds
    ds_read_b64_tr_b16 v[240:241], v12 offset:1024
    ds_read_b64_tr_b16 v[242:243], v12 offset:1280
    s_waitcnt lgkmcnt(10)
    v_mfma_f32_32x32x16_bf16 v[144:159], v[248:251], v[76:79], v[144:159]
    ds_read_b64_tr_b16 v[244:245], v12 offset:1056
    ds_read_b64_tr_b16 v[246:247], v12 offset:1312
    v_mfma_f32_32x32x16_bf16 v[160:175], v[252:255], v[76:79], v[160:175]
    buffer_store_dwordx4 a[236:239], v8, s[8:11], s56 offen offset:512 sc1
    ds_read_b64_tr_b16 v[248:249], v12 offset:1088
    ds_read_b64_tr_b16 v[250:251], v12 offset:1344
    s_waitcnt lgkmcnt(10)
    v_mfma_f32_32x32x16_bf16 v[192:207], v[224:227], v[80:83], v[192:207]
    ds_read_b64_tr_b16 v[252:253], v12 offset:1120
    ds_read_b64_tr_b16 v[254:255], v12 offset:1376
    v_mfma_f32_32x32x16_bf16 v[176:191], v[228:231], v[80:83], v[176:191]
    buffer_load_dwordx4 v[136:139], v6, s[8:11], s53 offen offset:2048 sc1
    ds_read_b64_tr_b16 v[224:225], v12 offset:2048
    ds_read_b64_tr_b16 v[226:227], v12 offset:2304
    s_waitcnt lgkmcnt(10)
    v_mfma_f32_32x32x16_bf16 v[144:159], v[232:235], v[80:83], v[144:159]
    ds_read_b64_tr_b16 v[228:229], v12 offset:2080
    ds_read_b64_tr_b16 v[230:231], v12 offset:2336
    v_mfma_f32_32x32x16_bf16 v[160:175], v[236:239], v[80:83], v[160:175]
    buffer_load_dwordx4 v[140:143], v6, s[8:11], s53 offen offset:3072 sc1
    s_add_u32 m0, s40, 12288
    s_mov_b32 s39, 1605632
    ds_read_b64_tr_b16 v[232:233], v12 offset:2112
    ds_read_b64_tr_b16 v[234:235], v12 offset:2368
    s_waitcnt lgkmcnt(10)
    v_mfma_f32_32x32x16_bf16 v[192:207], v[240:243], v[84:87], v[192:207]
    ds_read_b64_tr_b16 v[236:237], v12 offset:2144
    ds_read_b64_tr_b16 v[238:239], v12 offset:2400
    v_mfma_f32_32x32x16_bf16 v[176:191], v[244:247], v[84:87], v[176:191]
    buffer_load_dwordx4 v13, s[60:63], s39 offen lds
    s_add_u32 m0, s40, 13312
    s_mov_b32 s39, 1662976
    s_waitcnt vmcnt(23)
    ds_read_b64_tr_b16 v[240:241], v12 offset:3072
    ds_read_b64_tr_b16 v[242:243], v12 offset:3328
    s_waitcnt lgkmcnt(10)
    v_mfma_f32_32x32x16_bf16 v[144:159], v[248:251], v[84:87], v[144:159]
    v_or3_b32 v9, v96, v100, v104
    v_or_b32 v9, v9, v108
    ds_read_b64_tr_b16 v[244:245], v12 offset:3104
    ds_read_b64_tr_b16 v[246:247], v12 offset:3360
    v_mfma_f32_32x32x16_bf16 v[160:175], v[252:255], v[84:87], v[160:175]
    v_and_b32 v9, 1, v9
    buffer_load_dwordx4 v13, s[60:63], s39 offen lds
    ds_read_b64_tr_b16 v[248:249], v12 offset:3136
    ds_read_b64_tr_b16 v[250:251], v12 offset:3392
    s_waitcnt lgkmcnt(10)
    v_mfma_f32_32x32x16_bf16 v[192:207], v[224:227], v[88:91], v[192:207]
    v_cmp_ne_u32 vcc, 0, v9
    ds_read_b64_tr_b16 v[252:253], v12 offset:3168
    ds_read_b64_tr_b16 v[254:255], v12 offset:3424
    v_mfma_f32_32x32x16_bf16 v[176:191], v[228:231], v[88:91], v[176:191]
    s_cbranch_vccnz L_rt_84
L_ok_85:
    s_add_u32 m0, s40, 14336
    s_mov_b32 s39, 1720320
    s_waitcnt vmcnt(13)
    s_barrier
    ds_read_b64_tr_b16 v[224:225], v12 offset:4096
    ds_read_b64_tr_b16 v[226:227], v12 offset:4352
    s_waitcnt lgkmcnt(10)
    v_mfma_f32_32x32x16_bf16 v[144:159], v[232:235], v[88:91], v[144:159]
    buffer_load_dwordx4 v13, s[60:63], s39 offen lds
    ds_read_b64_tr_b16 v[228:229], v12 offset:4128
    ds_read_b64_tr_b16 v[230:231], v12 offset:4384
    v_mfma_f32_32x32x16_bf16 v[160:175], v[236:239], v[88:91], v[160:175]
    s_add_u32 m0, s40, 15360
    s_mov_b32 s39, 1777664
    ds_read_b64_tr_b16 v[232:233], v12 offset:4160
    ds_read_b64_tr_b16 v[234:235], v12 offset:4416
    s_waitcnt lgkmcnt(10)
    v_mfma_f32_32x32x16_bf16 v[192:207], v[240:243], v[92:95], v[192:207]
    buffer_load_dwordx4 v13, s[60:63], s39 offen lds
    ds_read_b64_tr_b16 v[236:237], v12 offset:4192
    ds_read_b64_tr_b16 v[238:239], v12 offset:4448
    v_mfma_f32_32x32x16_bf16 v[176:191], v[244:247], v[92:95], v[176:191]
    s_add_u32 m0, s40, 0
    s_add_u32 s39, s38, 45056
    ds_read_b64_tr_b16 v[240:241], v12 offset:5120
    ds_read_b64_tr_b16 v[242:243], v12 offset:5376
    s_waitcnt lgkmcnt(10)
    v_mfma_f32_32x32x16_bf16 v[144:159], v[248:251], v[92:95], v[144:159]
    buffer_load_dwordx4 v6, s[8:11], s39 offen sc1 lds
    ds_read_b64_tr_b16 v[244:245], v12 offset:5152
    ds_read_b64_tr_b16 v[246:247], v12 offset:5408
    v_mfma_f32_32x32x16_bf16 v[160:175], v[252:255], v[92:95], v[160:175]
    s_add_u32 m0, s40, 1024
    s_add_u32 s39, s38, 49152
    ds_read_b64_tr_b16 v[248:249], v12 offset:5184
    ds_read_b64_tr_b16 v[250:251], v12 offset:5440
    s_waitcnt lgkmcnt(10)
    v_mfma_f32_32x32x16_bf16 v[192:207], v[224:227], v[96:99], v[192:207]
    buffer_load_dwordx4 v6, s[8:11], s39 offen sc1 lds
    ds_read_b64_tr_b16 v[252:253], v12 offset:5216
    ds_read_b64_tr_b16 v[254:255], v12 offset:5472
    v_mfma_f32_32x32x16_bf16 v[176:191], v[228:231], v[96:99], v[176:191]
    ds_read_b64_tr_b16 v[224:225], v12 offset:6144
    ds_read_b64_tr_b16 v[226:227], v12 offset:6400
    s_waitcnt lgkmcnt(10)
    v_mfma_f32_32x32x16_bf16 v[144:159], v[232:235], v[96:99], v[144:159]
    ds_read_b64_tr_b16 v[228:229], v12 offset:6176
    ds_read_b64_tr_b16 v[230:231], v12 offset:6432
    v_mfma_f32_32x32x16_bf16 v[160:175], v[236:239], v[96:99], v[160:175]
    ds_read_b64_tr_b16 v[232:233], v12 offset:6208
    ds_read_b64_tr_b16 v[234:235], v12 offset:6464
    s_waitcnt lgkmcnt(10)
    v_mfma_f32_32x32x16_bf16 v[192:207], v[240:243], v[100:103], v[192:207]
    ds_read_b64_tr_b16 v[236:237], v12 offset:6240
    ds_read_b64_tr_b16 v[238:239], v12 offset:6496
    v_mfma_f32_32x32x16_bf16 v[176:191], v[244:247], v[100:103], v[176:191]
    s_waitcnt vmcnt(16)
    ds_read_b64_tr_b16 v[240:241], v12 offset:7168
    ds_read_b64_tr_b16 v[242:243], v12 offset:7424
    s_waitcnt lgkmcnt(10)
    v_mfma_f32_32x32x16_bf16 v[144:159], v[248:251], v[100:103], v[144:159]
    v_or3_b32 v9, v112, v116, v120
    v_or_b32 v9, v9, v124
    ds_read_b64_tr_b16 v[244:245], v12 offset:7200
    ds_read_b64_tr_b16 v[246:247], v12 offset:7456
    v_mfma_f32_32x32x16_bf16 v[160:175], v[252:255], v[100:103], v[160:175]
    v_and_b32 v9, 1, v9
    ds_read_b64_tr_b16 v[248:249], v12 offset:7232
    ds_read_b64_tr_b16 v[250:251], v12 offset:7488
    s_waitcnt lgkmcnt(10)
    v_mfma_f32_32x32x16_bf16 v[192:207], v[224:227], v[104:107], v[192:207]
    v_cmp_ne_u32 vcc, 0, v9
    ds_read_b64_tr_b16 v[252:253], v12 offset:7264
    ds_read_b64_tr_b16 v[254:255], v12 offset:7520
    v_mfma_f32_32x32x16_bf16 v[176:191], v[228:231], v[104:107], v[176:191]
    s_cbranch_vccnz L_rt_86
L_ok_87:
    s_add_u32 m0, s40, 2048
    s_add_u32 s39, s38, 53248
    s_waitcnt vmcnt(9)
    s_barrier
    ds_read_b64_tr_b16 v[224:225], v12 offset:8192
    ds_read_b64_tr_b16 v[226:227], v12 offset:8448
    s_waitcnt lgkmcnt(10)
    v_mfma_f32_32x32x16_bf16 v[144:159], v[232:235], v[104:107], v[144:159]
    buffer_load_dwordx4 v6, s[8:11], s39 offen sc1 lds
    ds_read_b64_tr_b16 v[228:229], v12 offset:8224
    ds_read_b64_tr_b16 v[230:231], v12 offset:8480
    v_mfma_f32_32x32x16_bf16 v[160:175], v[236:239], v[104:107], v[160:175]
    s_add_u32 m0, s40, 3072
    s_add_u32 s39, s38, 57344
    ds_read_b64_tr_b16 v[232:233], v12 offset:8256
    ds_read_b64_tr_b16 v[234:235], v12 offset:8512
    s_waitcnt lgkmcnt(10)
    v_mfma_f32_32x32x16_bf16 v[192:207], v[240:243], v[108:111], v[192:207]
    buffer_load_dwordx4 v6, s[8:11], s39 offen sc1 lds
    ds_read_b64_tr_b16 v[236:237], v12 offset:8288
    ds_read_b64_tr_b16 v[238:239], v12 offset:8544
    v_mfma_f32_32x32x16_bf16 v[176:191], v[244:247], v[108:111], v[176:191]
    s_add_u32 m0, s40, 4096
    s_add_u32 s39, s38, 61440
    ds_read_b64_tr_b16 v[240:241], v12 offset:9216
    ds_read_b64_tr_b16 v[242:243], v12 offset:9472
    s_waitcnt lgkmcnt(10)
    v_mfma_f32_32x32x16_bf16 v[144:159], v[248:251], v[108:111], v[144:159]
    buffer_load_dwordx4 v6, s[8:11], s39 offen sc1 lds
    ds_read_b64_tr_b16 v[244:245], v12 offset:9248
    ds_read_b64_tr_b16 v[246:247], v12 offset:9504
    v_mfma_f32_32x32x16_bf16 v[160:175], v[252:255], v[108:111], v[160:175]
    ds_read_b64_tr_b16 v[248:249], v12 offset:9280
    ds_read_b64_tr_b16 v[250:251], v12 offset:9536
    s_waitcnt lgkmcnt(10)
    v_mfma_f32_32x32x16_bf16 v[192:207], v[224:227], v[112:115], v[192:207]
    ds_read_b64_tr_b16 v[252:253], v12 offset:9312
    ds_read_b64_tr_b16 v[254:255], v12 offset:9568
    v_mfma_f32_32x32x16_bf16 v[176:191], v[228:231], v[112:115], v[176:191]
    ds_read_b64_tr_b16 v[224:225], v12 offset:10240
    ds_read_b64_tr_b16 v[226:227], v12 offset:10496
    s_waitcnt lgkmcnt(10)
    v_mfma_f32_32x32x16_bf16 v[144:159], v[232:235], v[112:115], v[144:159]
    ds_read_b64_tr_b16 v[228:229], v12 offset:10272
    ds_read_b64_tr_b16 v[230:231], v12 offset:10528
    v_mfma_f32_32x32x16_bf16 v[160:175], v[236:239], v[112:115], v[160:175]
    ds_read_b64_tr_b16 v[232:233], v12 offset:10304
    ds_read_b64_tr_b16 v[234:235], v12 offset:10560
    s_waitcnt lgkmcnt(10)
    v_mfma_f32_32x32x16_bf16 v[192:207], v[240:243], v[116:119], v[192:207]
    ds_read_b64_tr_b16 v[236:237], v12 offset:10336
    ds_read_b64_tr_b16 v[238:239], v12 offset:10592
    v_mfma_f32_32x32x16_bf16 v[176:191], v[244:247], v[116:119], v[176:191]
    s_waitcnt vmcnt(9)
    ds_read_b64_tr_b16 v[240:241], v12 offset:11264
    ds_read_b64_tr_b16 v[242:243], v12 offset:11520
    s_waitcnt lgkmcnt(10)
    v_mfma_f32_32x32x16_bf16 v[144:159], v[248:251], v[116:119], v[144:159]
    v_or3_b32 v9, v128, v132, v136
    v_or_b32 v9, v9, v140
    ds_read_b64_tr_b16 v[244:245], v12 offset:11296
    ds_read_b64_tr_b16 v[246:247], v12 offset:11552
    v_mfma_f32_32x32x16_bf16 v[160:175], v[252:255], v[116:119], v[160:175]
    v_and_b32 v9, 1, v9
    ds_read_b64_tr_b16 v[248:249], v12 offset:11328
    ds_read_b64_tr_b16 v[250:251], v12 offset:11584
    s_waitcnt lgkmcnt(10)
    v_mfma_f32_32x32x16_bf16 v[192:207], v[224:227], v[120:123], v[192:207]
    v_cmp_ne_u32 vcc, 0, v9
    ds_read_b64_tr_b16 v[252:253], v12 offset:11360
    ds_read_b64_tr_b16 v[254:255], v12 offset:11616
    v_mfma_f32_32x32x16_bf16 v[176:191], v[228:231], v[120:123], v[176:191]
    s_cbranch_vccnz L_rt_88
L_ok_89:
    s_waitcnt vmcnt(5)
    s_barrier
    ds_read_b64_tr_b16 v[224:225], v12 offset:12288
    ds_read_b64_tr_b16 v[226:227], v12 offset:12544
    s_waitcnt lgkmcnt(10)
    v_mfma_f32_32x32x16_bf16 v[144:159], v[232:235], v[120:123], v[144:159]
    ds_read_b64_tr_b16 v[228:229], v12 offset:12320
    ds_read_b64_tr_b16 v[230:231], v12 offset:12576
    v_mfma_f32_32x32x16_bf16 v[160:175], v[236:239], v[120:123], v[160:175]
    ds_read_b64_tr_b16 v[232:233], v12 offset:12352
    ds_read_b64_tr_b16 v[234:235], v12 offset:12608
    s_waitcnt lgkmcnt(10)
    v_mfma_f32_32x32x16_bf16 v[192:207], v[240:243], v[124:127], v[192:207]
    ds_read_b64_tr_b16 v[236:237], v12 offset:12384
    ds_read_b64_tr_b16 v[238:239], v12 offset:12640
    v_mfma_f32_32x32x16_bf16 v[176:191], v[244:247], v[124:127], v[176:191]
    ds_read_b64_tr_b16 v[240:241], v12 offset:13312
    ds_read_b64_tr_b16 v[242:243], v12 offset:13568
    s_waitcnt lgkmcnt(10)
    v_mfma_f32_32x32x16_bf16 v[144:159], v[248:251], v[124:127], v[144:159]
    ds_read_b64_tr_b16 v[244:245], v12 offset:13344
    ds_read_b64_tr_b16 v[246:247], v12 offset:13600
    v_mfma_f32_32x32x16_bf16 v[160:175], v[252:255], v[124:127], v[160:175]
    ds_read_b64_tr_b16 v[248:249], v12 offset:13376
    ds_read_b64_tr_b16 v[250:251], v12 offset:13632
    s_waitcnt lgkmcnt(10)
    v_mfma_f32_32x32x16_bf16 v[192:207], v[224:227], v[128:131], v[192:207]
    ds_read_b64_tr_b16 v[252:253], v12 offset:13408
    ds_read_b64_tr_b16 v[254:255], v12 offset:13664
    v_mfma_f32_32x32x16_bf16 v[176:191], v[228:231], v[128:131], v[176:191]
    ds_read_b64_tr_b16 v[224:225], v12 offset:14336
    ds_read_b64_tr_b16 v[226:227], v12 offset:14592
    s_waitcnt lgkmcnt(10)
    v_mfma_f32_32x32x16_bf16 v[144:159], v[232:235], v[128:131], v[144:159]
    ds_read_b64_tr_b16 v[228:229], v12 offset:14368
    ds_read_b64_tr_b16 v[230:231], v12 offset:14624
    v_mfma_f32_32x32x16_bf16 v[160:175], v[236:239], v[128:131], v[160:175]
    ds_read_b64_tr_b16 v[232:233], v12 offset:14400
    ds_read_b64_tr_b16 v[234:235], v12 offset:14656
    s_waitcnt lgkmcnt(10)
    v_mfma_f32_32x32x16_bf16 v[192:207], v[240:243], v[132:135], v[192:207]
    ds_read_b64_tr_b16 v[236:237], v12 offset:14432
    ds_read_b64_tr_b16 v[238:239], v12 offset:14688
    v_mfma_f32_32x32x16_bf16 v[176:191], v[244:247], v[132:135], v[176:191]
    ds_read_b64_tr_b16 v[240:241], v12 offset:15360
    ds_read_b64_tr_b16 v[242:243], v12 offset:15616
    s_waitcnt lgkmcnt(10)
    v_mfma_f32_32x32x16_bf16 v[144:159], v[248:251], v[132:135], v[144:159]
    ds_read_b64_tr_b16 v[244:245], v12 offset:15392
    ds_read_b64_tr_b16 v[246:247], v12 offset:15648
    v_mfma_f32_32x32x16_bf16 v[160:175], v[252:255], v[132:135], v[160:175]
    ds_read_b64_tr_b16 v[248:249], v12 offset:15424
    ds_read_b64_tr_b16 v[250:251], v12 offset:15680
    s_waitcnt lgkmcnt(10)
    v_mfma_f32_32x32x16_bf16 v[192:207], v[224:227], v[136:139], v[192:207]
    ds_read_b64_tr_b16 v[252:253], v12 offset:15456
    ds_read_b64_tr_b16 v[254:255], v12 offset:15712
    v_mfma_f32_32x32x16_bf16 v[176:191], v[228:231], v[136:139], v[176:191]
    ds_read_b64_tr_b16 v[224:225], v12 offset:24576
    ds_read_b64_tr_b16 v[226:227], v12 offset:24832
    s_waitcnt lgkmcnt(10)
    v_mfma_f32_32x32x16_bf16 v[144:159], v[232:235], v[136:139], v[144:159]
    ds_read_b64_tr_b16 v[228:229], v12 offset:24640
    ds_read_b64_tr_b16 v[230:231], v12 offset:24896
    v_mfma_f32_32x32x16_bf16 v[160:175], v[236:239], v[136:139], v[160:175]
    ds_read_b64_tr_b16 v[232:233], v12 offset:25600
    ds_read_b64_tr_b16 v[234:235], v12 offset:25856
    s_waitcnt lgkmcnt(10)
    v_mfma_f32_32x32x16_bf16 v[192:207], v[240:243], v[140:143], v[192:207]
    ds_read_b64_tr_b16 v[236:237], v12 offset:25664
    ds_read_b64_tr_b16 v[238:239], v12 offset:25920
    v_mfma_f32_32x32x16_bf16 v[176:191], v[244:247], v[140:143], v[176:191]
    ds_read_b64_tr_b16 v[240:241], v12 offset:26624
    ds_read_b64_tr_b16 v[242:243], v12 offset:26880
    s_waitcnt lgkmcnt(10)
    v_mfma_f32_32x32x16_bf16 v[144:159], v[248:251], v[140:143], v[144:159]
    ds_read_b64_tr_b16 v[244:245], v12 offset:26688
    ds_read_b64_tr_b16 v[246:247], v12 offset:26944
    v_mfma_f32_32x32x16_bf16 v[160:175], v[252:255], v[140:143], v[160:175]
    ds_read_b64_tr_b16 v[248:249], v12 offset:27648
    ds_read_b64_tr_b16 v[250:251], v12 offset:27904
    s_waitcnt lgkmcnt(10)
    v_mfma_f32_32x32x16_bf16 v[208:223], v[224:227], v[16:19], 0
    ds_read_b64_tr_b16 v[252:253], v12 offset:27712
    ds_read_b64_tr_b16 v[254:255], v12 offset:27968
    v_mfma_f32_32x32x16_bf16 v[208:223], v[228:231], v[20:23], v[208:223]
    ds_read_b64_tr_b16 v[224:225], v12 offset:28672
    ds_read_b64_tr_b16 v[226:227], v12 offset:28928
    s_waitcnt lgkmcnt(10)
    v_mfma_f32_32x32x16_bf16 v[208:223], v[232:235], v[24:27], v[208:223]
    v_max_f32 v192, 0, v192
    v_max_f32 v193, 0, v193
    ds_read_b64_tr_b16 v[228:229], v12 offset:28736
    ds_read_b64_tr_b16 v[230:231], v12 offset:28992
    v_mfma_f32_32x32x16_bf16 v[208:223], v[236:239], v[28:31], v[208:223]
    v_max_f32 v194, 0, v194
    v_max_f32 v195, 0, v195
    v_max_f32 v196, 0, v196
    ds_read_b64_tr_b16 v[232:233], v12 offset:29696
    ds_read_b64_tr_b16 v[234:235], v12 offset:29952
    s_waitcnt lgkmcnt(10)
    v_mfma_f32_32x32x16_bf16 v[208:223], v[240:243], v[32:35], v[208:223]
    v_max_f32 v197, 0, v197
    v_max_f32 v198, 0, v198
    ds_read_b64_tr_b16 v[236:237], v12 offset:29760
    ds_read_b64_tr_b16 v[238:239], v12 offset:30016
    v_mfma_f32_32x32x16_bf16 v[208:223], v[244:247], v[36:39], v[208:223]
    v_max_f32 v199, 0, v199
    v_mul_f32 v192, v192, v200
    v_mul_f32 v193, v193, v201
    ds_read_b64_tr_b16 v[240:241], v12 offset:30720
    ds_read_b64_tr_b16 v[242:243], v12 offset:30976
    s_waitcnt lgkmcnt(10)
    v_mfma_f32_32x32x16_bf16 v[208:223], v[248:251], v[40:43], v[208:223]
    v_mul_f32 v194, v194, v202
    v_mul_f32 v195, v195, v203
    ds_read_b64_tr_b16 v[244:245], v12 offset:30784
    ds_read_b64_tr_b16 v[246:247], v12 offset:31040
    v_mfma_f32_32x32x16_bf16 v[208:223], v[252:255], v[44:47], v[208:223]
    v_mul_f32 v196, v196, v204
    v_mul_f32 v197, v197, v205
    v_mul_f32 v198, v198, v206
    ds_read_b64_tr_b16 v[248:249], v12 offset:31744
    ds_read_b64_tr_b16 v[250:251], v12 offset:32000
    s_waitcnt lgkmcnt(10)
    v_mfma_f32_32x32x16_bf16 v[208:223], v[224:227], v[48:51], v[208:223]
    v_mul_f32 v199, v199, v207
    v_cvt_pk_bf16_f32 v200, v192, v193
    ds_read_b64_tr_b16 v[252:253], v12 offset:31808
    ds_read_b64_tr_b16 v[254:255], v12 offset:32064
    v_mfma_f32_32x32x16_bf16 v[208:223], v[228:231], v[52:55], v[208:223]
    v_cvt_pk_bf16_f32 v201, v194, v195
    v_cvt_pk_bf16_f32 v202, v196, v197
    v_cvt_pk_bf16_f32 v203, v198, v199
    ds_read_b64_tr_b16 v[224:225], v12 offset:32768
    ds_read_b64_tr_b16 v[226:227], v12 offset:33024
    s_waitcnt lgkmcnt(10)
    v_mfma_f32_32x32x16_bf16 v[208:223], v[232:235], v[56:59], v[208:223]
    v_or_b32 v200, 1, v200
    buffer_store_dwordx4 v[200:203], v6, s[8:11], s45 offen offset:0 sc1
    ds_read_b64_tr_b16 v[228:229], v12 offset:32832
    ds_read_b64_tr_b16 v[230:231], v12 offset:33088
    v_mfma_f32_32x32x16_bf16 v[208:223], v[236:239], v[60:63], v[208:223]
    v_max_f32 v176, 0, v176
    v_max_f32 v177, 0, v177
    v_max_f32 v178, 0, v178
    ds_read_b64_tr_b16 v[232:233], v12 offset:33792
    ds_read_b64_tr_b16 v[234:235], v12 offset:34048
    s_waitcnt lgkmcnt(10)
    v_mfma_f32_32x32x16_bf16 v[208:223], v[240:243], v[64:67], v[208:223]
    v_max_f32 v179, 0, v179
    v_max_f32 v180, 0, v180
    ds_read_b64_tr_b16 v[236:237], v12 offset:33856
    ds_read_b64_tr_b16 v[238:239], v12 offset:34112
    v_mfma_f32_32x32x16_bf16 v[208:223], v[244:247], v[68:71], v[208:223]
    v_max_f32 v181, 0, v181
    v_max_f32 v182, 0, v182
    v_max_f32 v183, 0, v183
    ds_read_b64_tr_b16 v[240:241], v12 offset:34816
    ds_read_b64_tr_b16 v[242:243], v12 offset:35072
    s_waitcnt lgkmcnt(10)
    v_mfma_f32_32x32x16_bf16 v[208:223], v[248:251], v[72:75], v[208:223]
    v_mul_f32 v176, v176, v184
    v_mul_f32 v177, v177, v185
    ds_read_b64_tr_b16 v[244:245], v12 offset:34880
    ds_read_b64_tr_b16 v[246:247], v12 offset:35136
    v_mfma_f32_32x32x16_bf16 v[208:223], v[252:255], v[76:79], v[208:223]
    v_mul_f32 v178, v178, v186
    v_mul_f32 v179, v179, v187
    v_mul_f32 v180, v180, v188
    s_waitcnt vmcnt(1)
    s_barrier
    ds_read_b64_tr_b16 v[248:249], v12 offset:0
    ds_read_b64_tr_b16 v[250:251], v12 offset:256
    s_waitcnt lgkmcnt(10)
    v_mfma_f32_32x32x16_bf16 v[208:223], v[224:227], v[80:83], v[208:223]
    v_mul_f32 v181, v181, v189
    v_mul_f32 v182, v182, v190
    ds_read_b64_tr_b16 v[252:253], v12 offset:64
    ds_read_b64_tr_b16 v[254:255], v12 offset:320
    v_mfma_f32_32x32x16_bf16 v[208:223], v[228:231], v[84:87], v[208:223]
    v_mul_f32 v183, v183, v191
    v_cvt_pk_bf16_f32 v184, v176, v177
    v_cvt_pk_bf16_f32 v185, v178, v179
    ds_read_b64_tr_b16 v[224:225], v12 offset:1024
    ds_read_b64_tr_b16 v[226:227], v12 offset:1280
    s_waitcnt lgkmcnt(10)
    v_mfma_f32_32x32x16_bf16 v[208:223], v[232:235], v[88:91], v[208:223]
    v_cvt_pk_bf16_f32 v186, v180, v181
    v_cvt_pk_bf16_f32 v187, v182, v183
    ds_read_b64_tr_b16 v[228:229], v12 offset:1088
    ds_read_b64_tr_b16 v[230:231], v12 offset:1344
    v_mfma_f32_32x32x16_bf16 v[208:223], v[236:239], v[92:95], v[208:223]
    v_or_b32 v184, 1, v184
    buffer_store_dwordx4 v[184:187], v6, s[8:11], s45 offen offset:1024 sc1
    ds_read_b64_tr_b16 v[232:233], v12 offset:2048
    ds_read_b64_tr_b16 v[234:235], v12 offset:2304
    s_waitcnt lgkmcnt(10)
    v_mfma_f32_32x32x16_bf16 v[208:223], v[240:243], v[96:99], v[208:223]
    v_max_f32 v144, 0, v144
    v_max_f32 v145, 0, v145
    ds_read_b64_tr_b16 v[236:237], v12 offset:2112
    ds_read_b64_tr_b16 v[238:239], v12 offset:2368
    v_mfma_f32_32x32x16_bf16 v[208:223], v[244:247], v[100:103], v[208:223]
    v_max_f32 v146, 0, v146
    v_max_f32 v147, 0, v147
    v_max_f32 v148, 0, v148
    ds_read_b64_tr_b16 v[240:241], v12 offset:3072
    ds_read_b64_tr_b16 v[242:243], v12 offset:3328
    s_waitcnt lgkmcnt(10)
    v_mfma_f32_32x32x16_bf16 v[208:223], v[248:251], v[104:107], v[208:223]
    v_max_f32 v149, 0, v149
    v_max_f32 v150, 0, v150
    ds_read_b64_tr_b16 v[244:245], v12 offset:3136
    ds_read_b64_tr_b16 v[246:247], v12 offset:3392
    v_mfma_f32_32x32x16_bf16 v[208:223], v[252:255], v[108:111], v[208:223]
    v_max_f32 v151, 0, v151
    v_mul_f32 v144, v144, v152
    v_mul_f32 v145, v145, v153
    ds_read_b64_tr_b16 v[248:249], v12 offset:4096
    ds_read_b64_tr_b16 v[250:251], v12 offset:4352
    s_waitcnt lgkmcnt(10)
    v_mfma_f32_32x32x16_bf16 v[208:223], v[224:227], v[112:115], v[208:223]
    v_mul_f32 v146, v146, v154
    v_mul_f32 v147, v147, v155
    ds_read_b64_tr_b16 v[252:253], v12 offset:4160
    ds_read_b64_tr_b16 v[254:255], v12 offset:4416
    v_mfma_f32_32x32x16_bf16 v[208:223], v[228:231], v[116:119], v[208:223]
    v_mul_f32 v148, v148, v156
    v_mul_f32 v149, v149, v157
    v_mul_f32 v150, v150, v158
    ds_read_b64_tr_b16 v[224:225], v12 offset:24608
    ds_read_b64_tr_b16 v[226:227], v12 offset:24864
    s_waitcnt lgkmcnt(10)
    v_mfma_f32_32x32x16_bf16 v[208:223], v[232:235], v[120:123], v[208:223]
    v_mul_f32 v151, v151, v159
    v_cvt_pk_bf16_f32 v152, v144, v145
    ds_read_b64_tr_b16 v[228:229], v12 offset:24672
    ds_read_b64_tr_b16 v[230:231], v12 offset:24928
    v_mfma_f32_32x32x16_bf16 v[208:223], v[236:239], v[124:127], v[208:223]
    v_cvt_pk_bf16_f32 v153, v146, v147
    v_cvt_pk_bf16_f32 v154, v148, v149
    v_cvt_pk_bf16_f32 v155, v150, v151
    ds_read_b64_tr_b16 v[232:233], v12 offset:25632
    ds_read_b64_tr_b16 v[234:235], v12 offset:25888
    s_waitcnt lgkmcnt(10)
    v_mfma_f32_32x32x16_bf16 v[208:223], v[240:243], v[128:131], v[208:223]
    v_or_b32 v152, 1, v152
    buffer_store_dwordx4 v[152:155], v6, s[8:11], s45 offen offset:2048 sc1
    ds_read_b64_tr_b16 v[236:237], v12 offset:25696
    ds_read_b64_tr_b16 v[238:239], v12 offset:25952
    v_mfma_f32_32x32x16_bf16 v[208:223], v[244:247], v[132:135], v[208:223]
    v_max_f32 v160, 0, v160
    v_max_f32 v161, 0, v161
    v_max_f32 v162, 0, v162
    ds_read_b64_tr_b16 v[240:241], v12 offset:26656
    ds_read_b64_tr_b16 v[242:243], v12 offset:26912
    s_waitcnt lgkmcnt(10)
    v_mfma_f32_32x32x16_bf16 v[208:223], v[248:251], v[136:139], v[208:223]
    v_max_f32 v163, 0, v163
    v_max_f32 v164, 0, v164
    ds_read_b64_tr_b16 v[244:245], v12 offset:26720
    ds_read_b64_tr_b16 v[246:247], v12 offset:26976
    v_mfma_f32_32x32x16_bf16 v[208:223], v[252:255], v[140:143], v[208:223]
    v_max_f32 v165, 0, v165
    v_max_f32 v166, 0, v166
    v_max_f32 v167, 0, v167
    ds_read_b64_tr_b16 v[248:249], v12 offset:27680
    ds_read_b64_tr_b16 v[250:251], v12 offset:27936
    s_waitcnt lgkmcnt(10)
    v_mfma_f32_32x32x16_bf16 v[192:207], v[224:227], v[16:19], 0
    v_mul_f32 v160, v160, v168
    v_mul_f32 v161, v161, v169
    ds_read_b64_tr_b16 v[252:253], v12 offset:27744
    ds_read_b64_tr_b16 v[254:255], v12 offset:28000
    v_mfma_f32_32x32x16_bf16 v[192:207], v[228:231], v[20:23], v[192:207]
    v_mul_f32 v162, v162, v170
    v_mul_f32 v163, v163, v171
    v_mul_f32 v164, v164, v172
    ds_read_b64_tr_b16 v[224:225], v12 offset:28704
    ds_read_b64_tr_b16 v[226:227], v12 offset:28960
    s_waitcnt lgkmcnt(10)
    v_mfma_f32_32x32x16_bf16 v[192:207], v[232:235], v[24:27], v[192:207]
    v_mul_f32 v165, v165, v173
    v_mul_f32 v166, v166, v174
    ds_read_b64_tr_b16 v[228:229], v12 offset:28768
    ds_read_b64_tr_b16 v[230:231], v12 offset:29024
    v_mfma_f32_32x32x16_bf16 v[192:207], v[236:239], v[28:31], v[192:207]
    v_mul_f32 v167, v167, v175
    v_cvt_pk_bf16_f32 v168, v160, v161
    v_cvt_pk_bf16_f32 v169, v162, v163
    ds_read_b64_tr_b16 v[232:233], v12 offset:29728
    ds_read_b64_tr_b16 v[234:235], v12 offset:29984
    s_waitcnt lgkmcnt(10)
    v_mfma_f32_32x32x16_bf16 v[192:207], v[240:243], v[32:35], v[192:207]
    v_cvt_pk_bf16_f32 v170, v164, v165
    v_cvt_pk_bf16_f32 v171, v166, v167
    ds_read_b64_tr_b16 v[236:237], v12 offset:29792
    ds_read_b64_tr_b16 v[238:239], v12 offset:30048
    v_mfma_f32_32x32x16_bf16 v[192:207], v[244:247], v[36:39], v[192:207]
    v_or_b32 v168, 1, v168
    buffer_store_dwordx4 v[168:171], v6, s[8:11], s45 offen offset:3072 sc1
    ds_read_b64_tr_b16 v[240:241], v12 offset:30752
    ds_read_b64_tr_b16 v[242:243], v12 offset:31008
    s_waitcnt lgkmcnt(10)
    v_mfma_f32_32x32x16_bf16 v[192:207], v[248:251], v[40:43], v[192:207]
    v_max_f32 v208, 0, v208
    v_max_f32 v209, 0, v209
    ds_read_b64_tr_b16 v[244:245], v12 offset:30816
    ds_read_b64_tr_b16 v[246:247], v12 offset:31072
    v_mfma_f32_32x32x16_bf16 v[192:207], v[252:255], v[44:47], v[192:207]
    v_max_f32 v210, 0, v210
    v_max_f32 v211, 0, v211
    v_max_f32 v212, 0, v212
    ds_read_b64_tr_b16 v[248:249], v12 offset:31776
    ds_read_b64_tr_b16 v[250:251], v12 offset:32032
    s_waitcnt lgkmcnt(10)
    v_mfma_f32_32x32x16_bf16 v[192:207], v[224:227], v[48:51], v[192:207]
    v_max_f32 v213, 0, v213
    v_max_f32 v214, 0, v214
    ds_read_b64_tr_b16 v[252:253], v12 offset:31840
    ds_read_b64_tr_b16 v[254:255], v12 offset:32096
    v_mfma_f32_32x32x16_bf16 v[192:207], v[228:231], v[52:55], v[192:207]
    v_max_f32 v215, 0, v215
    v_mul_f32 v208, v208, v216
    v_mul_f32 v209, v209, v217
    ds_read_b64_tr_b16 v[224:225], v12 offset:32800
    ds_read_b64_tr_b16 v[226:227], v12 offset:33056
    s_waitcnt lgkmcnt(10)
    v_mfma_f32_32x32x16_bf16 v[192:207], v[232:235], v[56:59], v[192:207]
    v_mul_f32 v210, v210, v218
    v_mul_f32 v211, v211, v219
    ds_read_b64_tr_b16 v[228:229], v12 offset:32864
    ds_read_b64_tr_b16 v[230:231], v12 offset:33120
    v_mfma_f32_32x32x16_bf16 v[192:207], v[236:239], v[60:63], v[192:207]
    v_mul_f32 v212, v212, v220
    v_mul_f32 v213, v213, v221
    v_mul_f32 v214, v214, v222
    ds_read_b64_tr_b16 v[232:233], v12 offset:33824
    ds_read_b64_tr_b16 v[234:235], v12 offset:34080
    s_waitcnt lgkmcnt(10)
    v_mfma_f32_32x32x16_bf16 v[192:207], v[240:243], v[64:67], v[192:207]
    v_mul_f32 v215, v215, v223
    v_cvt_pk_bf16_f32 v216, v208, v209
    ds_read_b64_tr_b16 v[236:237], v12 offset:33888
    ds_read_b64_tr_b16 v[238:239], v12 offset:34144
    v_mfma_f32_32x32x16_bf16 v[192:207], v[244:247], v[68:71], v[192:207]
    v_cvt_pk_bf16_f32 v217, v210, v211
    v_cvt_pk_bf16_f32 v218, v212, v213
    v_cvt_pk_bf16_f32 v219, v214, v215
    ds_read_b64_tr_b16 v[240:241], v12 offset:34848
    ds_read_b64_tr_b16 v[242:243], v12 offset:35104
    s_waitcnt lgkmcnt(10)
    v_mfma_f32_32x32x16_bf16 v[192:207], v[248:251], v[72:75], v[192:207]
    v_or_b32 v216, 1, v216
    buffer_store_dwordx4 v[216:219], v6, s[8:11], s46 offen offset:0 sc1
    ds_read_b64_tr_b16 v[244:245], v12 offset:34912
    ds_read_b64_tr_b16 v[246:247], v12 offset:35168
    v_mfma_f32_32x32x16_bf16 v[192:207], v[252:255], v[76:79], v[192:207]
    ds_read_b64_tr_b16 v[248:249], v12 offset:32
    ds_read_b64_tr_b16 v[250:251], v12 offset:288
    s_waitcnt lgkmcnt(10)
    v_mfma_f32_32x32x16_bf16 v[192:207], v[224:227], v[80:83], v[192:207]
    ds_read_b64_tr_b16 v[252:253], v12 offset:96
    ds_read_b64_tr_b16 v[254:255], v12 offset:352
    v_mfma_f32_32x32x16_bf16 v[192:207], v[228:231], v[84:87], v[192:207]
    ds_read_b64_tr_b16 v[224:225], v12 offset:1056
    ds_read_b64_tr_b16 v[226:227], v12 offset:1312
    s_waitcnt lgkmcnt(10)
    v_mfma_f32_32x32x16_bf16 v[192:207], v[232:235], v[88:91], v[192:207]
    ds_read_b64_tr_b16 v[228:229], v12 offset:1120
    ds_read_b64_tr_b16 v[230:231], v12 offset:1376
    v_mfma_f32_32x32x16_bf16 v[192:207], v[236:239], v[92:95], v[192:207]
    ds_read_b64_tr_b16 v[232:233], v12 offset:2080
    ds_read_b64_tr_b16 v[234:235], v12 offset:2336
    s_waitcnt lgkmcnt(10)
    v_mfma_f32_32x32x16_bf16 v[192:207], v[240:243], v[96:99], v[192:207]
    ds_read_b64_tr_b16 v[236:237], v12 offset:2144
    ds_read_b64_tr_b16 v[238:239], v12 offset:2400
    v_mfma_f32_32x32x16_bf16 v[192:207], v[244:247], v[100:103], v[192:207]
    buffer_load_dwordx4 v[144:147], v6, s[8:11], s28 offen offset:0 sc1
    ds_read_b64_tr_b16 v[240:241], v12 offset:3104
    ds_read_b64_tr_b16 v[242:243], v12 offset:3360
    s_waitcnt lgkmcnt(10)
    v_mfma_f32_32x32x16_bf16 v[192:207], v[248:251], v[104:107], v[192:207]
    ds_read_b64_tr_b16 v[244:245], v12 offset:3168
    ds_read_b64_tr_b16 v[246:247], v12 offset:3424
    v_mfma_f32_32x32x16_bf16 v[192:207], v[252:255], v[108:111], v[192:207]
    buffer_load_dwordx4 v[148:151], v6, s[8:11], s32 offen offset:0 sc1
    ds_read_b64_tr_b16 v[248:249], v12 offset:4128
    ds_read_b64_tr_b16 v[250:251], v12 offset:4384
    s_waitcnt lgkmcnt(10)
    v_mfma_f32_32x32x16_bf16 v[192:207], v[224:227], v[112:115], v[192:207]
    ds_read_b64_tr_b16 v[252:253], v12 offset:4192
    ds_read_b64_tr_b16 v[254:255], v12 offset:4448
    v_mfma_f32_32x32x16_bf16 v[192:207], v[228:231], v[116:119], v[192:207]
    buffer_load_dwordx4 v[152:155], v6, s[8:11], s29 offen offset:0 sc1
    ds_read_b64_tr_b16 v[224:225], v12 offset:16384
    ds_read_b64_tr_b16 v[226:227], v12 offset:16640
    s_waitcnt lgkmcnt(10)
    v_mfma_f32_32x32x16_bf16 v[192:207], v[232:235], v[120:123], v[192:207]
    ds_read_b64_tr_b16 v[228:229], v12 offset:16416
    ds_read_b64_tr_b16 v[230:231], v12 offset:16672
    v_mfma_f32_32x32x16_bf16 v[192:207], v[236:239], v[124:127], v[192:207]
    buffer_load_dwordx4 v[156:159], v6, s[8:11], s33 offen offset:0 sc1
    ds_read_b64_tr_b16 v[232:233], v12 offset:16448
    ds_read_b64_tr_b16 v[234:235], v12 offset:16704
    s_waitcnt lgkmcnt(10)
    v_mfma_f32_32x32x16_bf16 v[192:207], v[240:243], v[128:131], v[192:207]
    ds_read_b64_tr_b16 v[236:237], v12 offset:16480
    ds_read_b64_tr_b16 v[238:239], v12 offset:16736
    v_mfma_f32_32x32x16_bf16 v[192:207], v[244:247], v[132:135], v[192:207]
    buffer_load_dwordx4 v[160:163], v6, s[8:11], s30 offen offset:0 sc1
    ds_read_b64_tr_b16 v[240:241], v12 offset:17408
    ds_read_b64_tr_b16 v[242:243], v12 offset:17664
    s_waitcnt lgkmcnt(10)
    v_mfma_f32_32x32x16_bf16 v[192:207], v[248:251], v[136:139], v[192:207]
    ds_read_b64_tr_b16 v[244:245], v12 offset:17440
    ds_read_b64_tr_b16 v[246:247], v12 offset:17696
    v_mfma_f32_32x32x16_bf16 v[192:207], v[252:255], v[140:143], v[192:207]
    buffer_load_dwordx4 v[164:167], v6, s[8:11], s34 offen offset:0 sc1
    ds_read_b64_tr_b16 v[248:249], v12 offset:17472
    ds_read_b64_tr_b16 v[250:251], v12 offset:17728
    s_waitcnt lgkmcnt(10)
    v_mfma_f32_32x32x16_bf16 v[176:191], v[224:227], v[16:19], 0
    ds_read_b64_tr_b16 v[252:253], v12 offset:17504
    ds_read_b64_tr_b16 v[254:255], v12 offset:17760
    v_mfma_f32_32x32x16_bf16 v[176:191], v[228:231], v[20:23], v[176:191]
    buffer_load_dwordx4 v[168:171], v6, s[8:11], s31 offen offset:0 sc1
    ds_read_b64_tr_b16 v[224:225], v12 offset:18432
    ds_read_b64_tr_b16 v[226:227], v12 offset:18688
    s_waitcnt lgkmcnt(10)
    v_mfma_f32_32x32x16_bf16 v[176:191], v[232:235], v[24:27], v[176:191]
    v_max_f32 v192, 0, v192
    v_max_f32 v193, 0, v193
    ds_read_b64_tr_b16 v[228:229], v12 offset:18464
    ds_read_b64_tr_b16 v[230:231], v12 offset:18720
    v_mfma_f32_32x32x16_bf16 v[176:191], v[236:239], v[28:31], v[176:191]
    buffer_load_dwordx4 v[172:175], v6, s[8:11], s35 offen offset:0 sc1
    v_max_f32 v194, 0, v194
    v_max_f32 v195, 0, v195
    ds_read_b64_tr_b16 v[232:233], v12 offset:18496
    ds_read_b64_tr_b16 v[234:235], v12 offset:18752
    s_waitcnt lgkmcnt(10)
    v_mfma_f32_32x32x16_bf16 v[176:191], v[240:243], v[32:35], v[176:191]
    v_max_f32 v196, 0, v196
    v_max_f32 v197, 0, v197
    ds_read_b64_tr_b16 v[236:237], v12 offset:18528
    ds_read_b64_tr_b16 v[238:239], v12 offset:18784
    v_mfma_f32_32x32x16_bf16 v[176:191], v[244:247], v[36:39], v[176:191]
    buffer_load_dwordx4 v[16:19], v6, s[8:11], s28 offen offset:1024 sc1
    v_max_f32 v198, 0, v198
    v_max_f32 v199, 0, v199
    ds_read_b64_tr_b16 v[240:241], v12 offset:19456
    ds_read_b64_tr_b16 v[242:243], v12 offset:19712
    s_waitcnt lgkmcnt(10)
    v_mfma_f32_32x32x16_bf16 v[176:191], v[248:251], v[40:43], v[176:191]
    v_mul_f32 v192, v192, v200
    v_mul_f32 v193, v193, v201
    ds_read_b64_tr_b16 v[244:245], v12 offset:19488
    ds_read_b64_tr_b16 v[246:247], v12 offset:19744
    v_mfma_f32_32x32x16_bf16 v[176:191], v[252:255], v[44:47], v[176:191]
    buffer_load_dwordx4 v[20:23], v6, s[8:11], s32 offen offset:1024 sc1
    v_mul_f32 v194, v194, v202
    v_mul_f32 v195, v195, v203
    ds_read_b64_tr_b16 v[248:249], v12 offset:19520
    ds_read_b64_tr_b16 v[250:251], v12 offset:19776
    s_waitcnt lgkmcnt(10)
    v_mfma_f32_32x32x16_bf16 v[176:191], v[224:227], v[48:51], v[176:191]
    v_mul_f32 v196, v196, v204
    v_mul_f32 v197, v197, v205
    ds_read_b64_tr_b16 v[252:253], v12 offset:19552
    ds_read_b64_tr_b16 v[254:255], v12 offset:19808
    v_mfma_f32_32x32x16_bf16 v[176:191], v[228:231], v[52:55], v[176:191]
    buffer_load_dwordx4 v[24:27], v6, s[8:11], s29 offen offset:1024 sc1
    v_mul_f32 v198, v198, v206
    v_mul_f32 v199, v199, v207
    ds_read_b64_tr_b16 v[224:225], v12 offset:20480
    ds_read_b64_tr_b16 v[226:227], v12 offset:20736
    s_waitcnt lgkmcnt(10)
    v_mfma_f32_32x32x16_bf16 v[176:191], v[232:235], v[56:59], v[176:191]
    v_cvt_pk_bf16_f32 v200, v192, v193
    v_cvt_pk_bf16_f32 v201, v194, v195
    ds_read_b64_tr_b16 v[228:229], v12 offset:20512
    ds_read_b64_tr_b16 v[230:231], v12 offset:20768
    v_mfma_f32_32x32x16_bf16 v[176:191], v[236:239], v[60:63], v[176:191]
    buffer_load_dwordx4 v[28:31], v6, s[8:11], s33 offen offset:1024 sc1
    v_cvt_pk_bf16_f32 v202, v196, v197
    v_cvt_pk_bf16_f32 v203, v198, v199
    ds_read_b64_tr_b16 v[232:233], v12 offset:20544
    ds_read_b64_tr_b16 v[234:235], v12 offset:20800
    s_waitcnt lgkmcnt(10)
    v_mfma_f32_32x32x16_bf16 v[176:191], v[240:243], v[64:67], v[176:191]
    v_or_b32 v200, 1, v200
    buffer_store_dwordx4 v[200:203], v6, s[8:11], s46 offen offset:1024 sc1
    ds_read_b64_tr_b16 v[236:237], v12 offset:20576
    ds_read_b64_tr_b16 v[238:239], v12 offset:20832
    v_mfma_f32_32x32x16_bf16 v[176:191], v[244:247], v[68:71], v[176:191]
    ds_read_b64_tr_b16 v[240:241], v12 offset:21504
    ds_read_b64_tr_b16 v[242:243], v12 offset:21760
    s_waitcnt lgkmcnt(10)
    v_mfma_f32_32x32x16_bf16 v[176:191], v[248:251], v[72:75], v[176:191]
    buffer_load_dwordx4 v[32:35], v6, s[8:11], s30 offen offset:1024 sc1
    ds_read_b64_tr_b16 v[244:245], v12 offset:21536
    ds_read_b64_tr_b16 v[246:247], v12 offset:21792
    v_mfma_f32_32x32x16_bf16 v[176:191], v[252:255], v[76:79], v[176:191]
    ds_read_b64_tr_b16 v[248:249], v12 offset:21568
    ds_read_b64_tr_b16 v[250:251], v12 offset:21824
    s_waitcnt lgkmcnt(10)
    v_mfma_f32_32x32x16_bf16 v[176:191], v[224:227], v[80:83], v[176:191]
    buffer_load_dwordx4 v[36:39], v6, s[8:11], s34 offen offset:1024 sc1
    ds_read_b64_tr_b16 v[252:253], v12 offset:21600
    ds_read_b64_tr_b16 v[254:255], v12 offset:21856
    v_mfma_f32_32x32x16_bf16 v[176:191], v[228:231], v[84:87], v[176:191]
    ds_read_b64_tr_b16 v[224:225], v12 offset:22528
    ds_read_b64_tr_b16 v[226:227], v12 offset:22784
    s_waitcnt lgkmcnt(10)
    v_mfma_f32_32x32x16_bf16 v[176:191], v[232:235], v[88:91], v[176:191]
    buffer_load_dwordx4 v[40:43], v6, s[8:11], s31 offen offset:1024 sc1
    ds_read_b64_tr_b16 v[228:229], v12 offset:22560
    ds_read_b64_tr_b16 v[230:231], v12 offset:22816
    v_mfma_f32_32x32x16_bf16 v[176:191], v[236:239], v[92:95], v[176:191]
    ds_read_b64_tr_b16 v[232:233], v12 offset:22592
    ds_read_b64_tr_b16 v[234:235], v12 offset:22848
    s_waitcnt lgkmcnt(10)
    v_mfma_f32_32x32x16_bf16 v[176:191], v[240:243], v[96:99], v[176:191]
    buffer_load_dwordx4 v[44:47], v6, s[8:11], s35 offen offset:1024 sc1
    ds_read_b64_tr_b16 v[236:237], v12 offset:22624
    ds_read_b64_tr_b16 v[238:239], v12 offset:22880
    v_mfma_f32_32x32x16_bf16 v[176:191], v[244:247], v[100:103], v[176:191]
    ds_read_b64_tr_b16 v[240:241], v12 offset:23552
    ds_read_b64_tr_b16 v[242:243], v12 offset:23808
    s_waitcnt lgkmcnt(10)
    v_mfma_f32_32x32x16_bf16 v[176:191], v[248:251], v[104:107], v[176:191]
    buffer_load_dwordx4 v[48:51], v6, s[8:11], s28 offen offset:2048 sc1
    ds_read_b64_tr_b16 v[244:245], v12 offset:23584
    ds_read_b64_tr_b16 v[246:247], v12 offset:23840
    v_mfma_f32_32x32x16_bf16 v[176:191], v[252:255], v[108:111], v[176:191]
    ds_read_b64_tr_b16 v[248:249], v12 offset:23616
    ds_read_b64_tr_b16 v[250:251], v12 offset:23872
    s_waitcnt lgkmcnt(10)
    v_mfma_f32_32x32x16_bf16 v[176:191], v[224:227], v[112:115], v[176:191]
    s_waitcnt vmcnt(14)
    v_bitop3_b32 v9, v148, v144, v156 bitop3:0x80
    v_bitop3_b32 v9, v9, v152, 1 bitop3:0x80
    buffer_load_dwordx4 v[52:55], v6, s[8:11], s32 offen offset:2048 sc1
    ds_read_b64_tr_b16 v[252:253], v12 offset:23648
    ds_read_b64_tr_b16 v[254:255], v12 offset:23904
    v_mfma_f32_32x32x16_bf16 v[176:191], v[228:231], v[116:119], v[176:191]
    v_cmp_ne_u32 vcc, 1, v9
    s_waitcnt lgkmcnt(8)
    v_mfma_f32_32x32x16_bf16 v[176:191], v[232:235], v[120:123], v[176:191]
    s_cbranch_vccnz L_rt_90
L_ok_91:
    buffer_load_dwordx4 v[56:59], v6, s[8:11], s29 offen offset:2048 sc1
    v_mfma_f32_32x32x16_bf16 v[176:191], v[236:239], v[124:127], v[176:191]
    s_waitcnt lgkmcnt(4)
    v_mfma_f32_32x32x16_bf16 v[176:191], v[240:243], v[128:131], v[176:191]
    buffer_load_dwordx4 v[60:63], v6, s[8:11], s33 offen offset:2048 sc1
    v_mfma_f32_32x32x16_bf16 v[176:191], v[244:247], v[132:135], v[176:191]
    s_waitcnt lgkmcnt(0)
    v_mfma_f32_32x32x16_bf16 v[176:191], v[248:251], v[136:139], v[176:191]
    buffer_load_dwordx4 v[64:67], v6, s[8:11], s30 offen offset:2048 sc1
    v_mfma_f32_32x32x16_bf16 v[176:191], v[252:255], v[140:143], v[176:191]
    v_mfma_f32_32x32x16_bf16 v[192:207], a[0:3], v[148:151], 0
    s_waitcnt vmcnt(14)
    v_bitop3_b32 v9, v164, v160, v172 bitop3:0x80
    v_bitop3_b32 v9, v9, v168, 1 bitop3:0x80
    buffer_load_dwordx4 v[68:71], v6, s[8:11], s34 offen offset:2048 sc1
    v_mfma_f32_32x32x16_bf16 v[208:223], a[4:7], v[148:151], 0
    v_cmp_ne_u32 vcc, 1, v9
    v_mfma_f32_32x32x16_bf16 v[224:239], a[0:3], v[144:147], 0
    s_cbranch_vccnz L_rt_92
L_ok_93:
    buffer_load_dwordx4 v[72:75], v6, s[8:11], s31 offen offset:2048 sc1
    v_mfma_f32_32x32x16_bf16 v[240:255], a[4:7], v[144:147], 0
    s_nop 0
    v_max_f32 v176, 0, v176
    v_max_f32 v177, 0, v177
    v_max_f32 v178, 0, v178
    v_max_f32 v179, 0, v179
    v_mfma_f32_32x32x16_bf16 v[192:207], a[8:11], v[156:159], v[192:207]
    buffer_load_dwordx4 v[76:79], v6, s[8:11], s35 offen offset:2048 sc1
    v_max_f32 v180, 0, v180
    v_max_f32 v181, 0, v181
    v_mfma_f32_32x32x16_bf16 v[208:223], a[12:15], v[156:159], v[208:223]
    v_max_f32 v182, 0, v182
    v_max_f32 v183, 0, v183
    v_mul_f32 v176, v176, v184
    v_mul_f32 v177, v177, v185
    v_mfma_f32_32x32x16_bf16 v[224:239], a[8:11], v[152:155], v[224:239]
    buffer_load_dwordx4 v[80:83], v6, s[8:11], s28 offen offset:3072 sc1
    v_mul_f32 v178, v178, v186
    v_mul_f32 v179, v179, v187
    v_mfma_f32_32x32x16_bf16 v[240:255], a[12:15], v[152:155], v[240:255]
    v_mul_f32 v180, v180, v188
    v_mul_f32 v181, v181, v189
    v_mul_f32 v182, v182, v190
    v_mul_f32 v183, v183, v191
    v_mfma_f32_32x32x16_bf16 v[192:207], a[16:19], v[164:167], v[192:207]
    s_waitcnt vmcnt(14)
    v_bitop3_b32 v9, v20, v16, v28 bitop3:0x80
    v_bitop3_b32 v9, v9, v24, 1 bitop3:0x80
    buffer_load_dwordx4 v[84:87], v6, s[8:11], s32 offen offset:3072 sc1
    v_cvt_pk_bf16_f32 v184, v176, v177
    v_cvt_pk_bf16_f32 v185, v178, v179
    v_mfma_f32_32x32x16_bf16 v[208:223], a[20:23], v[164:167], v[208:223]
    v_cmp_ne_u32 vcc, 1, v9
    v_cvt_pk_bf16_f32 v186, v180, v181
    v_cvt_pk_bf16_f32 v187, v182, v183
    v_or_b32 v184, 1, v184
    v_mfma_f32_32x32x16_bf16 v[224:239], a[16:19], v[160:163], v[224:239]
    s_cbranch_vccnz L_rt_94
L_ok_95:
    buffer_load_dwordx4 v[88:91], v6, s[8:11], s29 offen offset:3072 sc1
    v_mfma_f32_32x32x16_bf16 v[240:255], a[20:23], v[160:163], v[240:255]
    buffer_store_dwordx4 v[184:187], v6, s[8:11], s46 offen offset:2048 sc1
    v_mfma_f32_32x32x16_bf16 v[192:207], a[24:27], v[172:175], v[192:207]
    v_mfma_f32_32x32x16_bf16 v[208:223], a[28:31], v[172:175], v[208:223]
    buffer_load_dwordx4 v[92:95], v6, s[8:11], s33 offen offset:3072 sc1
    v_mfma_f32_32x32x16_bf16 v[224:239], a[24:27], v[168:171], v[224:239]
    v_mfma_f32_32x32x16_bf16 v[240:255], a[28:31], v[168:171], v[240:255]
    buffer_load_dwordx4 v[96:99], v6, s[8:11], s30 offen offset:3072 sc1
    v_mfma_f32_32x32x16_bf16 v[192:207], a[32:35], v[20:23], v[192:207]
    s_waitcnt vmcnt(14)
    v_bitop3_b32 v9, v36, v32, v44 bitop3:0x80
    v_bitop3_b32 v9, v9, v40, 1 bitop3:0x80
    v_mfma_f32_32x32x16_bf16 v[208:223], a[36:39], v[20:23], v[208:223]
    v_cmp_ne_u32 vcc, 1, v9
    buffer_load_dwordx4 v[100:103], v6, s[8:11], s34 offen offset:3072 sc1
    v_mfma_f32_32x32x16_bf16 v[224:239], a[32:35], v[16:19], v[224:239]
    s_cbranch_vccnz L_rt_96
L_ok_97:
    v_mfma_f32_32x32x16_bf16 v[240:255], a[36:39], v[16:19], v[240:255]
    buffer_load_dwordx4 v[104:107], v6, s[8:11], s31 offen offset:3072 sc1
    v_mfma_f32_32x32x16_bf16 v[192:207], a[40:43], v[28:31], v[192:207]
    v_mfma_f32_32x32x16_bf16 v[208:223], a[44:47], v[28:31], v[208:223]
    buffer_load_dwordx4 v[108:111], v6, s[8:11], s35 offen offset:3072 sc1
    s_add_u32 s52, s28, 4096
    v_mfma_f32_32x32x16_bf16 v[224:239], a[40:43], v[24:27], v[224:239]
    v_mfma_f32_32x32x16_bf16 v[240:255], a[44:47], v[24:27], v[240:255]
    buffer_load_dwordx4 v[112:115], v6, s[8:11], s52 offen offset:0 sc1
    s_add_u32 s52, s32, 4096
    s_barrier
    v_mfma_f32_32x32x16_bf16 v[192:207], a[48:51], v[36:39], v[192:207]
    s_waitcnt vmcnt(14)
    v_bitop3_b32 v9, v52, v48, v60 bitop3:0x80
    v_bitop3_b32 v9, v9, v56, 1 bitop3:0x80
    buffer_load_dwordx4 v[176:179], v11, s[8:11], s36 offen sc1
    v_mfma_f32_32x32x16_bf16 v[208:223], a[52:55], v[36:39], v[208:223]
    v_cmp_ne_u32 vcc, 1, v9
    buffer_load_dwordx4 v[180:183], v11, s[8:11], s37 offen sc1
    v_bfe_u32 v188, v0, 3, 3
    v_mfma_f32_32x32x16_bf16 v[224:239], a[48:51], v[32:35], v[224:239]
    s_cbranch_vccnz L_rt_98
L_ok_99:
    v_and_b32 v184, 7, v0
    v_lshlrev_b32 v184, 1, v184
    v_xor_b32 v184, v184, v188
    v_mfma_f32_32x32x16_bf16 v[240:255], a[52:55], v[32:35], v[240:255]
    buffer_load_dwordx4 v[116:119], v6, s[8:11], s52 offen offset:0 sc1
    s_add_u32 s52, s29, 4096
    v_lshlrev_b32 v184, 4, v184
    v_lshl_add_u32 v184, v188, 8, v184
    v_mfma_f32_32x32x16_bf16 v[192:207], a[56:59], v[44:47], v[192:207]
    v_lshl_add_u32 v184, v3, 11, v184
    v_xor_b32 v185, 16, v184
    v_bfe_u32 v188, v0, 5, 1
    v_and_b32 v186, 7, v0
    v_mfma_f32_32x32x16_bf16 v[208:223], a[60:63], v[44:47], v[208:223]
    buffer_load_dwordx4 v[120:123], v6, s[8:11], s52 offen offset:0 sc1
    s_add_u32 s52, s33, 4096
    v_xor_b32 v188, v188, v186
    v_lshlrev_b32 v188, 4, v188
    v_mfma_f32_32x32x16_bf16 v[224:239], a[56:59], v[40:43], v[224:239]
    v_and_b32 v186, 31, v0
    v_lshl_add_u32 v188, v186, 8, v188
    v_xor_b32 v189, 32, v188
    v_xor_b32 v190, 64, v188
    v_mfma_f32_32x32x16_bf16 v[240:255], a[60:63], v[40:43], v[240:255]
    buffer_load_dwordx4 v[124:127], v6, s[8:11], s52 offen offset:0 sc1
    s_add_u32 s52, s30, 4096
    v_xor_b32 v191, 96, v188
    v_add_u32 v188, s40, v188
    v_mfma_f32_32x32x16_bf16 v[192:207], a[64:67], v[52:55], v[192:207]
    s_waitcnt vmcnt(15)
    v_bitop3_b32 v9, v68, v64, v76 bitop3:0x80
    v_bitop3_b32 v9, v9, v72, 1 bitop3:0x80
    v_add_u32 v189, s40, v189
    v_add_u32 v190, s40, v190
    v_mfma_f32_32x32x16_bf16 v[208:223], a[68:71], v[52:55], v[208:223]
    v_cmp_ne_u32 vcc, 1, v9
    buffer_load_dwordx4 v[128:131], v6, s[8:11], s52 offen offset:0 sc1
    s_add_u32 s52, s31, 4096
    v_add_u32 v191, s40, v191
    v_add_u32 v186, 71744, v184
    v_mfma_f32_32x32x16_bf16 v[224:239], a[64:67], v[48:51], v[224:239]
    s_cbranch_vccnz L_rt_100
L_ok_101:
    v_add_u32 v187, 71744, v185
    v_mfma_f32_32x32x16_bf16 v[240:255], a[68:71], v[48:51], v[240:255]
    buffer_load_dwordx4 v[136:139], v6, s[8:11], s52 offen offset:0 sc1
    s_add_u32 s52, s28, 4096
    v_mfma_f32_32x32x16_bf16 v[192:207], a[72:75], v[60:63], v[192:207]
    v_mfma_f32_32x32x16_bf16 v[208:223], a[76:79], v[60:63], v[208:223]
    buffer_load_dwordx4 v[144:147], v6, s[8:11], s52 offen offset:1024 sc1
    s_add_u32 s52, s29, 4096
    v_mfma_f32_32x32x16_bf16 v[224:239], a[72:75], v[56:59], v[224:239]
    v_mfma_f32_32x32x16_bf16 v[240:255], a[76:79], v[56:59], v[240:255]
    buffer_load_dwordx4 v[152:155], v6, s[8:11], s52 offen offset:1024 sc1
    s_add_u32 s52, s30, 4096
    v_mfma_f32_32x32x16_bf16 v[192:207], a[80:83], v[68:71], v[192:207]
    s_waitcnt vmcnt(14)
    v_bitop3_b32 v9, v84, v80, v92 bitop3:0x80
    v_bitop3_b32 v9, v9, v88, 1 bitop3:0x80
    v_mfma_f32_32x32x16_bf16 v[208:223], a[84:87], v[68:71], v[208:223]
    v_cmp_ne_u32 vcc, 1, v9
    buffer_load_dwordx4 v[160:163], v6, s[8:11], s52 offen offset:1024 sc1
    s_add_u32 s52, s31, 4096
    v_mfma_f32_32x32x16_bf16 v[224:239], a[80:83], v[64:67], v[224:239]
    s_cbranch_vccnz L_rt_102
L_ok_103:
    v_mfma_f32_32x32x16_bf16 v[240:255], a[84:87], v[64:67], v[240:255]
    buffer_load_dwordx4 v[168:171], v6, s[8:11], s52 offen offset:1024 sc1
    s_add_u32 s52, s28, 4096
    v_mfma_f32_32x32x16_bf16 v[192:207], a[88:91], v[76:79], v[192:207]
    v_mfma_f32_32x32x16_bf16 v[208:223], a[92:95], v[76:79], v[208:223]
    buffer_load_dwordx4 v[16:19], v6, s[8:11], s52 offen offset:2048 sc1
    s_add_u32 s52, s29, 4096
    v_mfma_f32_32x32x16_bf16 v[224:239], a[88:91], v[72:75], v[224:239]
    v_mfma_f32_32x32x16_bf16 v[240:255], a[92:95], v[72:75], v[240:255]
    buffer_load_dwordx4 v[24:27], v6, s[8:11], s52 offen offset:2048 sc1
    s_add_u32 s52, s34, 4096
    v_mfma_f32_32x32x16_bf16 v[192:207], a[96:99], v[84:87], v[192:207]
    s_waitcnt vmcnt(14)
    v_bitop3_b32 v9, v100, v96, v108 bitop3:0x80
    v_bitop3_b32 v9, v9, v104, 1 bitop3:0x80
    v_mfma_f32_32x32x16_bf16 v[208:223], a[100:103], v[84:87], v[208:223]
    v_cmp_ne_u32 vcc, 1, v9
    buffer_load_dwordx4 v[132:135], v6, s[8:11], s52 offen offset:0 sc1
    s_add_u32 s52, s35, 4096
    v_mfma_f32_32x32x16_bf16 v[224:239], a[96:99], v[80:83], v[224:239]
    s_cbranch_vccnz L_rt_104
L_ok_105:
    v_mfma_f32_32x32x16_bf16 v[240:255], a[100:103], v[80:83], v[240:255]
    buffer_load_dwordx4 v[140:143], v6, s[8:11], s52 offen offset:0 sc1
    s_add_u32 s52, s30, 4096
    v_mfma_f32_32x32x16_bf16 v[192:207], a[104:107], v[92:95], v[192:207]
    v_mfma_f32_32x32x16_bf16 v[208:223], a[108:111], v[92:95], v[208:223]
    buffer_load_dwordx4 v[32:35], v6, s[8:11], s52 offen offset:2048 sc1
    s_add_u32 s52, s31, 4096
    v_mfma_f32_32x32x16_bf16 v[224:239], a[104:107], v[88:91], v[224:239]
    v_mfma_f32_32x32x16_bf16 v[240:255], a[108:111], v[88:91], v[240:255]
    buffer_load_dwordx4 v[40:43], v6, s[8:11], s52 offen offset:2048 sc1
    s_add_u32 s52, s32, 4096
    v_mfma_f32_32x32x16_bf16 v[192:207], a[112:115], v[100:103], v[192:207]
    s_waitcnt vmcnt(12)
    v_bitop3_b32 v9, v116, v112, v124 bitop3:0x80
    v_bitop3_b32 v9, v9, v120, 1 bitop3:0x80
    v_mfma_f32_32x32x16_bf16 v[208:223], a[116:119], v[100:103], v[208:223]
    v_cmp_ne_u32 vcc, 1, v9
    buffer_load_dwordx4 v[148:151], v6, s[8:11], s52 offen offset:1024 sc1
    s_add_u32 s52, s33, 4096
    v_mfma_f32_32x32x16_bf16 v[224:239], a[112:115], v[96:99], v[224:239]
    s_cbranch_vccnz L_rt_106
L_ok_107:
    v_mfma_f32_32x32x16_bf16 v[240:255], a[116:119], v[96:99], v[240:255]
    buffer_load_dwordx4 v[156:159], v6, s[8:11], s52 offen offset:1024 sc1
    s_add_u32 s52, s34, 4096
    v_mfma_f32_32x32x16_bf16 v[192:207], a[120:123], v[108:111], v[192:207]
    v_mfma_f32_32x32x16_bf16 v[208:223], a[124:127], v[108:111], v[208:223]
    buffer_load_dwordx4 v[164:167], v6, s[8:11], s52 offen offset:1024 sc1
    s_add_u32 s52, s35, 4096
    v_mfma_f32_32x32x16_bf16 v[224:239], a[120:123], v[104:107], v[224:239]
    v_mfma_f32_32x32x16_bf16 v[240:255], a[124:127], v[104:107], v[240:255]
    buffer_load_dwordx4 v[172:175], v6, s[8:11], s52 offen offset:1024 sc1
    s_add_u32 s52, s32, 4096
    v_mfma_f32_32x32x16_bf16 v[192:207], a[128:131], v[116:119], v[192:207]
    s_waitcnt vmcnt(12)
    v_bitop3_b32 v9, v128, v136, v144 bitop3:0x80
    v_bitop3_b32 v9, v9, v152, 1 bitop3:0x80
    v_mfma_f32_32x32x16_bf16 v[208:223], a[132:135], v[116:119], v[208:223]
    v_cmp_ne_u32 vcc, 1, v9
    buffer_load_dwordx4 v[20:23], v6, s[8:11], s52 offen offset:2048 sc1
    s_add_u32 s52, s33, 4096
    v_mfma_f32_32x32x16_bf16 v[224:239], a[128:131], v[112:115], v[224:239]
    s_cbranch_vccnz L_rt_108
L_ok_109:
    v_mfma_f32_32x32x16_bf16 v[240:255], a[132:135], v[112:115], v[240:255]
    buffer_load_dwordx4 v[28:31], v6, s[8:11], s52 offen offset:2048 sc1
    s_add_u32 s52, s34, 4096
    v_mfma_f32_32x32x16_bf16 v[192:207], a[136:139], v[124:127], v[192:207]
    v_mfma_f32_32x32x16_bf16 v[208:223], a[140:143], v[124:127], v[208:223]
    buffer_load_dwordx4 v[36:39], v6, s[8:11], s52 offen offset:2048 sc1
    s_add_u32 s52, s35, 4096
    v_mfma_f32_32x32x16_bf16 v[224:239], a[136:139], v[120:123], v[224:239]
    v_mfma_f32_32x32x16_bf16 v[240:255], a[140:143], v[120:123], v[240:255]
    buffer_load_dwordx4 v[44:47], v6, s[8:11], s52 offen offset:2048 sc1
    v_mfma_f32_32x32x16_bf16 v[224:239], a[144:147], v[128:131], v[224:239]
    s_waitcnt vmcnt(12)
    v_bitop3_b32 v9, v160, v168, v16 bitop3:0x80
    v_bitop3_b32 v9, v9, v24, 1 bitop3:0x80
    v_mfma_f32_32x32x16_bf16 v[240:255], a[148:151], v[128:131], v[240:255]
    v_cmp_ne_u32 vcc, 1, v9
    v_mfma_f32_32x32x16_bf16 v[224:239], a[152:155], v[136:139], v[224:239]
    s_cbranch_vccnz L_rt_110
L_ok_111:
    v_mfma_f32_32x32x16_bf16 v[240:255], a[156:159], v[136:139], v[240:255]
    v_mfma_f32_32x32x16_bf16 v[224:239], a[160:163], v[144:147], v[224:239]
    v_mfma_f32_32x32x16_bf16 v[240:255], a[164:167], v[144:147], v[240:255]
    v_mfma_f32_32x32x16_bf16 v[224:239], a[168:171], v[152:155], v[224:239]
    s_waitcnt vmcnt(8)
    v_bitop3_b32 v9, v32, v40, v132 bitop3:0x80
    v_bitop3_b32 v9, v9, v140, 1 bitop3:0x80
    v_mfma_f32_32x32x16_bf16 v[240:255], a[172:175], v[152:155], v[240:255]
    v_cmp_ne_u32 vcc, 1, v9
    v_mfma_f32_32x32x16_bf16 v[224:239], a[176:179], v[160:163], v[224:239]
    s_waitcnt vmcnt(23)
    s_cbranch_vccnz L_rt_112
L_ok_113:
    v_lshlrev_b32 v48, 16, v176
    v_and_b32 v49, 0xffff0000, v176
    v_lshlrev_b32 v50, 16, v177
    v_mfma_f32_32x32x16_bf16 v[240:255], a[180:183], v[160:163], v[240:255]
    v_and_b32 v51, 0xffff0000, v177
    v_lshlrev_b32 v52, 16, v178
    v_and_b32 v53, 0xffff0000, v178
    v_lshlrev_b32 v54, 16, v179
    v_mfma_f32_32x32x16_bf16 v[224:239], a[184:187], v[168:171], v[224:239]
    v_and_b32 v55, 0xffff0000, v179
    v_lshlrev_b32 v56, 16, v180
    v_and_b32 v57, 0xffff0000, v180
    v_lshlrev_b32 v58, 16, v181
    v_mfma_f32_32x32x16_bf16 v[240:255], a[188:191], v[168:171], v[240:255]
    v_and_b32 v59, 0xffff0000, v181
    v_lshlrev_b32 v60, 16, v182
    v_and_b32 v61, 0xffff0000, v182
    v_lshlrev_b32 v62, 16, v183
    v_mfma_f32_32x32x16_bf16 v[224:239], a[192:195], v[16:19], v[224:239]
    v_and_b32 v63, 0xffff0000, v183
    v_mfma_f32_32x32x16_bf16 v[224:239], a[200:203], v[24:27], v[224:239]
    v_mfma_f32_32x32x16_bf16 v[224:239], a[208:211], v[32:35], v[224:239]
    v_mfma_f32_32x32x16_bf16 v[224:239], a[216:219], v[40:43], v[224:239]
    v_mfma_f32_32x32x16_bf16 v[240:255], a[196:199], v[16:19], v[240:255]
    s_waitcnt vmcnt(4)
    v_bitop3_b32 v9, v148, v156, v164 bitop3:0x80
    v_bitop3_b32 v9, v9, v172, 1 bitop3:0x80
    v_mfma_f32_32x32x16_bf16 v[240:255], a[204:207], v[24:27], v[240:255]
    v_cmp_ne_u32 vcc, 1, v9
    v_mfma_f32_32x32x16_bf16 v[240:255], a[212:215], v[32:35], v[240:255]
    s_cbranch_vccnz L_rt_114
L_ok_115:
    v_mfma_f32_32x32x16_bf16 v[240:255], a[220:223], v[40:43], v[240:255]
    s_nop 2
    ds_write_b128 v188, v[224:227] offset:0
    ds_write_b128 v189, v[228:231] offset:0
    ds_write_b128 v190, v[232:235] offset:0
    ds_write_b128 v191, v[236:239] offset:0
    v_mfma_f32_32x32x16_bf16 v[192:207], a[144:147], v[132:135], v[192:207]
    v_mfma_f32_32x32x16_bf16 v[208:223], a[148:151], v[132:135], v[208:223]
    v_mfma_f32_32x32x16_bf16 v[192:207], a[152:155], v[140:143], v[192:207]
    v_mfma_f32_32x32x16_bf16 v[208:223], a[156:159], v[140:143], v[208:223]
    s_nop 0
    ds_write_b128 v188, v[240:243] offset:128
    ds_write_b128 v189, v[244:247] offset:128
    ds_write_b128 v190, v[248:251] offset:128
    ds_write_b128 v191, v[252:255] offset:128
    v_mfma_f32_32x32x16_bf16 v[192:207], a[160:163], v[148:151], v[192:207]
    s_waitcnt vmcnt(0)
    v_bitop3_b32 v9, v20, v28, v36 bitop3:0x80
    v_bitop3_b32 v9, v9, v44, 1 bitop3:0x80
    s_waitcnt lgkmcnt(0)
    s_barrier
    ds_read_b128 v[64:67], v184 offset:0
    v_mfma_f32_32x32x16_bf16 v[208:223], a[164:167], v[148:151], v[208:223]
    v_cmp_ne_u32 vcc, 1, v9
    ds_read_b128 v[68:71], v185 offset:0
    ds_read_b128 v[72:75], v184 offset:35872
    ds_read_b128 v[76:79], v185 offset:35872
    v_mfma_f32_32x32x16_bf16 v[192:207], a[168:171], v[156:159], v[192:207]
    s_cbranch_vccnz L_rt_116
L_ok_117:
    ds_read_b128 v[80:83], v186 offset:0
    ds_read_b128 v[84:87], v187 offset:0
    ds_read_b128 v[88:91], v186 offset:35872
    v_mfma_f32_32x32x16_bf16 v[208:223], a[172:175], v[156:159], v[208:223]
    ds_read_b128 v[92:95], v187 offset:35872
    v_mfma_f32_32x32x16_bf16 v[192:207], a[176:179], v[164:167], v[192:207]
    v_mfma_f32_32x32x16_bf16 v[208:223], a[180:183], v[164:167], v[208:223]
    v_mfma_f32_32x32x16_bf16 v[192:207], a[184:187], v[172:175], v[192:207]
    v_mfma_f32_32x32x16_bf16 v[208:223], a[188:191], v[172:175], v[208:223]
    s_waitcnt lgkmcnt(6)
    v_pk_add_f32 v[48:49], v[48:49], v[64:65]
    v_pk_add_f32 v[50:51], v[50:51], v[66:67]
    v_pk_add_f32 v[52:53], v[52:53], v[68:69]
    v_pk_add_f32 v[54:55], v[54:55], v[70:71]
    v_mfma_f32_32x32x16_bf16 v[192:207], a[192:195], v[20:23], v[192:207]
    s_waitcnt lgkmcnt(4)
    v_pk_add_f32 v[48:49], v[48:49], v[72:73]
    v_pk_add_f32 v[50:51], v[50:51], v[74:75]
    v_pk_add_f32 v[52:53], v[52:53], v[76:77]
    v_pk_add_f32 v[54:55], v[54:55], v[78:79]
    v_mfma_f32_32x32x16_bf16 v[192:207], a[200:203], v[28:31], v[192:207]
    s_waitcnt lgkmcnt(2)
    v_pk_add_f32 v[48:49], v[48:49], v[80:81]
    v_pk_add_f32 v[50:51], v[50:51], v[82:83]
    v_pk_add_f32 v[52:53], v[52:53], v[84:85]
    v_pk_add_f32 v[54:55], v[54:55], v[86:87]
    v_mfma_f32_32x32x16_bf16 v[192:207], a[208:211], v[36:39], v[192:207]
    s_waitcnt lgkmcnt(0)
    v_pk_add_f32 v[48:49], v[48:49], v[88:89]
    v_pk_add_f32 v[50:51], v[50:51], v[90:91]
    v_pk_add_f32 v[52:53], v[52:53], v[92:93]
    v_pk_add_f32 v[54:55], v[54:55], v[94:95]
    v_mfma_f32_32x32x16_bf16 v[192:207], a[216:219], v[44:47], v[192:207]
    v_cvt_pk_bf16_f32 v176, v48, v49
    v_cvt_pk_bf16_f32 v177, v50, v51
    v_cvt_pk_bf16_f32 v178, v52, v53
    v_cvt_pk_bf16_f32 v179, v54, v55
    v_mfma_f32_32x32x16_bf16 v[208:223], a[196:199], v[20:23], v[208:223]
    buffer_store_dwordx4 v[176:179], v11, s[16:19], s57 offen sc1
    v_mfma_f32_32x32x16_bf16 v[208:223], a[204:207], v[28:31], v[208:223]
    v_mfma_f32_32x32x16_bf16 v[208:223], a[212:215], v[36:39], v[208:223]
    v_mfma_f32_32x32x16_bf16 v[208:223], a[220:223], v[44:47], v[208:223]
    s_nop 2
    ds_write_b128 v188, v[192:195] offset:8192
    ds_write_b128 v189, v[196:199] offset:8192
    ds_write_b128 v190, v[200:203] offset:8192
    ds_write_b128 v191, v[204:207] offset:8192
    s_nop 4
    ds_write_b128 v188, v[208:211] offset:8320
    ds_write_b128 v189, v[212:215] offset:8320
    ds_write_b128 v190, v[216:219] offset:8320
    ds_write_b128 v191, v[220:223] offset:8320
    s_waitcnt lgkmcnt(0)
    s_barrier
    ds_read_b128 v[64:67], v184 offset:8192
    ds_read_b128 v[68:71], v185 offset:8192
    ds_read_b128 v[72:75], v184 offset:44064
    ds_read_b128 v[76:79], v185 offset:44064
    ds_read_b128 v[80:83], v186 offset:8192
    ds_read_b128 v[84:87], v187 offset:8192
    ds_read_b128 v[88:91], v186 offset:44064
    ds_read_b128 v[92:95], v187 offset:44064
    s_waitcnt lgkmcnt(6)
    v_pk_add_f32 v[56:57], v[56:57], v[64:65]
    v_pk_add_f32 v[58:59], v[58:59], v[66:67]
    v_pk_add_f32 v[60:61], v[60:61], v[68:69]
    v_pk_add_f32 v[62:63], v[62:63], v[70:71]
    s_waitcnt lgkmcnt(4)
    v_pk_add_f32 v[56:57], v[56:57], v[72:73]
    v_pk_add_f32 v[58:59], v[58:59], v[74:75]
    v_pk_add_f32 v[60:61], v[60:61], v[76:77]
    v_pk_add_f32 v[62:63], v[62:63], v[78:79]
    s_waitcnt lgkmcnt(2)
    v_pk_add_f32 v[56:57], v[56:57], v[80:81]
    v_pk_add_f32 v[58:59], v[58:59], v[82:83]
    v_pk_add_f32 v[60:61], v[60:61], v[84:85]
    v_pk_add_f32 v[62:63], v[62:63], v[86:87]
    s_waitcnt lgkmcnt(0)
    v_pk_add_f32 v[56:57], v[56:57], v[88:89]
    v_pk_add_f32 v[58:59], v[58:59], v[90:91]
    v_pk_add_f32 v[60:61], v[60:61], v[92:93]
    v_pk_add_f32 v[62:63], v[62:63], v[94:95]
    v_cvt_pk_bf16_f32 v180, v56, v57
    v_cvt_pk_bf16_f32 v181, v58, v59
    v_cvt_pk_bf16_f32 v182, v60, v61
    v_cvt_pk_bf16_f32 v183, v62, v63
    buffer_store_dwordx4 v[180:183], v11, s[16:19], s58 offen sc1
    s_endpgm
L_rt_10:
    s_add_u32 s24, s24, 1
    s_cmp_gt_u32 s24, 1000000
    s_cbranch_scc1 L_ok_11
    s_mov_b64 exec, vcc
    buffer_load_dwordx4 v[16:19], v176, s[8:11], s30 offen sc1
    buffer_load_dwordx4 v[20:23], v176, s[8:11], s33 offen sc1
    s_mov_b64 exec, -1
    s_waitcnt vmcnt(0)
    v_bitop3_b32 v9, v16, v20, s22 bitop3:0x7e
    v_and_b32 v9, 1, v9
    v_cmp_ne_u32 vcc, 0, v9
    s_cbranch_vccnz L_rt_10
    s_branch L_ok_11
L_rt_22:
    s_add_u32 s24, s24, 1
    s_cmp_gt_u32 s24, 1000000
    s_cbranch_scc1 L_ok_23
    s_mov_b64 exec, vcc
    buffer_load_dwordx4 v[24:27], v244, s[8:11], s33 offen sc1
    buffer_load_dwordx4 v[28:31], v244, s[8:11], s34 offen sc1
    s_mov_b64 exec, -1
    s_waitcnt vmcnt(0)
    v_bitop3_b32 v9, v24, v28, s22 bitop3:0x7e
    v_and_b32 v9, 1, v9
    v_cmp_ne_u32 vcc, 0, v9
    s_cbranch_vccnz L_rt_22
    s_branch L_ok_23
L_rt_28:
    s_add_u32 s24, s24, 1
    s_cmp_gt_u32 s24, 1000000
    s_cbranch_scc1 L_ok_29
    s_mov_b64 exec, vcc
    s_add_u32 s54, s44, 0
    buffer_load_dwordx4 v[16:19], v6, s[8:11], s54 offen offset:0 sc1
    buffer_load_dwordx4 v[20:23], v6, s[8:11], s54 offen offset:1024 sc1
    buffer_load_dwordx4 v[24:27], v6, s[8:11], s54 offen offset:2048 sc1
    buffer_load_dwordx4 v[28:31], v6, s[8:11], s54 offen offset:3072 sc1
    s_mov_b64 exec, -1
    s_waitcnt vmcnt(0)
    v_or3_b32 v9, v16, v20, v24
    v_or_b32 v9, v9, v28
    v_and_b32 v9, 1, v9
    v_cmp_ne_u32 vcc, 0, v9
    s_cbranch_vccnz L_rt_28
    s_branch L_ok_29
L_rt_30:
    s_add_u32 s24, s24, 1
    s_cmp_gt_u32 s24, 1000000
    s_cbranch_scc1 L_ok_31
    s_mov_b64 exec, vcc
    s_add_u32 s54, s44, 4096
    buffer_load_dwordx4 v[32:35], v6, s[8:11], s54 offen offset:0 sc1
    buffer_load_dwordx4 v[36:39], v6, s[8:11], s54 offen offset:1024 sc1
    buffer_load_dwordx4 v[40:43], v6, s[8:11], s54 offen offset:2048 sc1
    buffer_load_dwordx4 v[44:47], v6, s[8:11], s54 offen offset:3072 sc1
    s_mov_b64 exec, -1
    s_waitcnt vmcnt(0)
    v_or3_b32 v9, v32, v36, v40
    v_or_b32 v9, v9, v44
    v_and_b32 v9, 1, v9
    v_cmp_ne_u32 vcc, 0, v9
    s_cbranch_vccnz L_rt_30
    s_branch L_ok_31
L_rt_32:
    s_add_u32 s24, s24, 1
    s_cmp_gt_u32 s24, 1000000
    s_cbranch_scc1 L_ok_33
    s_mov_b64 exec, vcc
    s_add_u32 s54, s44, 8192
    buffer_load_dwordx4 v[48:51], v6, s[8:11], s54 offen offset:0 sc1
    buffer_load_dwordx4 v[52:55], v6, s[8:11], s54 offen offset:1024 sc1
    buffer_load_dwordx4 v[56:59], v6, s[8:11], s54 offen offset:2048 sc1
    buffer_load_dwordx4 v[60:63], v6, s[8:11], s54 offen offset:3072 sc1
    s_mov_b64 exec, -1
    s_waitcnt vmcnt(0)
    v_or3_b32 v9, v48, v52, v56
    v_or_b32 v9, v9, v60
    v_and_b32 v9, 1, v9
    v_cmp_ne_u32 vcc, 0, v9
    s_cbranch_vccnz L_rt_32
    s_branch L_ok_33
L_rt_34:
    s_add_u32 s24, s24, 1
    s_cmp_gt_u32 s24, 1000000
    s_cbranch_scc1 L_ok_35
    s_mov_b64 exec, vcc
    s_add_u32 s54, s44, 12288
    buffer_load_dwordx4 v[64:67], v6, s[8:11], s54 offen offset:0 sc1
    buffer_load_dwordx4 v[68:71], v6, s[8:11], s54 offen offset:1024 sc1
    buffer_load_dwordx4 v[72:75], v6, s[8:11], s54 offen offset:2048 sc1
    buffer_load_dwordx4 v[76:79], v6, s[8:11], s54 offen offset:3072 sc1
    s_mov_b64 exec, -1
    s_waitcnt vmcnt(0)
    v_or3_b32 v9, v64, v68, v72
    v_or_b32 v9, v9, v76
    v_and_b32 v9, 1, v9
    v_cmp_ne_u32 vcc, 0, v9
    s_cbranch_vccnz L_rt_34
    s_branch L_ok_35
L_rt_36:
    s_add_u32 s24, s24, 1
    s_cmp_gt_u32 s24, 1000000
    s_cbranch_scc1 L_ok_37
    s_mov_b64 exec, vcc
    s_add_u32 s54, s44, 16384
    buffer_load_dwordx4 v[80:83], v6, s[8:11], s54 offen offset:0 sc1
    buffer_load_dwordx4 v[84:87], v6, s[8:11], s54 offen offset:1024 sc1
    buffer_load_dwordx4 v[88:91], v6, s[8:11], s54 offen offset:2048 sc1
    buffer_load_dwordx4 v[92:95], v6, s[8:11], s54 offen offset:3072 sc1
    s_mov_b64 exec, -1
    s_waitcnt vmcnt(0)
    v_or3_b32 v9, v80, v84, v88
    v_or_b32 v9, v9, v92
    v_and_b32 v9, 1, v9
    v_cmp_ne_u32 vcc, 0, v9
    s_cbranch_vccnz L_rt_36
    s_branch L_ok_37
L_rt_38:
    s_add_u32 s24, s24, 1
    s_cmp_gt_u32 s24, 1000000
    s_cbranch_scc1 L_ok_39
    s_mov_b64 exec, vcc
    s_add_u32 s54, s44, 20480
    buffer_load_dwordx4 v[96:99], v6, s[8:11], s54 offen offset:0 sc1
    buffer_load_dwordx4 v[100:103], v6, s[8:11], s54 offen offset:1024 sc1
    buffer_load_dwordx4 v[104:107], v6, s[8:11], s54 offen offset:2048 sc1
    buffer_load_dwordx4 v[108:111], v6, s[8:11], s54 offen offset:3072 sc1
    s_mov_b64 exec, -1
    s_waitcnt vmcnt(0)
    v_or3_b32 v9, v96, v100, v104
    v_or_b32 v9, v9, v108
    v_and_b32 v9, 1, v9
    v_cmp_ne_u32 vcc, 0, v9
    s_cbranch_vccnz L_rt_38
    s_branch L_ok_39
L_rt_40:
    s_add_u32 s24, s24, 1
    s_cmp_gt_u32 s24, 1000000
    s_cbranch_scc1 L_ok_41
    s_mov_b64 exec, vcc
    s_add_u32 s54, s44, 24576
    buffer_load_dwordx4 v[112:115], v6, s[8:11], s54 offen offset:0 sc1
    buffer_load_dwordx4 v[116:119], v6, s[8:11], s54 offen offset:1024 sc1
    buffer_load_dwordx4 v[120:123], v6, s[8:11], s54 offen offset:2048 sc1
    buffer_load_dwordx4 v[124:127], v6, s[8:11], s54 offen offset:3072 sc1
    s_mov_b64 exec, -1
    s_waitcnt vmcnt(0)
    v_or3_b32 v9, v112, v116, v120
    v_or_b32 v9, v9, v124
    v_and_b32 v9, 1, v9
    v_cmp_ne_u32 vcc, 0, v9
    s_cbranch_vccnz L_rt_40
    s_branch L_ok_41
L_rt_42:
    s_add_u32 s24, s24, 1
    s_cmp_gt_u32 s24, 1000000
    s_cbranch_scc1 L_ok_43
    s_mov_b64 exec, vcc
    s_add_u32 s54, s44, 28672
    buffer_load_dwordx4 v[128:131], v6, s[8:11], s54 offen offset:0 sc1
    buffer_load_dwordx4 v[132:135], v6, s[8:11], s54 offen offset:1024 sc1
    buffer_load_dwordx4 v[136:139], v6, s[8:11], s54 offen offset:2048 sc1
    buffer_load_dwordx4 v[140:143], v6, s[8:11], s54 offen offset:3072 sc1
    s_mov_b64 exec, -1
    s_waitcnt vmcnt(0)
    v_or3_b32 v9, v128, v132, v136
    v_or_b32 v9, v9, v140
    v_and_b32 v9, 1, v9
    v_cmp_ne_u32 vcc, 0, v9
    s_cbranch_vccnz L_rt_42
    s_branch L_ok_43
L_rt_44:
    s_add_u32 s24, s24, 1
    s_cmp_gt_u32 s24, 1000000
    s_cbranch_scc1 L_ok_45
    s_add_u32 s55, s32, 0
    buffer_load_dwordx4 v[148:151], v6, s[8:11], s55 offen sc1
    s_add_u32 s55, s28, 0
    buffer_load_dwordx4 v[144:147], v6, s[8:11], s55 offen sc1
    s_add_u32 s55, s33, 0
    buffer_load_dwordx4 v[156:159], v6, s[8:11], s55 offen sc1
    s_add_u32 s55, s29, 0
    buffer_load_dwordx4 v[152:155], v6, s[8:11], s55 offen sc1
    s_mov_b64 exec, -1
    s_waitcnt vmcnt(0)
    v_xor_b32 v148, v148, v14
    v_xor_b32 v149, v149, v15
    v_or_b32 v9, v148, v149
    v_xor_b32 v144, v144, v14
    v_xor_b32 v145, v145, v15
    v_or3_b32 v9, v9, v144, v145
    v_xor_b32 v156, v156, v14
    v_xor_b32 v157, v157, v15
    v_or3_b32 v9, v9, v156, v157
    v_xor_b32 v152, v152, v14
    v_xor_b32 v153, v153, v15
    v_or3_b32 v9, v9, v152, v153
    v_and_b32 v9, 0x30003, v9
    v_cmp_ne_u32 vcc, 0, v9
    s_cbranch_vccnz L_rt_44
    s_branch L_ok_45
L_rt_46:
    s_add_u32 s24, s24, 1
    s_cmp_gt_u32 s24, 1000000
    s_cbranch_scc1 L_ok_47
    s_add_u32 s55, s34, 0
    buffer_load_dwordx4 v[164:167], v6, s[8:11], s55 offen sc1
    s_add_u32 s55, s30, 0
    buffer_load_dwordx4 v[160:163], v6, s[8:11], s55 offen sc1
    s_add_u32 s55, s35, 0
    buffer_load_dwordx4 v[172:175], v6, s[8:11], s55 offen sc1
    s_add_u32 s55, s31, 0
    buffer_load_dwordx4 v[168:171], v6, s[8:11], s55 offen sc1
    s_mov_b64 exec, -1
    s_waitcnt vmcnt(0)
    v_xor_b32 v164, v164, v14
    v_xor_b32 v165, v165, v15
    v_or_b32 v9, v164, v165
    v_xor_b32 v160, v160, v14
    v_xor_b32 v161, v161, v15
    v_or3_b32 v9, v9, v160, v161
    v_xor_b32 v172, v172, v14
    v_xor_b32 v173, v173, v15
    v_or3_b32 v9, v9, v172, v173
    v_xor_b32 v168, v168, v14
    v_xor_b32 v169, v169, v15
    v_or3_b32 v9, v9, v168, v169
    v_and_b32 v9, 0x30003, v9
    v_cmp_ne_u32 vcc, 0, v9
    s_cbranch_vccnz L_rt_46
    s_branch L_ok_47
L_rt_48:
    s_add_u32 s24, s24, 1
    s_cmp_gt_u32 s24, 1000000
    s_cbranch_scc1 L_ok_49
    s_add_u32 s55, s32, 1024
    buffer_load_dwordx4 v[20:23], v6, s[8:11], s55 offen sc1
    s_add_u32 s55, s28, 1024
    buffer_load_dwordx4 v[16:19], v6, s[8:11], s55 offen sc1
    s_add_u32 s55, s33, 1024
    buffer_load_dwordx4 v[28:31], v6, s[8:11], s55 offen sc1
    s_add_u32 s55, s29, 1024
    buffer_load_dwordx4 v[24:27], v6, s[8:11], s55 offen sc1
    s_mov_b64 exec, -1
    s_waitcnt vmcnt(0)
    v_xor_b32 v20, v20, v14
    v_xor_b32 v21, v21, v15
    v_or_b32 v9, v20, v21
    v_xor_b32 v16, v16, v14
    v_xor_b32 v17, v17, v15
    v_or3_b32 v9, v9, v16, v17
    v_xor_b32 v28, v28, v14
    v_xor_b32 v29, v29, v15
    v_or3_b32 v9, v9, v28, v29
    v_xor_b32 v24, v24, v14
    v_xor_b32 v25, v25, v15
    v_or3_b32 v9, v9, v24, v25
    v_and_b32 v9, 0x30003, v9
    v_cmp_ne_u32 vcc, 0, v9
    s_cbranch_vccnz L_rt_48
    s_branch L_ok_49
L_rt_50:
    s_add_u32 s24, s24, 1
    s_cmp_gt_u32 s24, 1000000
    s_cbranch_scc1 L_ok_51
    s_add_u32 s55, s34, 1024
    buffer_load_dwordx4 v[36:39], v6, s[8:11], s55 offen sc1
    s_add_u32 s55, s30, 1024
    buffer_load_dwordx4 v[32:35], v6, s[8:11], s55 offen sc1
    s_add_u32 s55, s35, 1024
    buffer_load_dwordx4 v[44:47], v6, s[8:11], s55 offen sc1
    s_add_u32 s55, s31, 1024
    buffer_load_dwordx4 v[40:43], v6, s[8:11], s55 offen sc1
    s_mov_b64 exec, -1
    s_waitcnt vmcnt(0)
    v_xor_b32 v36, v36, v14
    v_xor_b32 v37, v37, v15
    v_or_b32 v9, v36, v37
    v_xor_b32 v32, v32, v14
    v_xor_b32 v33, v33, v15
    v_or3_b32 v9, v9, v32, v33
    v_xor_b32 v44, v44, v14
    v_xor_b32 v45, v45, v15
    v_or3_b32 v9, v9, v44, v45
    v_xor_b32 v40, v40, v14
    v_xor_b32 v41, v41, v15
    v_or3_b32 v9, v9, v40, v41
    v_and_b32 v9, 0x30003, v9
    v_cmp_ne_u32 vcc, 0, v9
    s_cbranch_vccnz L_rt_50
    s_branch L_ok_51
L_rt_52:
    s_add_u32 s24, s24, 1
    s_cmp_gt_u32 s24, 1000000
    s_cbranch_scc1 L_ok_53
    s_add_u32 s55, s32, 2048
    buffer_load_dwordx4 v[52:55], v6, s[8:11], s55 offen sc1
    s_add_u32 s55, s28, 2048
    buffer_load_dwordx4 v[48:51], v6, s[8:11], s55 offen sc1
    s_add_u32 s55, s33, 2048
    buffer_load_dwordx4 v[60:63], v6, s[8:11], s55 offen sc1
    s_add_u32 s55, s29, 2048
    buffer_load_dwordx4 v[56:59], v6, s[8:11], s55 offen sc1
    s_mov_b64 exec, -1
    s_waitcnt vmcnt(0)
    v_xor_b32 v52, v52, v14
    v_xor_b32 v53, v53, v15
    v_or_b32 v9, v52, v53
    v_xor_b32 v48, v48, v14
    v_xor_b32 v49, v49, v15
    v_or3_b32 v9, v9, v48, v49
    v_xor_b32 v60, v60, v14
    v_xor_b32 v61, v61, v15
    v_or3_b32 v9, v9, v60, v61
    v_xor_b32 v56, v56, v14
    v_xor_b32 v57, v57, v15
    v_or3_b32 v9, v9, v56, v57
    v_and_b32 v9, 0x30003, v9
    v_cmp_ne_u32 vcc, 0, v9
    s_cbranch_vccnz L_rt_52
    s_branch L_ok_53
L_rt_54:
    s_add_u32 s24, s24, 1
    s_cmp_gt_u32 s24, 1000000
    s_cbranch_scc1 L_ok_55
    s_add_u32 s55, s34, 2048
    buffer_load_dwordx4 v[68:71], v6, s[8:11], s55 offen sc1
    s_add_u32 s55, s30, 2048
    buffer_load_dwordx4 v[64:67], v6, s[8:11], s55 offen sc1
    s_add_u32 s55, s35, 2048
    buffer_load_dwordx4 v[76:79], v6, s[8:11], s55 offen sc1
    s_add_u32 s55, s31, 2048
    buffer_load_dwordx4 v[72:75], v6, s[8:11], s55 offen sc1
    s_mov_b64 exec, -1
    s_waitcnt vmcnt(0)
    v_xor_b32 v68, v68, v14
    v_xor_b32 v69, v69, v15
    v_or_b32 v9, v68, v69
    v_xor_b32 v64, v64, v14
    v_xor_b32 v65, v65, v15
    v_or3_b32 v9, v9, v64, v65
    v_xor_b32 v76, v76, v14
    v_xor_b32 v77, v77, v15
    v_or3_b32 v9, v9, v76, v77
    v_xor_b32 v72, v72, v14
    v_xor_b32 v73, v73, v15
    v_or3_b32 v9, v9, v72, v73
    v_and_b32 v9, 0x30003, v9
    v_cmp_ne_u32 vcc, 0, v9
    s_cbranch_vccnz L_rt_54
    s_branch L_ok_55
L_rt_56:
    s_add_u32 s24, s24, 1
    s_cmp_gt_u32 s24, 1000000
    s_cbranch_scc1 L_ok_57
    s_add_u32 s55, s32, 3072
    buffer_load_dwordx4 v[84:87], v6, s[8:11], s55 offen sc1
    s_add_u32 s55, s28, 3072
    buffer_load_dwordx4 v[80:83], v6, s[8:11], s55 offen sc1
    s_add_u32 s55, s33, 3072
    buffer_load_dwordx4 v[92:95], v6, s[8:11], s55 offen sc1
    s_add_u32 s55, s29, 3072
    buffer_load_dwordx4 v[88:91], v6, s[8:11], s55 offen sc1
    s_mov_b64 exec, -1
    s_waitcnt vmcnt(0)
    v_xor_b32 v84, v84, v14
    v_xor_b32 v85, v85, v15
    v_or_b32 v9, v84, v85
    v_xor_b32 v80, v80, v14
    v_xor_b32 v81, v81, v15
    v_or3_b32 v9, v9, v80, v81
    v_xor_b32 v92, v92, v14
    v_xor_b32 v93, v93, v15
    v_or3_b32 v9, v9, v92, v93
    v_xor_b32 v88, v88, v14
    v_xor_b32 v89, v89, v15
    v_or3_b32 v9, v9, v88, v89
    v_and_b32 v9, 0x30003, v9
    v_cmp_ne_u32 vcc, 0, v9
    s_cbranch_vccnz L_rt_56
    s_branch L_ok_57
L_rt_58:
    s_add_u32 s24, s24, 1
    s_cmp_gt_u32 s24, 1000000
    s_cbranch_scc1 L_ok_59
    s_add_u32 s55, s34, 3072
    buffer_load_dwordx4 v[100:103], v6, s[8:11], s55 offen sc1
    s_add_u32 s55, s30, 3072
    buffer_load_dwordx4 v[96:99], v6, s[8:11], s55 offen sc1
    s_add_u32 s55, s35, 3072
    buffer_load_dwordx4 v[108:111], v6, s[8:11], s55 offen sc1
    s_add_u32 s55, s31, 3072
    buffer_load_dwordx4 v[104:107], v6, s[8:11], s55 offen sc1
    s_mov_b64 exec, -1
    s_waitcnt vmcnt(0)
    v_xor_b32 v100, v100, v14
    v_xor_b32 v101, v101, v15
    v_or_b32 v9, v100, v101
    v_xor_b32 v96, v96, v14
    v_xor_b32 v97, v97, v15
    v_or3_b32 v9, v9, v96, v97
    v_xor_b32 v108, v108, v14
    v_xor_b32 v109, v109, v15
    v_or3_b32 v9, v9, v108, v109
    v_xor_b32 v104, v104, v14
    v_xor_b32 v105, v105, v15
    v_or3_b32 v9, v9, v104, v105
    v_and_b32 v9, 0x30003, v9
    v_cmp_ne_u32 vcc, 0, v9
    s_cbranch_vccnz L_rt_58
    s_branch L_ok_59
L_rt_60:
    s_add_u32 s24, s24, 1
    s_cmp_gt_u32 s24, 1000000
    s_cbranch_scc1 L_ok_61
    s_add_u32 s55, s32, 4096
    buffer_load_dwordx4 v[116:119], v6, s[8:11], s55 offen sc1
    s_add_u32 s55, s28, 4096
    buffer_load_dwordx4 v[112:115], v6, s[8:11], s55 offen sc1
    s_add_u32 s55, s33, 4096
    buffer_load_dwordx4 v[124:127], v6, s[8:11], s55 offen sc1
    s_add_u32 s55, s29, 4096
    buffer_load_dwordx4 v[120:123], v6, s[8:11], s55 offen sc1
    s_mov_b64 exec, -1
    s_waitcnt vmcnt(0)
    v_xor_b32 v116, v116, v14
    v_xor_b32 v117, v117, v15
    v_or_b32 v9, v116, v117
    v_xor_b32 v112, v112, v14
    v_xor_b32 v113, v113, v15
    v_or3_b32 v9, v9, v112, v113
    v_xor_b32 v124, v124, v14
    v_xor_b32 v125, v125, v15
    v_or3_b32 v9, v9, v124, v125
    v_xor_b32 v120, v120, v14
    v_xor_b32 v121, v121, v15
    v_or3_b32 v9, v9, v120, v121
    v_and_b32 v9, 0x30003, v9
    v_cmp_ne_u32 vcc, 0, v9
    s_cbranch_vccnz L_rt_60
    s_branch L_ok_61
L_rt_62:
    s_add_u32 s24, s24, 1
    s_cmp_gt_u32 s24, 1000000
    s_cbranch_scc1 L_ok_63
    s_add_u32 s55, s30, 4096
    buffer_load_dwordx4 v[128:131], v6, s[8:11], s55 offen sc1
    s_add_u32 s55, s31, 4096
    buffer_load_dwordx4 v[136:139], v6, s[8:11], s55 offen sc1
    s_add_u32 s55, s28, 5120
    buffer_load_dwordx4 v[144:147], v6, s[8:11], s55 offen sc1
    s_add_u32 s55, s29, 5120
    buffer_load_dwordx4 v[152:155], v6, s[8:11], s55 offen sc1
    s_mov_b64 exec, -1
    s_waitcnt vmcnt(0)
    v_xor_b32 v128, v128, v14
    v_xor_b32 v129, v129, v15
    v_or_b32 v9, v128, v129
    v_xor_b32 v136, v136, v14
    v_xor_b32 v137, v137, v15
    v_or3_b32 v9, v9, v136, v137
    v_xor_b32 v144, v144, v14
    v_xor_b32 v145, v145, v15
    v_or3_b32 v9, v9, v144, v145
    v_xor_b32 v152, v152, v14
    v_xor_b32 v153, v153, v15
    v_or3_b32 v9, v9, v152, v153
    v_and_b32 v9, 0x30003, v9
    v_cmp_ne_u32 vcc, 0, v9
    s_cbranch_vccnz L_rt_62
    s_branch L_ok_63
L_rt_64:
    s_add_u32 s24, s24, 1
    s_cmp_gt_u32 s24, 1000000
    s_cbranch_scc1 L_ok_65
    s_add_u32 s55, s30, 5120
    buffer_load_dwordx4 v[160:163], v6, s[8:11], s55 offen sc1
    s_add_u32 s55, s31, 5120
    buffer_load_dwordx4 v[168:171], v6, s[8:11], s55 offen sc1
    s_add_u32 s55, s28, 6144
    buffer_load_dwordx4 v[16:19], v6, s[8:11], s55 offen sc1
    s_add_u32 s55, s29, 6144
    buffer_load_dwordx4 v[24:27], v6, s[8:11], s55 offen sc1
    s_mov_b64 exec, -1
    s_waitcnt vmcnt(0)
    v_xor_b32 v160, v160, v14
    v_xor_b32 v161, v161, v15
    v_or_b32 v9, v160, v161
    v_xor_b32 v168, v168, v14
    v_xor_b32 v169, v169, v15
    v_or3_b32 v9, v9, v168, v169
    v_xor_b32 v16, v16, v14
    v_xor_b32 v17, v17, v15
    v_or3_b32 v9, v9, v16, v17
    v_xor_b32 v24, v24, v14
    v_xor_b32 v25, v25, v15
    v_or3_b32 v9, v9, v24, v25
    v_and_b32 v9, 0x30003, v9
    v_cmp_ne_u32 vcc, 0, v9
    s_cbranch_vccnz L_rt_64
    s_branch L_ok_65
L_rt_66:
    s_add_u32 s24, s24, 1
    s_cmp_gt_u32 s24, 1000000
    s_cbranch_scc1 L_ok_67
    s_add_u32 s55, s30, 6144
    buffer_load_dwordx4 v[32:35], v6, s[8:11], s55 offen sc1
    s_add_u32 s55, s31, 6144
    buffer_load_dwordx4 v[40:43], v6, s[8:11], s55 offen sc1
    s_add_u32 s55, s34, 4096
    buffer_load_dwordx4 v[132:135], v6, s[8:11], s55 offen sc1
    s_add_u32 s55, s35, 4096
    buffer_load_dwordx4 v[140:143], v6, s[8:11], s55 offen sc1
    s_mov_b64 exec, -1
    s_waitcnt vmcnt(0)
    v_xor_b32 v32, v32, v14
    v_xor_b32 v33, v33, v15
    v_or_b32 v9, v32, v33
    v_xor_b32 v40, v40, v14
    v_xor_b32 v41, v41, v15
    v_or3_b32 v9, v9, v40, v41
    v_xor_b32 v132, v132, v14
    v_xor_b32 v133, v133, v15
    v_or3_b32 v9, v9, v132, v133
    v_xor_b32 v140, v140, v14
    v_xor_b32 v141, v141, v15
    v_or3_b32 v9, v9, v140, v141
    v_and_b32 v9, 0x30003, v9
    v_cmp_ne_u32 vcc, 0, v9
    s_cbranch_vccnz L_rt_66
    s_branch L_ok_67
L_rt_68:
    s_add_u32 s24, s24, 1
    s_cmp_gt_u32 s24, 1000000
    s_cbranch_scc1 L_ok_69
    s_add_u32 s55, s32, 5120
    buffer_load_dwordx4 v[148:151], v6, s[8:11], s55 offen sc1
    s_add_u32 s55, s33, 5120
    buffer_load_dwordx4 v[156:159], v6, s[8:11], s55 offen sc1
    s_add_u32 s55, s34, 5120
    buffer_load_dwordx4 v[164:167], v6, s[8:11], s55 offen sc1
    s_add_u32 s55, s35, 5120
    buffer_load_dwordx4 v[172:175], v6, s[8:11], s55 offen sc1
    s_mov_b64 exec, -1
    s_waitcnt vmcnt(0)
    v_xor_b32 v148, v148, v14
    v_xor_b32 v149, v149, v15
    v_or_b32 v9, v148, v149
    v_xor_b32 v156, v156, v14
    v_xor_b32 v157, v157, v15
    v_or3_b32 v9, v9, v156, v157
    v_xor_b32 v164, v164, v14
    v_xor_b32 v165, v165, v15
    v_or3_b32 v9, v9, v164, v165
    v_xor_b32 v172, v172, v14
    v_xor_b32 v173, v173, v15
    v_or3_b32 v9, v9, v172, v173
    v_and_b32 v9, 0x30003, v9
    v_cmp_ne_u32 vcc, 0, v9
    s_cbranch_vccnz L_rt_68
    s_branch L_ok_69
L_rt_70:
    s_add_u32 s24, s24, 1
    s_cmp_gt_u32 s24, 1000000
    s_cbranch_scc1 L_ok_71
    s_add_u32 s55, s32, 6144
    buffer_load_dwordx4 v[20:23], v6, s[8:11], s55 offen sc1
    s_add_u32 s55, s33, 6144
    buffer_load_dwordx4 v[28:31], v6, s[8:11], s55 offen sc1
    s_add_u32 s55, s34, 6144
    buffer_load_dwordx4 v[36:39], v6, s[8:11], s55 offen sc1
    s_add_u32 s55, s35, 6144
    buffer_load_dwordx4 v[44:47], v6, s[8:11], s55 offen sc1
    s_mov_b64 exec, -1
    s_waitcnt vmcnt(0)
    v_xor_b32 v20, v20, v14
    v_xor_b32 v21, v21, v15
    v_or_b32 v9, v20, v21
    v_xor_b32 v28, v28, v14
    v_xor_b32 v29, v29, v15
    v_or3_b32 v9, v9, v28, v29
    v_xor_b32 v36, v36, v14
    v_xor_b32 v37, v37, v15
    v_or3_b32 v9, v9, v36, v37
    v_xor_b32 v44, v44, v14
    v_xor_b32 v45, v45, v15
    v_or3_b32 v9, v9, v44, v45
    v_and_b32 v9, 0x30003, v9
    v_cmp_ne_u32 vcc, 0, v9
    s_cbranch_vccnz L_rt_70
    s_branch L_ok_71
L_rt_72:
    s_add_u32 s24, s24, 1
    s_cmp_gt_u32 s24, 1000000
    s_cbranch_scc1 L_ok_73
    s_mov_b64 exec, vcc
    buffer_load_dwordx4 v[16:19], v248, s[8:11], s30 offen offset:0 sc1
    buffer_load_dwordx4 v[20:23], v248, s[8:11], s30 offen offset:512 sc1
    s_mov_b64 exec, -1
    s_waitcnt vmcnt(0)
    v_bitop3_b32 v9, v16, v20, s22 bitop3:0x7e
    v_and_b32 v9, 1, v9
    v_cmp_ne_u32 vcc, 0, v9
    s_cbranch_vccnz L_rt_72
    s_branch L_ok_73
L_rt_74:
    s_add_u32 s24, s24, 1
    s_cmp_gt_u32 s24, 1000000
    s_cbranch_scc1 L_ok_75
    s_mov_b64 exec, vcc
    s_add_u32 s54, s44, 0
    buffer_load_dwordx4 v[16:19], v6, s[8:11], s54 offen offset:0 sc1
    buffer_load_dwordx4 v[20:23], v6, s[8:11], s54 offen offset:1024 sc1
    buffer_load_dwordx4 v[24:27], v6, s[8:11], s54 offen offset:2048 sc1
    buffer_load_dwordx4 v[28:31], v6, s[8:11], s54 offen offset:3072 sc1
    s_mov_b64 exec, -1
    s_waitcnt vmcnt(0)
    v_or3_b32 v9, v16, v20, v24
    v_or_b32 v9, v9, v28
    v_and_b32 v9, 1, v9
    v_cmp_ne_u32 vcc, 0, v9
    s_cbranch_vccnz L_rt_74
    s_branch L_ok_75
L_rt_76:
    s_add_u32 s24, s24, 1
    s_cmp_gt_u32 s24, 1000000
    s_cbranch_scc1 L_ok_77
    s_mov_b64 exec, vcc
    s_add_u32 s54, s44, 4096
    buffer_load_dwordx4 v[32:35], v6, s[8:11], s54 offen offset:0 sc1
    buffer_load_dwordx4 v[36:39], v6, s[8:11], s54 offen offset:1024 sc1
    buffer_load_dwordx4 v[40:43], v6, s[8:11], s54 offen offset:2048 sc1
    buffer_load_dwordx4 v[44:47], v6, s[8:11], s54 offen offset:3072 sc1
    s_mov_b64 exec, -1
    s_waitcnt vmcnt(0)
    v_or3_b32 v9, v32, v36, v40
    v_or_b32 v9, v9, v44
    v_and_b32 v9, 1, v9
    v_cmp_ne_u32 vcc, 0, v9
    s_cbranch_vccnz L_rt_76
    s_branch L_ok_77
L_rt_78:
    s_add_u32 s24, s24, 1
    s_cmp_gt_u32 s24, 1000000
    s_cbranch_scc1 L_ok_79
    s_mov_b64 exec, vcc
    s_add_u32 s54, s44, 8192
    buffer_load_dwordx4 v[48:51], v6, s[8:11], s54 offen offset:0 sc1
    buffer_load_dwordx4 v[52:55], v6, s[8:11], s54 offen offset:1024 sc1
    buffer_load_dwordx4 v[56:59], v6, s[8:11], s54 offen offset:2048 sc1
    buffer_load_dwordx4 v[60:63], v6, s[8:11], s54 offen offset:3072 sc1
    s_mov_b64 exec, -1
    s_waitcnt vmcnt(0)
    v_or3_b32 v9, v48, v52, v56
    v_or_b32 v9, v9, v60
    v_and_b32 v9, 1, v9
    v_cmp_ne_u32 vcc, 0, v9
    s_cbranch_vccnz L_rt_78
    s_branch L_ok_79
L_rt_80:
    s_add_u32 s24, s24, 1
    s_cmp_gt_u32 s24, 1000000
    s_cbranch_scc1 L_ok_81
    s_mov_b64 exec, vcc
    s_add_u32 s54, s44, 12288
    buffer_load_dwordx4 v[64:67], v6, s[8:11], s54 offen offset:0 sc1
    buffer_load_dwordx4 v[68:71], v6, s[8:11], s54 offen offset:1024 sc1
    buffer_load_dwordx4 v[72:75], v6, s[8:11], s54 offen offset:2048 sc1
    buffer_load_dwordx4 v[76:79], v6, s[8:11], s54 offen offset:3072 sc1
    s_mov_b64 exec, -1
    s_waitcnt vmcnt(0)
    v_or3_b32 v9, v64, v68, v72
    v_or_b32 v9, v9, v76
    v_and_b32 v9, 1, v9
    v_cmp_ne_u32 vcc, 0, v9
    s_cbranch_vccnz L_rt_80
    s_branch L_ok_81
L_rt_82:
    s_add_u32 s24, s24, 1
    s_cmp_gt_u32 s24, 1000000
    s_cbranch_scc1 L_ok_83
    s_mov_b64 exec, vcc
    s_add_u32 s54, s44, 16384
    buffer_load_dwordx4 v[80:83], v6, s[8:11], s54 offen offset:0 sc1
    buffer_load_dwordx4 v[84:87], v6, s[8:11], s54 offen offset:1024 sc1
    buffer_load_dwordx4 v[88:91], v6, s[8:11], s54 offen offset:2048 sc1
    buffer_load_dwordx4 v[92:95], v6, s[8:11], s54 offen offset:3072 sc1
    s_mov_b64 exec, -1
    s_waitcnt vmcnt(0)
    v_or3_b32 v9, v80, v84, v88
    v_or_b32 v9, v9, v92
    v_and_b32 v9, 1, v9
    v_cmp_ne_u32 vcc, 0, v9
    s_cbranch_vccnz L_rt_82
    s_branch L_ok_83
L_rt_84:
    s_add_u32 s24, s24, 1
    s_cmp_gt_u32 s24, 1000000
    s_cbranch_scc1 L_ok_85
    s_mov_b64 exec, vcc
    s_add_u32 s54, s44, 20480
    buffer_load_dwordx4 v[96:99], v6, s[8:11], s54 offen offset:0 sc1
    buffer_load_dwordx4 v[100:103], v6, s[8:11], s54 offen offset:1024 sc1
    buffer_load_dwordx4 v[104:107], v6, s[8:11], s54 offen offset:2048 sc1
    buffer_load_dwordx4 v[108:111], v6, s[8:11], s54 offen offset:3072 sc1
    s_mov_b64 exec, -1
    s_waitcnt vmcnt(0)
    v_or3_b32 v9, v96, v100, v104
    v_or_b32 v9, v9, v108
    v_and_b32 v9, 1, v9
    v_cmp_ne_u32 vcc, 0, v9
    s_cbranch_vccnz L_rt_84
    s_branch L_ok_85
L_rt_86:
    s_add_u32 s24, s24, 1
    s_cmp_gt_u32 s24, 1000000
    s_cbranch_scc1 L_ok_87
    s_mov_b64 exec, vcc
    s_add_u32 s54, s44, 24576
    buffer_load_dwordx4 v[112:115], v6, s[8:11], s54 offen offset:0 sc1
    buffer_load_dwordx4 v[116:119], v6, s[8:11], s54 offen offset:1024 sc1
    buffer_load_dwordx4 v[120:123], v6, s[8:11], s54 offen offset:2048 sc1
    buffer_load_dwordx4 v[124:127], v6, s[8:11], s54 offen offset:3072 sc1
    s_mov_b64 exec, -1
    s_waitcnt vmcnt(0)
    v_or3_b32 v9, v112, v116, v120
    v_or_b32 v9, v9, v124
    v_and_b32 v9, 1, v9
    v_cmp_ne_u32 vcc, 0, v9
    s_cbranch_vccnz L_rt_86
    s_branch L_ok_87
L_rt_88:
    s_add_u32 s24, s24, 1
    s_cmp_gt_u32 s24, 1000000
    s_cbranch_scc1 L_ok_89
    s_mov_b64 exec, vcc
    s_add_u32 s54, s44, 28672
    buffer_load_dwordx4 v[128:131], v6, s[8:11], s54 offen offset:0 sc1
    buffer_load_dwordx4 v[132:135], v6, s[8:11], s54 offen offset:1024 sc1
    buffer_load_dwordx4 v[136:139], v6, s[8:11], s54 offen offset:2048 sc1
    buffer_load_dwordx4 v[140:143], v6, s[8:11], s54 offen offset:3072 sc1
    s_mov_b64 exec, -1
    s_waitcnt vmcnt(0)
    v_or3_b32 v9, v128, v132, v136
    v_or_b32 v9, v9, v140
    v_and_b32 v9, 1, v9
    v_cmp_ne_u32 vcc, 0, v9
    s_cbranch_vccnz L_rt_88
    s_branch L_ok_89
L_rt_90:
    s_add_u32 s24, s24, 1
    s_cmp_gt_u32 s24, 1000000
    s_cbranch_scc1 L_ok_91
    s_mov_b64 exec, vcc
    s_add_u32 s55, s32, 0
    buffer_load_dwordx4 v[148:151], v6, s[8:11], s55 offen sc1
    s_add_u32 s55, s28, 0
    buffer_load_dwordx4 v[144:147], v6, s[8:11], s55 offen sc1
    s_add_u32 s55, s33, 0
    buffer_load_dwordx4 v[156:159], v6, s[8:11], s55 offen sc1
    s_add_u32 s55, s29, 0
    buffer_load_dwordx4 v[152:155], v6, s[8:11], s55 offen sc1
    s_mov_b64 exec, -1
    s_waitcnt vmcnt(0)
    v_bitop3_b32 v9, v148, v144, v156 bitop3:0x80
    v_bitop3_b32 v9, v9, v152, 1 bitop3:0x80
    v_cmp_ne_u32 vcc, 1, v9
    s_cbranch_vccnz L_rt_90
    s_branch L_ok_91
L_rt_92:
    s_add_u32 s24, s24, 1
    s_cmp_gt_u32 s24, 1000000
    s_cbranch_scc1 L_ok_93
    s_mov_b64 exec, vcc
    s_add_u32 s55, s34, 0
    buffer_load_dwordx4 v[164:167], v6, s[8:11], s55 offen sc1
    s_add_u32 s55, s30, 0
    buffer_load_dwordx4 v[160:163], v6, s[8:11], s55 offen sc1
    s_add_u32 s55, s35, 0
    buffer_load_dwordx4 v[172:175], v6, s[8:11], s55 offen sc1
    s_add_u32 s55, s31, 0
    buffer_load_dwordx4 v[168:171], v6, s[8:11], s55 offen sc1
    s_mov_b64 exec, -1
    s_waitcnt vmcnt(0)
    v_bitop3_b32 v9, v164, v160, v172 bitop3:0x80
    v_bitop3_b32 v9, v9, v168, 1 bitop3:0x80
    v_cmp_ne_u32 vcc, 1, v9
    s_cbranch_vccnz L_rt_92
    s_branch L_ok_93
L_rt_94:
    s_add_u32 s24, s24, 1
    s_cmp_gt_u32 s24, 1000000
    s_cbranch_scc1 L_ok_95
    s_mov_b64 exec, vcc
    s_add_u32 s55, s32, 1024
    buffer_load_dwordx4 v[20:23], v6, s[8:11], s55 offen sc1
    s_add_u32 s55, s28, 1024
    buffer_load_dwordx4 v[16:19], v6, s[8:11], s55 offen sc1
    s_add_u32 s55, s33, 1024
    buffer_load_dwordx4 v[28:31], v6, s[8:11], s55 offen sc1
    s_add_u32 s55, s29, 1024
    buffer_load_dwordx4 v[24:27], v6, s[8:11], s55 offen sc1
    s_mov_b64 exec, -1
    s_waitcnt vmcnt(0)
    v_bitop3_b32 v9, v20, v16, v28 bitop3:0x80
    v_bitop3_b32 v9, v9, v24, 1 bitop3:0x80
    v_cmp_ne_u32 vcc, 1, v9
    s_cbranch_vccnz L_rt_94
    s_branch L_ok_95
L_rt_96:
    s_add_u32 s24, s24, 1
    s_cmp_gt_u32 s24, 1000000
    s_cbranch_scc1 L_ok_97
    s_mov_b64 exec, vcc
    s_add_u32 s55, s34, 1024
    buffer_load_dwordx4 v[36:39], v6, s[8:11], s55 offen sc1
    s_add_u32 s55, s30, 1024
    buffer_load_dwordx4 v[32:35], v6, s[8:11], s55 offen sc1
    s_add_u32 s55, s35, 1024
    buffer_load_dwordx4 v[44:47], v6, s[8:11], s55 offen sc1
    s_add_u32 s55, s31, 1024
    buffer_load_dwordx4 v[40:43], v6, s[8:11], s55 offen sc1
    s_mov_b64 exec, -1
    s_waitcnt vmcnt(0)
    v_bitop3_b32 v9, v36, v32, v44 bitop3:0x80
    v_bitop3_b32 v9, v9, v40, 1 bitop3:0x80
    v_cmp_ne_u32 vcc, 1, v9
    s_cbranch_vccnz L_rt_96
    s_branch L_ok_97
L_rt_98:
    s_add_u32 s24, s24, 1
    s_cmp_gt_u32 s24, 1000000
    s_cbranch_scc1 L_ok_99
    s_mov_b64 exec, vcc
    s_add_u32 s55, s32, 2048
    buffer_load_dwordx4 v[52:55], v6, s[8:11], s55 offen sc1
    s_add_u32 s55, s28, 2048
    buffer_load_dwordx4 v[48:51], v6, s[8:11], s55 offen sc1
    s_add_u32 s55, s33, 2048
    buffer_load_dwordx4 v[60:63], v6, s[8:11], s55 offen sc1
    s_add_u32 s55, s29, 2048
    buffer_load_dwordx4 v[56:59], v6, s[8:11], s55 offen sc1
    s_mov_b64 exec, -1
    s_waitcnt vmcnt(0)
    v_bitop3_b32 v9, v52, v48, v60 bitop3:0x80
    v_bitop3_b32 v9, v9, v56, 1 bitop3:0x80
    v_cmp_ne_u32 vcc, 1, v9
    s_cbranch_vccnz L_rt_98
    s_branch L_ok_99
L_rt_100:
    s_add_u32 s24, s24, 1
    s_cmp_gt_u32 s24, 1000000
    s_cbranch_scc1 L_ok_101
    s_mov_b64 exec, vcc
    s_add_u32 s55, s34, 2048
    buffer_load_dwordx4 v[68:71], v6, s[8:11], s55 offen sc1
    s_add_u32 s55, s30, 2048
    buffer_load_dwordx4 v[64:67], v6, s[8:11], s55 offen sc1
    s_add_u32 s55, s35, 2048
    buffer_load_dwordx4 v[76:79], v6, s[8:11], s55 offen sc1
    s_add_u32 s55, s31, 2048
    buffer_load_dwordx4 v[72:75], v6, s[8:11], s55 offen sc1
    s_mov_b64 exec, -1
    s_waitcnt vmcnt(0)
    v_bitop3_b32 v9, v68, v64, v76 bitop3:0x80
    v_bitop3_b32 v9, v9, v72, 1 bitop3:0x80
    v_cmp_ne_u32 vcc, 1, v9
    s_cbranch_vccnz L_rt_100
    s_branch L_ok_101
L_rt_102:
    s_add_u32 s24, s24, 1
    s_cmp_gt_u32 s24, 1000000
    s_cbranch_scc1 L_ok_103
    s_mov_b64 exec, vcc
    s_add_u32 s55, s32, 3072
    buffer_load_dwordx4 v[84:87], v6, s[8:11], s55 offen sc1
    s_add_u32 s55, s28, 3072
    buffer_load_dwordx4 v[80:83], v6, s[8:11], s55 offen sc1
    s_add_u32 s55, s33, 3072
    buffer_load_dwordx4 v[92:95], v6, s[8:11], s55 offen sc1
    s_add_u32 s55, s29, 3072
    buffer_load_dwordx4 v[88:91], v6, s[8:11], s55 offen sc1
    s_mov_b64 exec, -1
    s_waitcnt vmcnt(0)
    v_bitop3_b32 v9, v84, v80, v92 bitop3:0x80
    v_bitop3_b32 v9, v9, v88, 1 bitop3:0x80
    v_cmp_ne_u32 vcc, 1, v9
    s_cbranch_vccnz L_rt_102
    s_branch L_ok_103
L_rt_104:
    s_add_u32 s24, s24, 1
    s_cmp_gt_u32 s24, 1000000
    s_cbranch_scc1 L_ok_105
    s_mov_b64 exec, vcc
    s_add_u32 s55, s34, 3072
    buffer_load_dwordx4 v[100:103], v6, s[8:11], s55 offen sc1
    s_add_u32 s55, s30, 3072
    buffer_load_dwordx4 v[96:99], v6, s[8:11], s55 offen sc1
    s_add_u32 s55, s35, 3072
    buffer_load_dwordx4 v[108:111], v6, s[8:11], s55 offen sc1
    s_add_u32 s55, s31, 3072
    buffer_load_dwordx4 v[104:107], v6, s[8:11], s55 offen sc1
    s_mov_b64 exec, -1
    s_waitcnt vmcnt(0)
    v_bitop3_b32 v9, v100, v96, v108 bitop3:0x80
    v_bitop3_b32 v9, v9, v104, 1 bitop3:0x80
    v_cmp_ne_u32 vcc, 1, v9
    s_cbranch_vccnz L_rt_104
    s_branch L_ok_105
L_rt_106:
    s_add_u32 s24, s24, 1
    s_cmp_gt_u32 s24, 1000000
    s_cbranch_scc1 L_ok_107
    s_mov_b64 exec, vcc
    s_add_u32 s55, s32, 4096
    buffer_load_dwordx4 v[116:119], v6, s[8:11], s55 offen sc1
    s_add_u32 s55, s28, 4096
    buffer_load_dwordx4 v[112:115], v6, s[8:11], s55 offen sc1
    s_add_u32 s55, s33, 4096
    buffer_load_dwordx4 v[124:127], v6, s[8:11], s55 offen sc1
    s_add_u32 s55, s29, 4096
    buffer_load_dwordx4 v[120:123], v6, s[8:11], s55 offen sc1
    s_mov_b64 exec, -1
    s_waitcnt vmcnt(0)
    v_bitop3_b32 v9, v116, v112, v124 bitop3:0x80
    v_bitop3_b32 v9, v9, v120, 1 bitop3:0x80
    v_cmp_ne_u32 vcc, 1, v9
    s_cbranch_vccnz L_rt_106
    s_branch L_ok_107
L_rt_108:
    s_add_u32 s24, s24, 1
    s_cmp_gt_u32 s24, 1000000
    s_cbranch_scc1 L_ok_109
    s_mov_b64 exec, vcc
    s_add_u32 s55, s30, 4096
    buffer_load_dwordx4 v[128:131], v6, s[8:11], s55 offen sc1
    s_add_u32 s55, s31, 4096
    buffer_load_dwordx4 v[136:139], v6, s[8:11], s55 offen sc1
    s_add_u32 s55, s28, 5120
    buffer_load_dwordx4 v[144:147], v6, s[8:11], s55 offen sc1
    s_add_u32 s55, s29, 5120
    buffer_load_dwordx4 v[152:155], v6, s[8:11], s55 offen sc1
    s_mov_b64 exec, -1
    s_waitcnt vmcnt(0)
    v_bitop3_b32 v9, v128, v136, v144 bitop3:0x80
    v_bitop3_b32 v9, v9, v152, 1 bitop3:0x80
    v_cmp_ne_u32 vcc, 1, v9
    s_cbranch_vccnz L_rt_108
    s_branch L_ok_109
L_rt_110:
    s_add_u32 s24, s24, 1
    s_cmp_gt_u32 s24, 1000000
    s_cbranch_scc1 L_ok_111
    s_mov_b64 exec, vcc
    s_add_u32 s55, s30, 5120
    buffer_load_dwordx4 v[160:163], v6, s[8:11], s55 offen sc1
    s_add_u32 s55, s31, 5120
    buffer_load_dwordx4 v[168:171], v6, s[8:11], s55 offen sc1
    s_add_u32 s55, s28, 6144
    buffer_load_dwordx4 v[16:19], v6, s[8:11], s55 offen sc1
    s_add_u32 s55, s29, 6144
    buffer_load_dwordx4 v[24:27], v6, s[8:11], s55 offen sc1
    s_mov_b64 exec, -1
    s_waitcnt vmcnt(0)
    v_bitop3_b32 v9, v160, v168, v16 bitop3:0x80
    v_bitop3_b32 v9, v9, v24, 1 bitop3:0x80
    v_cmp_ne_u32 vcc, 1, v9
    s_cbranch_vccnz L_rt_110
    s_branch L_ok_111
L_rt_112:
    s_add_u32 s24, s24, 1
    s_cmp_gt_u32 s24, 1000000
    s_cbranch_scc1 L_ok_113
    s_mov_b64 exec, vcc
    s_add_u32 s55, s30, 6144
    buffer_load_dwordx4 v[32:35], v6, s[8:11], s55 offen sc1
    s_add_u32 s55, s31, 6144
    buffer_load_dwordx4 v[40:43], v6, s[8:11], s55 offen sc1
    s_add_u32 s55, s34, 4096
    buffer_load_dwordx4 v[132:135], v6, s[8:11], s55 offen sc1
    s_add_u32 s55, s35, 4096
    buffer_load_dwordx4 v[140:143], v6, s[8:11], s55 offen sc1
    s_mov_b64 exec, -1
    s_waitcnt vmcnt(0)
    v_bitop3_b32 v9, v32, v40, v132 bitop3:0x80
    v_bitop3_b32 v9, v9, v140, 1 bitop3:0x80
    v_cmp_ne_u32 vcc, 1, v9
    s_cbranch_vccnz L_rt_112
    s_branch L_ok_113
L_rt_114:
    s_add_u32 s24, s24, 1
    s_cmp_gt_u32 s24, 1000000
    s_cbranch_scc1 L_ok_115
    s_mov_b64 exec, vcc
    s_add_u32 s55, s32, 5120
    buffer_load_dwordx4 v[148:151], v6, s[8:11], s55 offen sc1
    s_add_u32 s55, s33, 5120
    buffer_load_dwordx4 v[156:159], v6, s[8:11], s55 offen sc1
    s_add_u32 s55, s34, 5120
    buffer_load_dwordx4 v[164:167], v6, s[8:11], s55 offen sc1
    s_add_u32 s55, s35, 5120
    buffer_load_dwordx4 v[172:175], v6, s[8:11], s55 offen sc1
    s_mov_b64 exec, -1
    s_waitcnt vmcnt(0)
    v_bitop3_b32 v9, v148, v156, v164 bitop3:0x80
    v_bitop3_b32 v9, v9, v172, 1 bitop3:0x80
    v_cmp_ne_u32 vcc, 1, v9
    s_cbranch_vccnz L_rt_114
    s_branch L_ok_115
L_rt_116:
    s_add_u32 s24, s24, 1
    s_cmp_gt_u32 s24, 1000000
    s_cbranch_scc1 L_ok_117
    s_mov_b64 exec, vcc
    s_add_u32 s55, s32, 6144
    buffer_load_dwordx4 v[20:23], v6, s[8:11], s55 offen sc1
    s_add_u32 s55, s33, 6144
    buffer_load_dwordx4 v[28:31], v6, s[8:11], s55 offen sc1
    s_add_u32 s55, s34, 6144
    buffer_load_dwordx4 v[36:39], v6, s[8:11], s55 offen sc1
    s_add_u32 s55, s35, 6144
    buffer_load_dwordx4 v[44:47], v6, s[8:11], s55 offen sc1
    s_mov_b64 exec, -1
    s_waitcnt vmcnt(0)
    v_bitop3_b32 v9, v20, v28, v36 bitop3:0x80
    v_bitop3_b32 v9, v9, v44, 1 bitop3:0x80
    v_cmp_ne_u32 vcc, 1, v9
    s_cbranch_vccnz L_rt_116
    s_branch L_ok_117
L_exit:
    s_endpgm
.section .rodata,"a"
.p2align 6
.amdhsa_kernel interleave_layers__spectral_gfnet__glu_gated_reglu__prompt_kernel
  .amdhsa_next_free_vgpr 512
  .amdhsa_next_free_sgpr 102
  .amdhsa_accum_offset 256
  .amdhsa_group_segment_fixed_size 0
  .amdhsa_kernarg_size 80
  .amdhsa_user_sgpr_count 2
  .amdhsa_user_sgpr_kernarg_segment_ptr 1
  .amdhsa_system_sgpr_workgroup_id_x 1
.end_amdhsa_kernel
```
